```python
import torch

def _softmax(x, axis=-1):
    return torch.softmax(x, dim=axis)
def _gelu(x):
    return torch.nn.functional.gelu(x, approximate="tanh")
def _silu(x):
    return torch.nn.functional.silu(x)
def _sigmoid(x):
    return torch.sigmoid(x)
def _layernorm(x, axis=-1, eps=1e-5):
    m = x.mean(dim=axis, keepdim=True)
    v = x.var(dim=axis, keepdim=True, unbiased=False)
    return (x - m) / torch.sqrt(v + eps)
def _scatter_add(tgt, idx, src, axis=0):
    return tgt.clone().index_add_(axis, idx, src)
def _segment_sum(src, seg, n):
    out = torch.zeros((n,) + src.shape[1:], dtype=src.dtype)
    return out.index_add_(0, seg, src)
def _pad(x, pw):
    flat = tuple(v for pair in reversed(pw) for v in pair)
    return torch.nn.functional.pad(x, flat)

kernel_name = 'recurrent_scan__softmax_full_mha__glu_gated_swiglu__prompt'

def setup_inputs():

    _w = (lambda a: (lambda t: t.to(torch.bfloat16) if t.is_floating_point() else t)(torch.as_tensor(a)))
    def _A_setup():
        B, S, D = 1, 2048, 448
        return {
            "x": _w((lambda *s: torch.randn(*s, dtype=torch.bfloat16) * 0.05)(B, S, D)),
            "wqkv": _w((lambda *s: torch.randn(*s, dtype=torch.bfloat16) * 0.2)(D, 3 * D)),
            "wo": _w((lambda *s: torch.randn(*s, dtype=torch.bfloat16) * 0.2)(D, D)),
        }
    _A_in = _A_setup()

    def _B_setup():
        B, S, D, F = 1, 2048, 448, 1792
        return {
            "x": _w((lambda *s: torch.randn(*s, dtype=torch.bfloat16) * 0.05)(B, S, D)),
            "w1": _w((lambda *s: torch.randn(*s, dtype=torch.bfloat16) * 0.1)(D, F) * (2.0 / D) ** 0.5),
            "w3": _w((lambda *s: torch.randn(*s, dtype=torch.bfloat16) * 0.1)(D, F) * (2.0 / D) ** 0.5),
            "w2": _w((lambda *s: torch.randn(*s, dtype=torch.bfloat16) * 0.1)(F, D) * (2.0 / F) ** 0.5),
        }
    _B_in = _B_setup()

    return {
        "A_x": _A_in["x"],
        "A_wqkv": _A_in["wqkv"],
        "A_wo": _A_in["wo"],
        "B_x": _B_in["x"],
        "B_w1": _B_in["w1"],
        "B_w3": _B_in["w3"],
        "B_w2": _B_in["w2"],
    }

def reference(A_x, A_wqkv, A_wo, B_x, B_w1, B_w3, B_w2):
    def _A_ref(x, wqkv, wo):
        B, S, D = x.shape
        H = 16; Dh = D // H
        qkv = (lambda x, *d: x.permute(*d))((x @ wqkv).reshape(B, S, 3, H, Dh), 2, 0, 3, 1, 4)
        q, k, v = qkv[0], qkv[1], qkv[2]
        scale = Dh ** -0.5
        scores = torch.einsum("bhqd,bhkd->bhqk", q, k) * scale
        p = _softmax(scores, axis=-1)
        o = torch.einsum("bhqk,bhkd->bhqd", p, v)
        return (lambda x, *d: x.permute(*d))(o, 0, 2, 1, 3).reshape(B, S, D) @ wo

    def _B_ref(x, w1, w3, w2):
        gate = torch.einsum("bsd,df->bsf", x, w1)
        up = torch.einsum("bsd,df->bsf", x, w3)
        h = _silu(gate) * up
        out = torch.einsum("bsf,fd->bsd", h, w2)
        return out

    x = A_x
    xn = _layernorm(x, axis=-1)
    s = _A_ref(xn, A_wqkv, A_wo)
    g = _silu(_B_ref(xn, B_w1, B_w3, B_w2))
    return x + s * g
```

```asm
; @launch grid=(256,1,1) block=(512,1,1) lds=163840
.amdgcn_target "amdgcn-amd-amdhsa--gfx950"
.text
.globl recurrent_scan__softmax_full_mha__glu_gated_swiglu__prompt_kernel
.p2align 8
.type recurrent_scan__softmax_full_mha__glu_gated_swiglu__prompt_kernel,@function
recurrent_scan__softmax_full_mha__glu_gated_swiglu__prompt_kernel:
    s_cmp_ge_u32 s2, 256
    s_cbranch_scc1 L_end
    s_load_dwordx16 s[4:19], s[0:1], 0
    s_load_dwordx4 s[20:23], s[0:1], 64
    v_lshrrev_b32 v1, 6, v0
    v_and_b32 v0, 63, v0
    v_readfirstlane_b32 s60, v1
    s_and_b32 s32, s2, 7
    s_lshr_b32 s70, s2, 3
    s_cmp_lg_u32 s60, 7
    s_cbranch_scc1 L_1
    s_getpc_b64 s[76:77]
L_pc:
    s_sub_u32 s76, s76, L_pc-recurrent_scan__softmax_full_mha__glu_gated_swiglu__prompt_kernel
    s_subb_u32 s77, s77, 0
    s_and_b32 s75, s70, 7
    s_lshl_b32 s75, s75, 13
    v_lshlrev_b32 v12, 7, v0
    v_add_u32 v12, s75, v12
    v_min_u32 v12, L_code_end-recurrent_scan__softmax_full_mha__glu_gated_swiglu__prompt_kernel-4, v12
    global_load_dword v250, v12, s[76:77]
L_1:
    s_and_b32 s72, s32, 1
    s_lshl_b32 s72, s72, 3
    s_and_b32 s73, s70, 7
    s_add_u32 s62, s72, s73
    s_lshr_b32 s72, s32, 1
    s_lshl_b32 s72, s72, 2
    s_lshr_b32 s73, s70, 3
    s_add_u32 s63, s72, s73
    s_and_b32 s61, s60, 3
    s_mov_b32 s76, 0x67543210
    s_mov_b32 s77, 0xfedcba89
    s_lshl_b32 s75, s63, 2
    s_lshr_b64 s[76:77], s[76:77], s75
    s_and_b32 s64, s76, 15
    s_lshl_b32 s76, s32, 1
    s_and_b32 s77, s70, 1
    s_or_b32 s65, s76, s77
    s_lshr_b32 s66, s70, 1
    s_mul_i32 s76, s70, 37
    s_lshr_b32 s76, s76, 8
    s_mul_i32 s77, s76, 7
    s_sub_u32 s68, s70, s77
    s_lshl_b32 s77, s32, 2
    s_add_u32 s67, s77, s76
    v_lshrrev_b32 v12, 3, v0
    v_mul_u32_u24 v12, 896, v12
    v_and_b32 v13, 7, v0
    v_lshrrev_b32 v14, 4, v0
    v_xor_b32 v15, v13, v14
    v_lshl_add_u32 v1, v15, 4, v12
    v_xor_b32 v15, 4, v15
    v_lshl_add_u32 v2, v15, 4, v12
    s_lshl_b32 s73, s62, 2
    s_add_u32 s73, s73, s61
    s_mul_i32 s73, s73, 28672
    s_lshl_b32 s74, s61, 12
    s_mov_b32 s72, 0x12492493
    v_mul_hi_u32 v13, v0, s72
    v_mul_u32_u24 v14, 14, v13
    v_sub_u32 v14, v0, v14
    v_mul_u32_u24 v13, 3584, v13
    v_lshl_add_u32 v183, v14, 4, v13
    s_and_b32 s72, s61, 1
    s_mul_i32 s36, s72, 57344
    s_mul_i32 s75, s64, 224
    s_add_u32 s36, s36, s75
    s_mul_i32 s37, s72, 3584
    s_lshr_b32 s72, s61, 1
    s_mul_i32 s72, s72, 7296
    s_add_u32 s37, s37, s72
    s_mov_b32 s72, 0x15555556
    v_add_u32 v12, 0, v0
    v_mul_hi_u32 v13, v12, s72
    v_mul_u32_u24 v14, 12, v13
    v_sub_u32 v14, v12, v14
    v_lshlrev_b32 v14, 4, v14
    v_min_u32 v14, 152, v14
    v_mul_u32_u24 v13, 2688, v13
    v_add_u32 v180, v13, v14
    v_add_u32 v12, 64, v0
    v_mul_hi_u32 v13, v12, s72
    v_mul_u32_u24 v14, 12, v13
    v_sub_u32 v14, v12, v14
    v_lshlrev_b32 v14, 4, v14
    v_min_u32 v14, 152, v14
    v_mul_u32_u24 v13, 2688, v13
    v_add_u32 v181, v13, v14
    v_add_u32 v12, 128, v0
    v_mul_hi_u32 v13, v12, s72
    v_mul_u32_u24 v14, 12, v13
    v_sub_u32 v14, v12, v14
    v_lshlrev_b32 v14, 4, v14
    v_min_u32 v14, 152, v14
    v_mul_u32_u24 v13, 2688, v13
    v_add_u32 v182, v13, v14
    s_mul_i32 s38, s61, 43008
    s_mul_i32 s39, s63, 168
    s_add_u32 s38, s38, s39
    s_mul_i32 s39, s61, 3072
    s_cmp_ge_u32 s60, 4
    s_cbranch_scc1 L_ffn
    s_setprio 3
    s_waitcnt lgkmcnt(0)
    s_mov_b32 s24, s4
    s_mov_b32 s25, s5
    s_mov_b32 s26, 1835008
    s_mov_b32 s27, 0x20000
    s_cmp_ge_u32 s61, 2
    s_cselect_b32 s56, s14, s12
    s_cselect_b32 s57, s15, s13
    s_mov_b32 s58, 1605632
    s_mov_b32 s59, 0x20000
    s_mov_b32 s28, s6
    s_mov_b32 s29, s7
    s_mov_b32 s30, 1204224
    s_mov_b32 s31, 0x20000
    s_add_u32 m0, s74, 0
    s_add_u32 s75, s73, 0
    buffer_load_dwordx4 v1, s[24:27], s75 offen  lds
    s_add_u32 m0, s74, 1024
    s_add_u32 s75, s73, 7168
    buffer_load_dwordx4 v2, s[24:27], s75 offen  lds
    s_add_u32 m0, s74, 2048
    s_add_u32 s75, s73, 14336
    buffer_load_dwordx4 v1, s[24:27], s75 offen  lds
    s_add_u32 m0, s74, 3072
    s_add_u32 s75, s73, 21504
    buffer_load_dwordx4 v2, s[24:27], s75 offen  lds
    s_add_u32 m0, s74, 16384
    s_add_u32 s75, s73, 128
    buffer_load_dwordx4 v1, s[24:27], s75 offen  lds
    s_add_u32 m0, s74, 17408
    s_add_u32 s75, s73, 7296
    buffer_load_dwordx4 v2, s[24:27], s75 offen  lds
    s_add_u32 m0, s74, 18432
    s_add_u32 s75, s73, 14464
    buffer_load_dwordx4 v1, s[24:27], s75 offen  lds
    s_add_u32 m0, s74, 19456
    s_add_u32 s75, s73, 21632
    buffer_load_dwordx4 v2, s[24:27], s75 offen  lds
    s_mov_b32 s52, s22
    s_mov_b32 s53, s23
    s_mov_b32 s54, 18874368
    s_mov_b32 s55, 0x20000
    v_mov_b32 v212, 0
    buffer_load_dword v212, v212, s[52:55], 0 offen sc1
    s_lshl_b32 s75, s2, 1
    s_add_u32 s75, s75, s61
    s_add_u32 s75, s75, 255
    s_cmp_eq_u32 s61, 0
    s_cselect_b32 s75, s2, s75
    s_mov_b32 s76, s4
    s_mov_b32 s77, s5
    s_mov_b32 s78, s75
    s_mov_b32 s79, 256
    s_mov_b32 s80, 2
    s_mov_b32 s81, 896
    s_mov_b32 s33, 1
    s_sub_u32 s72, s75, 64
    s_cmp_ge_u32 s75, 64
    s_cselect_b32 s76, s6, s76
    s_cselect_b32 s77, s7, s77
    s_cselect_b32 s78, s72, s78
    s_cselect_b32 s79, 344064, s79
    s_cselect_b32 s80, 2, s80
    s_cselect_b32 s81, 256, s81
    s_cselect_b32 s33, 1, s33
    s_sub_u32 s72, s75, 106
    s_cmp_ge_u32 s75, 106
    s_cselect_b32 s76, s12, s76
    s_cselect_b32 s77, s13, s77
    s_cselect_b32 s78, s72, s78
    s_cselect_b32 s79, 0, s79
    s_cselect_b32 s80, 2, s80
    s_cselect_b32 s81, 256, s81
    s_cselect_b32 s33, 1, s33
    s_sub_u32 s72, s75, 176
    s_cmp_ge_u32 s75, 176
    s_cselect_b32 s76, s14, s76
    s_cselect_b32 s77, s15, s77
    s_cselect_b32 s78, s72, s78
    s_cselect_b32 s79, 0, s79
    s_cselect_b32 s80, 2, s80
    s_cselect_b32 s81, 256, s81
    s_cselect_b32 s33, 1, s33
    s_cmp_ge_u32 s75, 246
    s_cselect_b32 s33, 0, s33
    s_sub_u32 s72, s75, 256
    s_cmp_ge_u32 s75, 256
    s_cselect_b32 s76, s4, s76
    s_cselect_b32 s77, s5, s77
    s_cselect_b32 s78, s72, s78
    s_cselect_b32 s79, 512, s79
    s_cselect_b32 s80, 3, s80
    s_cselect_b32 s81, 896, s81
    s_cselect_b32 s33, 1, s33
    s_sub_u32 s72, s75, 352
    s_cmp_ge_u32 s75, 352
    s_cselect_b32 s76, s6, s76
    s_cselect_b32 s77, s7, s77
    s_cselect_b32 s78, s72, s78
    s_cselect_b32 s79, 688128, s79
    s_cselect_b32 s80, 2, s80
    s_cselect_b32 s81, 256, s81
    s_cselect_b32 s33, 1, s33
    s_sub_u32 s72, s75, 415
    s_cmp_ge_u32 s75, 415
    s_cselect_b32 s76, s12, s76
    s_cselect_b32 s77, s13, s77
    s_cselect_b32 s78, s72, s78
    s_cselect_b32 s79, 573440, s79
    s_cselect_b32 s80, 2, s80
    s_cselect_b32 s81, 256, s81
    s_cselect_b32 s33, 1, s33
    s_sub_u32 s72, s75, 541
    s_cmp_ge_u32 s75, 541
    s_cselect_b32 s76, s14, s76
    s_cselect_b32 s77, s15, s77
    s_cselect_b32 s78, s72, s78
    s_cselect_b32 s79, 573440, s79
    s_cselect_b32 s80, 2, s80
    s_cselect_b32 s81, 256, s81
    s_cselect_b32 s33, 1, s33
    s_cmp_ge_u32 s75, 667
    s_cselect_b32 s33, 0, s33
    s_mov_b32 s82, 0x80000000
    s_cmp_eq_u32 s80, 3
    s_cselect_b32 s82, 0x55555556, s82
    s_lshl_b32 s78, s78, 6
    v_add_u32 v148, s78, v0
    v_mul_hi_u32 v149, v148, s82
    v_mul_lo_u32 v150, v149, s80
    v_sub_u32 v148, v148, v150
    v_mul_lo_u32 v149, v149, s81
    v_lshl_add_u32 v148, v148, 7, v149
    v_add_u32 v148, s79, v148
    s_cmp_eq_u32 s61, 0
    s_cselect_b32 s72, 1, 2
    s_cmp_eq_u32 s61, 3
    s_cselect_b32 s72, 0, s72
    s_mul_i32 s20, s72, s33
    s_barrier
    s_cmp_lg_u32 s20, 1
    s_cbranch_scc1 L_2
    global_load_dword v146, v148, s[76:77]
L_2:
    v_and_b32 v10, 31, v0
    v_lshrrev_b32 v11, 5, v0
    s_and_b32 s83, s61, 3
    s_lshr_b32 s34, s61, 1
    v_bfe_u32 v12, v0, 1, 3
    v_lshl_add_u32 v13, s83, 1, v11
    v_lshl_add_u32 v14, v10, 7, s74
    v_xor_b32 v15, 0, v13
    v_xor_b32 v15, v15, v12
    v_lshl_add_u32 v4, v15, 4, v14
    v_xor_b32 v15, 2, v13
    v_xor_b32 v15, v15, v12
    v_lshl_add_u32 v5, v15, 4, v14
    v_xor_b32 v15, 4, v13
    v_xor_b32 v15, v15, v12
    v_lshl_add_u32 v6, v15, 4, v14
    v_xor_b32 v15, 6, v13
    v_xor_b32 v15, v15, v12
    v_lshl_add_u32 v7, v15, 4, v14
    v_and_b32 v12, 15, v0
    v_bfe_u32 v13, v0, 4, 1
    v_cmp_eq_u32 vcc, v12, v13
    v_mov_b32 v12, 0x3f803f80
    v_bfe_u32 v14, v0, 2, 2
    v_lshl_add_u32 v14, v11, 3, v14
    v_and_b32 v15, 3, v0
    v_lshlrev_b32 v15, 3, v15
    v_cndmask_b32 v196, 0, v12, vcc
    v_cndmask_b32 v197, 0, v12, vcc
    v_cndmask_b32 v198, 0, v12, vcc
    v_cndmask_b32 v199, 0, v12, vcc
    v_mul_u32_u24 v14, 192, v14
    v_add_u32 v14, v14, v15
    v_bfe_u32 v13, v0, 4, 1
    v_lshl_add_u32 v14, v13, 5, v14
    v_add_u32 v14, 49152, v14
    v_and_b32 v13, 0x13, v0
    v_cmp_eq_u32 vcc, 0x12, v13
    v_mov_b32 v15, 112
    v_mov_b32 v13, 120
    v_cndmask_b32 v15, v15, v13, vcc
    s_xor_b32 s72, s83, 0
    s_mul_i32 s72, s72, 3072
    v_add_u32 v204, s72, v14
    v_add_u32 v208, v204, v15
    s_xor_b32 s72, s83, 1
    s_mul_i32 s72, s72, 3072
    v_add_u32 v205, s72, v14
    v_add_u32 v209, v205, v15
    s_xor_b32 s72, s83, 2
    s_mul_i32 s72, s72, 3072
    v_add_u32 v206, s72, v14
    v_add_u32 v210, v206, v15
    s_xor_b32 s72, s83, 3
    s_mul_i32 s72, s72, 3072
    v_add_u32 v207, s72, v14
    v_add_u32 v211, v207, v15
    s_lshl_b32 s72, s66, 2
    s_add_u32 s72, s72, s61
    s_lshl_b32 s72, s72, 4
    s_add_u32 s72, s72, s65
    s_lshl_b32 s72, s72, 11
    s_add_u32 s35, s72, 16777216
    v_mov_b32 v152, -1
    v_mov_b32 v153, -1
    v_mov_b32 v154, -1
    v_mov_b32 v155, -1
    v_lshlrev_b32 v3, 4, v0
    s_cmp_lg_u32 s60, 3
    s_cbranch_scc1 LZ_3
    v_mov_b32 v16, 0
    v_mov_b32 v17, 0
    v_mov_b32 v18, 0
    v_mov_b32 v19, 0
    v_lshlrev_b32 v20, 4, v0
    v_add_u32 v20, 161152, v20
    ds_write_b128 v20, v[16:19]
LZ_3:
    s_lshl_b32 s72, s2, 3
    s_add_u32 s72, s72, s60
    s_cmp_lg_u32 s72, 3
    s_cbranch_scc1 LZ_4
    v_lshlrev_b32 v20, 7, v0
    v_add_u32 v20, 256, v20
    s_mov_b32 exec_hi, 0xffff
    buffer_store_dword v16, v20, s[52:55], 0 offen sc1
    s_mov_b64 exec, 1
    v_mov_b32 v20, 128
    s_waitcnt vmcnt(0)
    v_readfirstlane_b32 s69, v212
    s_mul_i32 s69, s69, 0x9e3779b1
    s_add_u32 s69, s69, 0x7f4a7c15
    v_mov_b32 v21, s69
    buffer_store_dword v21, v20, s[52:55], 0 offen sc1
    s_mov_b64 exec, -1
LZ_4:
    v_lshlrev_b32 v176, 4, v10
    v_add_u32 v176, 161792, v176
    s_lshl_b32 s72, s61, 7
    s_add_u32 s72, s72, 161280
    v_lshl_add_u32 v177, v10, 2, s72
    v_mul_u32_u24 v14, 2048, v11
    v_add_u32 v177, v177, v14
    s_lshl_b32 s72, s61, 2
    s_add_u32 s72, s72, 161792
    v_lshl_add_u32 v200, v0, 4, s72
    v_mov_b32 v184, 0
    v_mov_b32 v185, 0
    v_mov_b32 v186, 0
    v_mov_b32 v187, 0
    v_mov_b32 v188, 0
    v_mov_b32 v189, 0
    v_mov_b32 v190, 0
    v_mov_b32 v191, 0
    v_mov_b32 v192, 0
    v_mov_b32 v193, 0
    v_mov_b32 v194, 0
    v_mov_b32 v195, 0
    v_mov_b32 v161, 0
    v_mov_b32 v162, 0
    v_mov_b32 v163, 0
    v_mov_b32 v165, 0
    v_mov_b32 v166, 0
    v_mov_b32 v167, 0
    v_mov_b32 v169, 0
    v_mov_b32 v170, 0
    v_mov_b32 v171, 0
    v_mov_b32 v173, 0
    v_mov_b32 v174, 0
    v_mov_b32 v175, 0
    s_mul_i32 s72, s61, 2304
    s_add_u32 s72, s72, 0
    v_mul_u32_u24 v178, 72, v10
    v_lshl_add_u32 v178, v11, 3, v178
    v_add_u32 v178, s72, v178
    v_bfe_u32 v179, v0, 2, 2
    v_lshl_add_u32 v179, v11, 2, v179
    v_mul_u32_u24 v179, 72, v179
    v_bfe_u32 v14, v0, 4, 1
    v_lshl_add_u32 v179, v14, 5, v179
    v_and_b32 v14, 3, v0
    v_lshl_add_u32 v179, v14, 3, v179
    v_add_u32 v179, s72, v179
    s_lshl_b32 s81, s62, 2
    s_add_u32 s81, s81, s61
    s_mul_i32 s82, s63, 3
    s_add_u32 s78, s82, 0
    s_and_b32 s79, s78, 15
    s_lshl_b32 s79, s79, 6
    s_add_u32 s79, s79, s81
    s_lshl_b32 s80, s79, 12
    s_lshl_b32 s79, s79, 11
    s_add_u32 s79, s79, 1048576
    s_cmp_ge_u32 s78, 32
    s_cselect_b32 s72, 2048, 0
    s_cselect_b32 s43, 0x51800000, 1.0
    s_cselect_b32 s46, 0, 0x3f800000
    s_cselect_b32 s47, 0, 0x3f80
    s_or_b32 s46, s46, 0x3f80
    s_add_u32 s80, s80, s72
    s_add_u32 s80, s80, 4194304
    s_cmp_lt_u32 s78, 16
    s_cselect_b32 s40, s79, s80
    s_cselect_b32 s43, 0x3e8b97f6, s43
    s_cselect_b32 s46, 0, s46
    s_cselect_b32 s47, 0, s47
    s_add_u32 s78, s82, 1
    s_and_b32 s79, s78, 15
    s_lshl_b32 s79, s79, 6
    s_add_u32 s79, s79, s81
    s_lshl_b32 s80, s79, 12
    s_lshl_b32 s79, s79, 11
    s_add_u32 s79, s79, 1048576
    s_cmp_ge_u32 s78, 32
    s_cselect_b32 s72, 2048, 0
    s_cselect_b32 s44, 0x51800000, 1.0
    s_cselect_b32 s48, 0, 0x3f800000
    s_cselect_b32 s49, 0, 0x3f80
    s_or_b32 s48, s48, 0x3f80
    s_add_u32 s80, s80, s72
    s_add_u32 s80, s80, 4194304
    s_cmp_lt_u32 s78, 16
    s_cselect_b32 s41, s79, s80
    s_cselect_b32 s44, 0x3e8b97f6, s44
    s_cselect_b32 s48, 0, s48
    s_cselect_b32 s49, 0, s49
    s_add_u32 s78, s82, 2
    s_and_b32 s79, s78, 15
    s_lshl_b32 s79, s79, 6
    s_add_u32 s79, s79, s81
    s_lshl_b32 s80, s79, 12
    s_lshl_b32 s79, s79, 11
    s_add_u32 s79, s79, 1048576
    s_cmp_ge_u32 s78, 32
    s_cselect_b32 s72, 2048, 0
    s_cselect_b32 s45, 0x51800000, 1.0
    s_cselect_b32 s50, 0, 0x3f800000
    s_cselect_b32 s51, 0, 0x3f80
    s_or_b32 s50, s50, 0x3f80
    s_add_u32 s80, s80, s72
    s_add_u32 s80, s80, 4194304
    s_cmp_lt_u32 s78, 16
    s_cselect_b32 s42, s79, s80
    s_cselect_b32 s45, 0x3e8b97f6, s45
    s_cselect_b32 s50, 0, s50
    s_cselect_b32 s51, 0, s51
    v_mov_b32 v136, 0
    v_mov_b32 v137, 0
    v_mov_b32 v140, 0
    v_mov_b32 v141, 0
    s_mov_b32 s33, 0xffff0000
    s_waitcnt vmcnt(5) lgkmcnt(0)
    s_barrier
    ds_read_b128 v[16:19], v4 offset:0
    ds_read_b64_tr_b16 v[20:21], v204 offset:0
    ds_read_b64_tr_b16 v[22:23], v204 offset:768
    ds_read_b64_tr_b16 v[24:25], v204 offset:56
    ds_read_b64_tr_b16 v[26:27], v204 offset:824
    ds_read_b64_tr_b16 v[28:29], v208 offset:0
    ds_read_b64_tr_b16 v[30:31], v208 offset:768
    ds_read_b128 v[32:35], v5 offset:0
    ds_read_b64_tr_b16 v[36:37], v205 offset:0
    ds_read_b64_tr_b16 v[38:39], v205 offset:768
    ds_read_b64_tr_b16 v[40:41], v205 offset:56
    ds_read_b64_tr_b16 v[42:43], v205 offset:824
    ds_read_b64_tr_b16 v[44:45], v209 offset:0
    ds_read_b64_tr_b16 v[46:47], v209 offset:768
    s_add_u32 m0, s74, 32768
    s_add_u32 s75, s73, 256
    buffer_load_dwordx4 v1, s[24:27], s75 offen  lds
    s_add_u32 m0, s74, 33792
    s_add_u32 s75, s73, 7424
    buffer_load_dwordx4 v2, s[24:27], s75 offen  lds
    s_waitcnt lgkmcnt(7)
    ds_read_b128 v[96:99], v6 offset:0
    ds_read_b64_tr_b16 v[100:101], v206 offset:0
    ds_read_b64_tr_b16 v[102:103], v206 offset:768
    ds_read_b64_tr_b16 v[104:105], v206 offset:56
    ds_read_b64_tr_b16 v[106:107], v206 offset:824
    ds_read_b64_tr_b16 v[108:109], v210 offset:0
    ds_read_b64_tr_b16 v[110:111], v210 offset:768
    v_mfma_f32_32x32x16_bf16 v[48:63], v[20:23], v[16:19], 0
    s_add_u32 m0, s74, 34816
    s_add_u32 s75, s73, 14592
    buffer_load_dwordx4 v1, s[24:27], s75 offen  lds
    v_lshlrev_b32 v142, 16, v16
    v_and_b32 v143, s33, v16
    v_add_f32 v136, v136, v142
    v_add_f32 v137, v137, v143
    v_fmac_f32 v140, v142, v142
    v_fmac_f32 v141, v143, v143
    v_lshlrev_b32 v144, 16, v17
    v_and_b32 v145, s33, v17
    v_mfma_f32_16x16x32_bf16 v[184:187], v[196:199], v[20:23], v[184:187]
    v_mfma_f32_32x32x16_bf16 v[64:79], v[24:27], v[16:19], 0
    v_add_f32 v136, v136, v144
    v_add_f32 v137, v137, v145
    v_fmac_f32 v140, v144, v144
    v_fmac_f32 v141, v145, v145
    v_lshlrev_b32 v142, 16, v18
    v_and_b32 v143, s33, v18
    v_add_f32 v136, v136, v142
    v_add_f32 v137, v137, v143
    v_mfma_f32_16x16x32_bf16 v[188:191], v[196:199], v[24:27], v[188:191]
    v_mfma_f32_32x32x16_bf16 v[80:95], v[28:31], v[16:19], 0
    v_fmac_f32 v140, v142, v142
    v_fmac_f32 v141, v143, v143
    v_lshlrev_b32 v144, 16, v19
    v_and_b32 v145, s33, v19
    v_add_f32 v136, v136, v144
    v_add_f32 v137, v137, v145
    v_fmac_f32 v140, v144, v144
    v_fmac_f32 v141, v145, v145
    v_mfma_f32_16x16x32_bf16 v[192:195], v[196:199], v[28:31], v[192:195]
    s_waitcnt lgkmcnt(7)
    ds_read_b128 v[112:115], v7 offset:0
    ds_read_b64_tr_b16 v[116:117], v207 offset:0
    ds_read_b64_tr_b16 v[118:119], v207 offset:768
    ds_read_b64_tr_b16 v[120:121], v207 offset:56
    ds_read_b64_tr_b16 v[122:123], v207 offset:824
    ds_read_b64_tr_b16 v[124:125], v211 offset:0
    ds_read_b64_tr_b16 v[126:127], v211 offset:768
    v_mfma_f32_32x32x16_bf16 v[48:63], v[36:39], v[32:35], v[48:63]
    s_add_u32 m0, s74, 35840
    s_add_u32 s75, s73, 21760
    buffer_load_dwordx4 v2, s[24:27], s75 offen  lds
    v_lshlrev_b32 v142, 16, v32
    v_and_b32 v143, s33, v32
    v_add_f32 v136, v136, v142
    v_add_f32 v137, v137, v143
    v_fmac_f32 v140, v142, v142
    v_fmac_f32 v141, v143, v143
    v_lshlrev_b32 v144, 16, v33
    v_and_b32 v145, s33, v33
    v_mfma_f32_32x32x16_bf16 v[64:79], v[40:43], v[32:35], v[64:79]
    v_add_f32 v136, v136, v144
    v_add_f32 v137, v137, v145
    v_fmac_f32 v140, v144, v144
    v_fmac_f32 v141, v145, v145
    v_lshlrev_b32 v142, 16, v34
    v_and_b32 v143, s33, v34
    v_add_f32 v136, v136, v142
    v_add_f32 v137, v137, v143
    v_mfma_f32_32x32x16_bf16 v[80:95], v[44:47], v[32:35], v[80:95]
    v_fmac_f32 v140, v142, v142
    v_fmac_f32 v141, v143, v143
    v_lshlrev_b32 v144, 16, v35
    v_and_b32 v145, s33, v35
    v_add_f32 v136, v136, v144
    v_add_f32 v137, v137, v145
    v_fmac_f32 v140, v144, v144
    v_fmac_f32 v141, v145, v145
    s_waitcnt vmcnt(5) lgkmcnt(0)
    s_barrier
    ds_read_b128 v[16:19], v4 offset:16384
    ds_read_b64_tr_b16 v[20:21], v204 offset:12288
    ds_read_b64_tr_b16 v[22:23], v204 offset:13056
    ds_read_b64_tr_b16 v[24:25], v204 offset:12344
    ds_read_b64_tr_b16 v[26:27], v204 offset:13112
    ds_read_b64_tr_b16 v[28:29], v208 offset:12288
    ds_read_b64_tr_b16 v[30:31], v208 offset:13056
    ds_read_b128 v[32:35], v5 offset:16384
    ds_read_b64_tr_b16 v[36:37], v205 offset:12288
    ds_read_b64_tr_b16 v[38:39], v205 offset:13056
    ds_read_b64_tr_b16 v[40:41], v205 offset:12344
    ds_read_b64_tr_b16 v[42:43], v205 offset:13112
    ds_read_b64_tr_b16 v[44:45], v209 offset:12288
    ds_read_b64_tr_b16 v[46:47], v209 offset:13056
    v_mfma_f32_32x32x16_bf16 v[48:63], v[100:103], v[96:99], v[48:63]
    s_add_u32 m0, s74, 0
    s_add_u32 s75, s73, 384
    buffer_load_dwordx4 v1, s[24:27], s75 offen  lds
    v_lshlrev_b32 v142, 16, v96
    v_and_b32 v143, s33, v96
    v_add_f32 v136, v136, v142
    v_add_f32 v137, v137, v143
    v_fmac_f32 v140, v142, v142
    v_fmac_f32 v141, v143, v143
    v_lshlrev_b32 v144, 16, v97
    v_and_b32 v145, s33, v97
    v_mfma_f32_32x32x16_bf16 v[64:79], v[104:107], v[96:99], v[64:79]
    s_add_u32 m0, s74, 1024
    s_add_u32 s75, s73, 7552
    buffer_load_dwordx4 v2, s[24:27], s75 offen  lds
    v_add_f32 v136, v136, v144
    v_add_f32 v137, v137, v145
    v_fmac_f32 v140, v144, v144
    v_fmac_f32 v141, v145, v145
    v_lshlrev_b32 v142, 16, v98
    v_and_b32 v143, s33, v98
    v_add_f32 v136, v136, v142
    v_add_f32 v137, v137, v143
    v_mfma_f32_32x32x16_bf16 v[80:95], v[108:111], v[96:99], v[80:95]
    v_fmac_f32 v140, v142, v142
    v_fmac_f32 v141, v143, v143
    v_lshlrev_b32 v144, 16, v99
    v_and_b32 v145, s33, v99
    v_add_f32 v136, v136, v144
    v_add_f32 v137, v137, v145
    v_fmac_f32 v140, v144, v144
    v_fmac_f32 v141, v145, v145
    v_mfma_f32_32x32x16_bf16 v[48:63], v[116:119], v[112:115], v[48:63]
    s_add_u32 m0, s74, 2048
    s_add_u32 s75, s73, 14720
    buffer_load_dwordx4 v1, s[24:27], s75 offen  lds
    v_lshlrev_b32 v142, 16, v112
    v_and_b32 v143, s33, v112
    v_add_f32 v136, v136, v142
    v_add_f32 v137, v137, v143
    v_fmac_f32 v140, v142, v142
    v_fmac_f32 v141, v143, v143
    v_lshlrev_b32 v144, 16, v113
    v_and_b32 v145, s33, v113
    v_mfma_f32_32x32x16_bf16 v[64:79], v[120:123], v[112:115], v[64:79]
    s_add_u32 m0, s74, 3072
    s_add_u32 s75, s73, 21888
    buffer_load_dwordx4 v2, s[24:27], s75 offen  lds
    v_add_f32 v136, v136, v144
    v_add_f32 v137, v137, v145
    v_fmac_f32 v140, v144, v144
    v_fmac_f32 v141, v145, v145
    v_lshlrev_b32 v142, 16, v114
    v_and_b32 v143, s33, v114
    v_add_f32 v136, v136, v142
    v_add_f32 v137, v137, v143
    v_mfma_f32_32x32x16_bf16 v[80:95], v[124:127], v[112:115], v[80:95]
    v_fmac_f32 v140, v142, v142
    v_fmac_f32 v141, v143, v143
    v_lshlrev_b32 v144, 16, v115
    v_and_b32 v145, s33, v115
    v_add_f32 v136, v136, v144
    v_add_f32 v137, v137, v145
    v_fmac_f32 v140, v144, v144
    v_fmac_f32 v141, v145, v145
    s_waitcnt lgkmcnt(7)
    ds_read_b128 v[96:99], v6 offset:16384
    ds_read_b64_tr_b16 v[100:101], v206 offset:12288
    ds_read_b64_tr_b16 v[102:103], v206 offset:13056
    ds_read_b64_tr_b16 v[104:105], v206 offset:12344
    ds_read_b64_tr_b16 v[106:107], v206 offset:13112
    ds_read_b64_tr_b16 v[108:109], v210 offset:12288
    ds_read_b64_tr_b16 v[110:111], v210 offset:13056
    v_mfma_f32_32x32x16_bf16 v[48:63], v[20:23], v[16:19], v[48:63]
    s_cmp_lg_u32 s20, 2
    s_cbranch_scc1 L_5
    global_load_dword v146, v148, s[76:77]
L_5:
    v_lshlrev_b32 v142, 16, v16
    v_and_b32 v143, s33, v16
    v_add_f32 v136, v136, v142
    v_add_f32 v137, v137, v143
    v_fmac_f32 v140, v142, v142
    v_fmac_f32 v141, v143, v143
    v_lshlrev_b32 v144, 16, v17
    v_and_b32 v145, s33, v17
    v_mfma_f32_16x16x32_bf16 v[184:187], v[196:199], v[20:23], v[184:187]
    v_mfma_f32_32x32x16_bf16 v[64:79], v[24:27], v[16:19], v[64:79]
    v_add_f32 v136, v136, v144
    v_add_f32 v137, v137, v145
    v_fmac_f32 v140, v144, v144
    v_fmac_f32 v141, v145, v145
    v_lshlrev_b32 v142, 16, v18
    v_and_b32 v143, s33, v18
    v_add_f32 v136, v136, v142
    v_add_f32 v137, v137, v143
    v_mfma_f32_16x16x32_bf16 v[188:191], v[196:199], v[24:27], v[188:191]
    v_mfma_f32_32x32x16_bf16 v[80:95], v[28:31], v[16:19], v[80:95]
    v_fmac_f32 v140, v142, v142
    v_fmac_f32 v141, v143, v143
    v_lshlrev_b32 v144, 16, v19
    v_and_b32 v145, s33, v19
    v_add_f32 v136, v136, v144
    v_add_f32 v137, v137, v145
    v_fmac_f32 v140, v144, v144
    v_fmac_f32 v141, v145, v145
    v_mfma_f32_16x16x32_bf16 v[192:195], v[196:199], v[28:31], v[192:195]
    s_waitcnt lgkmcnt(7)
    ds_read_b128 v[112:115], v7 offset:16384
    ds_read_b64_tr_b16 v[116:117], v207 offset:12288
    ds_read_b64_tr_b16 v[118:119], v207 offset:13056
    ds_read_b64_tr_b16 v[120:121], v207 offset:12344
    ds_read_b64_tr_b16 v[122:123], v207 offset:13112
    ds_read_b64_tr_b16 v[124:125], v211 offset:12288
    ds_read_b64_tr_b16 v[126:127], v211 offset:13056
    v_mfma_f32_32x32x16_bf16 v[48:63], v[36:39], v[32:35], v[48:63]
    v_lshlrev_b32 v142, 16, v32
    v_and_b32 v143, s33, v32
    v_add_f32 v136, v136, v142
    v_add_f32 v137, v137, v143
    v_fmac_f32 v140, v142, v142
    v_fmac_f32 v141, v143, v143
    v_lshlrev_b32 v144, 16, v33
    v_and_b32 v145, s33, v33
    v_mfma_f32_32x32x16_bf16 v[64:79], v[40:43], v[32:35], v[64:79]
    v_add_f32 v136, v136, v144
    v_add_f32 v137, v137, v145
    v_fmac_f32 v140, v144, v144
    v_fmac_f32 v141, v145, v145
    v_lshlrev_b32 v142, 16, v34
    v_and_b32 v143, s33, v34
    v_add_f32 v136, v136, v142
    v_add_f32 v137, v137, v143
    v_mfma_f32_32x32x16_bf16 v[80:95], v[44:47], v[32:35], v[80:95]
    v_fmac_f32 v140, v142, v142
    v_fmac_f32 v141, v143, v143
    v_lshlrev_b32 v144, 16, v35
    v_and_b32 v145, s33, v35
    v_add_f32 v136, v136, v144
    v_add_f32 v137, v137, v145
    v_fmac_f32 v140, v144, v144
    v_fmac_f32 v141, v145, v145
    s_waitcnt vmcnt(4) lgkmcnt(0)
    s_barrier
    ds_read_b128 v[16:19], v4 offset:32768
    ds_read_b64_tr_b16 v[20:21], v204 offset:24576
    ds_read_b64_tr_b16 v[22:23], v204 offset:25344
    ds_read_b64_tr_b16 v[24:25], v204 offset:24632
    ds_read_b64_tr_b16 v[26:27], v204 offset:25400
    ds_read_b64_tr_b16 v[28:29], v208 offset:24576
    ds_read_b64_tr_b16 v[30:31], v208 offset:25344
    ds_read_b128 v[32:35], v5 offset:32768
    ds_read_b64_tr_b16 v[36:37], v205 offset:24576
    ds_read_b64_tr_b16 v[38:39], v205 offset:25344
    ds_read_b64_tr_b16 v[40:41], v205 offset:24632
    ds_read_b64_tr_b16 v[42:43], v205 offset:25400
    ds_read_b64_tr_b16 v[44:45], v209 offset:24576
    ds_read_b64_tr_b16 v[46:47], v209 offset:25344
    v_mfma_f32_32x32x16_bf16 v[48:63], v[100:103], v[96:99], v[48:63]
    s_add_u32 m0, s74, 16384
    s_add_u32 s75, s73, 512
    buffer_load_dwordx4 v1, s[24:27], s75 offen  lds
    v_lshlrev_b32 v142, 16, v96
    v_and_b32 v143, s33, v96
    v_add_f32 v136, v136, v142
    v_add_f32 v137, v137, v143
    v_fmac_f32 v140, v142, v142
    v_fmac_f32 v141, v143, v143
    v_lshlrev_b32 v144, 16, v97
    v_and_b32 v145, s33, v97
    v_mfma_f32_32x32x16_bf16 v[64:79], v[104:107], v[96:99], v[64:79]
    v_add_f32 v136, v136, v144
    v_add_f32 v137, v137, v145
    v_fmac_f32 v140, v144, v144
    v_fmac_f32 v141, v145, v145
    v_lshlrev_b32 v142, 16, v98
    v_and_b32 v143, s33, v98
    v_add_f32 v136, v136, v142
    v_add_f32 v137, v137, v143
    v_mfma_f32_32x32x16_bf16 v[80:95], v[108:111], v[96:99], v[80:95]
    v_fmac_f32 v140, v142, v142
    v_fmac_f32 v141, v143, v143
    v_lshlrev_b32 v144, 16, v99
    v_and_b32 v145, s33, v99
    v_add_f32 v136, v136, v144
    v_add_f32 v137, v137, v145
    v_fmac_f32 v140, v144, v144
    v_fmac_f32 v141, v145, v145
    v_mfma_f32_32x32x16_bf16 v[48:63], v[116:119], v[112:115], v[48:63]
    s_add_u32 m0, s74, 17408
    s_add_u32 s75, s73, 7680
    buffer_load_dwordx4 v2, s[24:27], s75 offen  lds
    v_lshlrev_b32 v142, 16, v112
    v_and_b32 v143, s33, v112
    v_add_f32 v136, v136, v142
    v_add_f32 v137, v137, v143
    v_fmac_f32 v140, v142, v142
    v_fmac_f32 v141, v143, v143
    v_lshlrev_b32 v144, 16, v113
    v_and_b32 v145, s33, v113
    v_mfma_f32_32x32x16_bf16 v[64:79], v[120:123], v[112:115], v[64:79]
    v_add_f32 v136, v136, v144
    v_add_f32 v137, v137, v145
    v_fmac_f32 v140, v144, v144
    v_fmac_f32 v141, v145, v145
    v_lshlrev_b32 v142, 16, v114
    v_and_b32 v143, s33, v114
    v_add_f32 v136, v136, v142
    v_add_f32 v137, v137, v143
    v_mfma_f32_32x32x16_bf16 v[80:95], v[124:127], v[112:115], v[80:95]
    v_fmac_f32 v140, v142, v142
    v_fmac_f32 v141, v143, v143
    v_lshlrev_b32 v144, 16, v115
    v_and_b32 v145, s33, v115
    v_add_f32 v136, v136, v144
    v_add_f32 v137, v137, v145
    v_fmac_f32 v140, v144, v144
    v_fmac_f32 v141, v145, v145
    s_waitcnt lgkmcnt(7)
    ds_read_b128 v[96:99], v6 offset:32768
    ds_read_b64_tr_b16 v[100:101], v206 offset:24576
    ds_read_b64_tr_b16 v[102:103], v206 offset:25344
    ds_read_b64_tr_b16 v[104:105], v206 offset:24632
    ds_read_b64_tr_b16 v[106:107], v206 offset:25400
    ds_read_b64_tr_b16 v[108:109], v210 offset:24576
    ds_read_b64_tr_b16 v[110:111], v210 offset:25344
    v_mfma_f32_32x32x16_bf16 v[48:63], v[20:23], v[16:19], v[48:63]
    s_add_u32 m0, s74, 18432
    s_add_u32 s75, s73, 14848
    buffer_load_dwordx4 v1, s[24:27], s75 offen  lds
    v_lshlrev_b32 v142, 16, v16
    v_and_b32 v143, s33, v16
    v_add_f32 v136, v136, v142
    v_add_f32 v137, v137, v143
    v_fmac_f32 v140, v142, v142
    v_fmac_f32 v141, v143, v143
    v_lshlrev_b32 v144, 16, v17
    v_and_b32 v145, s33, v17
    v_mfma_f32_16x16x32_bf16 v[184:187], v[196:199], v[20:23], v[184:187]
    v_mfma_f32_32x32x16_bf16 v[64:79], v[24:27], v[16:19], v[64:79]
    v_add_f32 v136, v136, v144
    v_add_f32 v137, v137, v145
    v_fmac_f32 v140, v144, v144
    v_fmac_f32 v141, v145, v145
    v_lshlrev_b32 v142, 16, v18
    v_and_b32 v143, s33, v18
    v_add_f32 v136, v136, v142
    v_add_f32 v137, v137, v143
    v_mfma_f32_16x16x32_bf16 v[188:191], v[196:199], v[24:27], v[188:191]
    v_mfma_f32_32x32x16_bf16 v[80:95], v[28:31], v[16:19], v[80:95]
    v_fmac_f32 v140, v142, v142
    v_fmac_f32 v141, v143, v143
    v_lshlrev_b32 v144, 16, v19
    v_and_b32 v145, s33, v19
    v_add_f32 v136, v136, v144
    v_add_f32 v137, v137, v145
    v_fmac_f32 v140, v144, v144
    v_fmac_f32 v141, v145, v145
    v_mfma_f32_16x16x32_bf16 v[192:195], v[196:199], v[28:31], v[192:195]
    s_waitcnt lgkmcnt(7)
    ds_read_b128 v[112:115], v7 offset:32768
    ds_read_b64_tr_b16 v[116:117], v207 offset:24576
    ds_read_b64_tr_b16 v[118:119], v207 offset:25344
    ds_read_b64_tr_b16 v[120:121], v207 offset:24632
    ds_read_b64_tr_b16 v[122:123], v207 offset:25400
    ds_read_b64_tr_b16 v[124:125], v211 offset:24576
    ds_read_b64_tr_b16 v[126:127], v211 offset:25344
    v_mfma_f32_32x32x16_bf16 v[48:63], v[36:39], v[32:35], v[48:63]
    s_add_u32 m0, s74, 19456
    s_add_u32 s75, s73, 22016
    buffer_load_dwordx4 v2, s[24:27], s75 offen  lds
    v_lshlrev_b32 v142, 16, v32
    v_and_b32 v143, s33, v32
    v_add_f32 v136, v136, v142
    v_add_f32 v137, v137, v143
    v_fmac_f32 v140, v142, v142
    v_fmac_f32 v141, v143, v143
    v_lshlrev_b32 v144, 16, v33
    v_and_b32 v145, s33, v33
    v_mfma_f32_32x32x16_bf16 v[64:79], v[40:43], v[32:35], v[64:79]
    v_add_f32 v136, v136, v144
    v_add_f32 v137, v137, v145
    v_fmac_f32 v140, v144, v144
    v_fmac_f32 v141, v145, v145
    v_lshlrev_b32 v142, 16, v34
    v_and_b32 v143, s33, v34
    v_add_f32 v136, v136, v142
    v_add_f32 v137, v137, v143
    v_mfma_f32_32x32x16_bf16 v[80:95], v[44:47], v[32:35], v[80:95]
    v_fmac_f32 v140, v142, v142
    v_fmac_f32 v141, v143, v143
    v_lshlrev_b32 v144, 16, v35
    v_and_b32 v145, s33, v35
    v_add_f32 v136, v136, v144
    v_add_f32 v137, v137, v145
    v_fmac_f32 v140, v144, v144
    v_fmac_f32 v141, v145, v145
    s_waitcnt vmcnt(4) lgkmcnt(0)
    s_barrier
    ds_read_b128 v[16:19], v4 offset:0
    ds_read_b64_tr_b16 v[20:21], v204 offset:0
    ds_read_b64_tr_b16 v[22:23], v204 offset:768
    ds_read_b64_tr_b16 v[24:25], v204 offset:56
    ds_read_b64_tr_b16 v[26:27], v204 offset:824
    ds_read_b64_tr_b16 v[28:29], v208 offset:0
    ds_read_b64_tr_b16 v[30:31], v208 offset:768
    ds_read_b128 v[32:35], v5 offset:0
    ds_read_b64_tr_b16 v[36:37], v205 offset:0
    ds_read_b64_tr_b16 v[38:39], v205 offset:768
    ds_read_b64_tr_b16 v[40:41], v205 offset:56
    ds_read_b64_tr_b16 v[42:43], v205 offset:824
    ds_read_b64_tr_b16 v[44:45], v209 offset:0
    ds_read_b64_tr_b16 v[46:47], v209 offset:768
    v_mfma_f32_32x32x16_bf16 v[48:63], v[100:103], v[96:99], v[48:63]
    s_add_u32 m0, s74, 32768
    s_add_u32 s75, s73, 640
    buffer_load_dwordx4 v1, s[24:27], s75 offen  lds
    v_lshlrev_b32 v142, 16, v96
    v_and_b32 v143, s33, v96
    v_add_f32 v136, v136, v142
    v_add_f32 v137, v137, v143
    v_fmac_f32 v140, v142, v142
    v_fmac_f32 v141, v143, v143
    v_lshlrev_b32 v144, 16, v97
    v_and_b32 v145, s33, v97
    v_mfma_f32_32x32x16_bf16 v[64:79], v[104:107], v[96:99], v[64:79]
    v_add_f32 v136, v136, v144
    v_add_f32 v137, v137, v145
    v_fmac_f32 v140, v144, v144
    v_fmac_f32 v141, v145, v145
    v_lshlrev_b32 v142, 16, v98
    v_and_b32 v143, s33, v98
    v_add_f32 v136, v136, v142
    v_add_f32 v137, v137, v143
    v_mfma_f32_32x32x16_bf16 v[80:95], v[108:111], v[96:99], v[80:95]
    v_fmac_f32 v140, v142, v142
    v_fmac_f32 v141, v143, v143
    v_lshlrev_b32 v144, 16, v99
    v_and_b32 v145, s33, v99
    v_add_f32 v136, v136, v144
    v_add_f32 v137, v137, v145
    v_fmac_f32 v140, v144, v144
    v_fmac_f32 v141, v145, v145
    v_mfma_f32_32x32x16_bf16 v[48:63], v[116:119], v[112:115], v[48:63]
    s_add_u32 m0, s74, 33792
    s_add_u32 s75, s73, 7808
    buffer_load_dwordx4 v2, s[24:27], s75 offen  lds
    v_lshlrev_b32 v142, 16, v112
    v_and_b32 v143, s33, v112
    v_add_f32 v136, v136, v142
    v_add_f32 v137, v137, v143
    v_fmac_f32 v140, v142, v142
    v_fmac_f32 v141, v143, v143
    v_lshlrev_b32 v144, 16, v113
    v_and_b32 v145, s33, v113
    v_mfma_f32_32x32x16_bf16 v[64:79], v[120:123], v[112:115], v[64:79]
    v_add_f32 v136, v136, v144
    v_add_f32 v137, v137, v145
    v_fmac_f32 v140, v144, v144
    v_fmac_f32 v141, v145, v145
    v_lshlrev_b32 v142, 16, v114
    v_and_b32 v143, s33, v114
    v_add_f32 v136, v136, v142
    v_add_f32 v137, v137, v143
    v_mfma_f32_32x32x16_bf16 v[80:95], v[124:127], v[112:115], v[80:95]
    v_fmac_f32 v140, v142, v142
    v_fmac_f32 v141, v143, v143
    v_lshlrev_b32 v144, 16, v115
    v_and_b32 v145, s33, v115
    v_add_f32 v136, v136, v144
    v_add_f32 v137, v137, v145
    v_fmac_f32 v140, v144, v144
    v_fmac_f32 v141, v145, v145
    s_waitcnt lgkmcnt(7)
    ds_read_b128 v[96:99], v6 offset:0
    ds_read_b64_tr_b16 v[100:101], v206 offset:0
    ds_read_b64_tr_b16 v[102:103], v206 offset:768
    ds_read_b64_tr_b16 v[104:105], v206 offset:56
    ds_read_b64_tr_b16 v[106:107], v206 offset:824
    ds_read_b64_tr_b16 v[108:109], v210 offset:0
    ds_read_b64_tr_b16 v[110:111], v210 offset:768
    v_mfma_f32_32x32x16_bf16 v[48:63], v[20:23], v[16:19], v[48:63]
    s_add_u32 m0, s74, 34816
    s_add_u32 s75, s73, 14976
    buffer_load_dwordx4 v1, s[24:27], s75 offen  lds
    v_lshlrev_b32 v142, 16, v16
    v_and_b32 v143, s33, v16
    v_add_f32 v136, v136, v142
    v_add_f32 v137, v137, v143
    v_fmac_f32 v140, v142, v142
    v_fmac_f32 v141, v143, v143
    v_lshlrev_b32 v144, 16, v17
    v_and_b32 v145, s33, v17
    v_mfma_f32_16x16x32_bf16 v[184:187], v[196:199], v[20:23], v[184:187]
    v_mfma_f32_32x32x16_bf16 v[64:79], v[24:27], v[16:19], v[64:79]
    v_add_f32 v136, v136, v144
    v_add_f32 v137, v137, v145
    v_fmac_f32 v140, v144, v144
    v_fmac_f32 v141, v145, v145
    v_lshlrev_b32 v142, 16, v18
    v_and_b32 v143, s33, v18
    v_add_f32 v136, v136, v142
    v_add_f32 v137, v137, v143
    v_mfma_f32_16x16x32_bf16 v[188:191], v[196:199], v[24:27], v[188:191]
    v_mfma_f32_32x32x16_bf16 v[80:95], v[28:31], v[16:19], v[80:95]
    v_fmac_f32 v140, v142, v142
    v_fmac_f32 v141, v143, v143
    v_lshlrev_b32 v144, 16, v19
    v_and_b32 v145, s33, v19
    v_add_f32 v136, v136, v144
    v_add_f32 v137, v137, v145
    v_fmac_f32 v140, v144, v144
    v_fmac_f32 v141, v145, v145
    v_mfma_f32_16x16x32_bf16 v[192:195], v[196:199], v[28:31], v[192:195]
    s_waitcnt lgkmcnt(7)
    ds_read_b128 v[112:115], v7 offset:0
    ds_read_b64_tr_b16 v[116:117], v207 offset:0
    ds_read_b64_tr_b16 v[118:119], v207 offset:768
    ds_read_b64_tr_b16 v[120:121], v207 offset:56
    ds_read_b64_tr_b16 v[122:123], v207 offset:824
    ds_read_b64_tr_b16 v[124:125], v211 offset:0
    ds_read_b64_tr_b16 v[126:127], v211 offset:768
    v_mfma_f32_32x32x16_bf16 v[48:63], v[36:39], v[32:35], v[48:63]
    s_add_u32 m0, s74, 35840
    s_add_u32 s75, s73, 22144
    buffer_load_dwordx4 v2, s[24:27], s75 offen  lds
    v_lshlrev_b32 v142, 16, v32
    v_and_b32 v143, s33, v32
    v_add_f32 v136, v136, v142
    v_add_f32 v137, v137, v143
    v_fmac_f32 v140, v142, v142
    v_fmac_f32 v141, v143, v143
    v_lshlrev_b32 v144, 16, v33
    v_and_b32 v145, s33, v33
    v_mfma_f32_32x32x16_bf16 v[64:79], v[40:43], v[32:35], v[64:79]
    v_add_f32 v136, v136, v144
    v_add_f32 v137, v137, v145
    v_fmac_f32 v140, v144, v144
    v_fmac_f32 v141, v145, v145
    v_lshlrev_b32 v142, 16, v34
    v_and_b32 v143, s33, v34
    v_add_f32 v136, v136, v142
    v_add_f32 v137, v137, v143
    v_mfma_f32_32x32x16_bf16 v[80:95], v[44:47], v[32:35], v[80:95]
    v_fmac_f32 v140, v142, v142
    v_fmac_f32 v141, v143, v143
    v_lshlrev_b32 v144, 16, v35
    v_and_b32 v145, s33, v35
    v_add_f32 v136, v136, v144
    v_add_f32 v137, v137, v145
    v_fmac_f32 v140, v144, v144
    v_fmac_f32 v141, v145, v145
    s_waitcnt vmcnt(4) lgkmcnt(0)
    s_barrier
    ds_read_b128 v[16:19], v4 offset:16384
    ds_read_b64_tr_b16 v[20:21], v204 offset:12288
    ds_read_b64_tr_b16 v[22:23], v204 offset:13056
    ds_read_b64_tr_b16 v[24:25], v204 offset:12344
    ds_read_b64_tr_b16 v[26:27], v204 offset:13112
    ds_read_b64_tr_b16 v[28:29], v208 offset:12288
    ds_read_b64_tr_b16 v[30:31], v208 offset:13056
    ds_read_b128 v[32:35], v5 offset:16384
    ds_read_b64_tr_b16 v[36:37], v205 offset:12288
    ds_read_b64_tr_b16 v[38:39], v205 offset:13056
    ds_read_b64_tr_b16 v[40:41], v205 offset:12344
    ds_read_b64_tr_b16 v[42:43], v205 offset:13112
    ds_read_b64_tr_b16 v[44:45], v209 offset:12288
    ds_read_b64_tr_b16 v[46:47], v209 offset:13056
    v_mfma_f32_32x32x16_bf16 v[48:63], v[100:103], v[96:99], v[48:63]
    s_add_u32 m0, s74, 0
    s_add_u32 s75, s73, 768
    buffer_load_dwordx4 v1, s[24:27], s75 offen  lds
    v_lshlrev_b32 v142, 16, v96
    v_and_b32 v143, s33, v96
    v_add_f32 v136, v136, v142
    v_add_f32 v137, v137, v143
    v_fmac_f32 v140, v142, v142
    v_fmac_f32 v141, v143, v143
    v_lshlrev_b32 v144, 16, v97
    v_and_b32 v145, s33, v97
    v_mfma_f32_32x32x16_bf16 v[64:79], v[104:107], v[96:99], v[64:79]
    v_add_f32 v136, v136, v144
    v_add_f32 v137, v137, v145
    v_fmac_f32 v140, v144, v144
    v_fmac_f32 v141, v145, v145
    v_lshlrev_b32 v142, 16, v98
    v_and_b32 v143, s33, v98
    v_add_f32 v136, v136, v142
    v_add_f32 v137, v137, v143
    v_mfma_f32_32x32x16_bf16 v[80:95], v[108:111], v[96:99], v[80:95]
    v_fmac_f32 v140, v142, v142
    v_fmac_f32 v141, v143, v143
    v_lshlrev_b32 v144, 16, v99
    v_and_b32 v145, s33, v99
    v_add_f32 v136, v136, v144
    v_add_f32 v137, v137, v145
    v_fmac_f32 v140, v144, v144
    v_fmac_f32 v141, v145, v145
    v_mfma_f32_32x32x16_bf16 v[48:63], v[116:119], v[112:115], v[48:63]
    s_add_u32 m0, s74, 1024
    s_add_u32 s75, s73, 7936
    buffer_load_dwordx4 v2, s[24:27], s75 offen  lds
    v_lshlrev_b32 v142, 16, v112
    v_and_b32 v143, s33, v112
    v_add_f32 v136, v136, v142
    v_add_f32 v137, v137, v143
    v_fmac_f32 v140, v142, v142
    v_fmac_f32 v141, v143, v143
    v_lshlrev_b32 v144, 16, v113
    v_and_b32 v145, s33, v113
    v_mfma_f32_32x32x16_bf16 v[64:79], v[120:123], v[112:115], v[64:79]
    v_add_f32 v136, v136, v144
    v_add_f32 v137, v137, v145
    v_fmac_f32 v140, v144, v144
    v_fmac_f32 v141, v145, v145
    v_lshlrev_b32 v142, 16, v114
    v_and_b32 v143, s33, v114
    v_add_f32 v136, v136, v142
    v_add_f32 v137, v137, v143
    v_mfma_f32_32x32x16_bf16 v[80:95], v[124:127], v[112:115], v[80:95]
    v_fmac_f32 v140, v142, v142
    v_fmac_f32 v141, v143, v143
    v_lshlrev_b32 v144, 16, v115
    v_and_b32 v145, s33, v115
    v_add_f32 v136, v136, v144
    v_add_f32 v137, v137, v145
    v_fmac_f32 v140, v144, v144
    v_fmac_f32 v141, v145, v145
    s_waitcnt lgkmcnt(7)
    ds_read_b128 v[96:99], v6 offset:16384
    ds_read_b64_tr_b16 v[100:101], v206 offset:12288
    ds_read_b64_tr_b16 v[102:103], v206 offset:13056
    ds_read_b64_tr_b16 v[104:105], v206 offset:12344
    ds_read_b64_tr_b16 v[106:107], v206 offset:13112
    ds_read_b64_tr_b16 v[108:109], v210 offset:12288
    ds_read_b64_tr_b16 v[110:111], v210 offset:13056
    v_mfma_f32_32x32x16_bf16 v[48:63], v[20:23], v[16:19], v[48:63]
    s_add_u32 m0, s74, 2048
    s_add_u32 s75, s73, 15104
    buffer_load_dwordx4 v1, s[24:27], s75 offen  lds
    v_lshlrev_b32 v142, 16, v16
    v_and_b32 v143, s33, v16
    v_add_f32 v136, v136, v142
    v_add_f32 v137, v137, v143
    v_fmac_f32 v140, v142, v142
    v_fmac_f32 v141, v143, v143
    v_lshlrev_b32 v144, 16, v17
    v_and_b32 v145, s33, v17
    v_mfma_f32_16x16x32_bf16 v[184:187], v[196:199], v[20:23], v[184:187]
    v_mfma_f32_32x32x16_bf16 v[64:79], v[24:27], v[16:19], v[64:79]
    v_add_f32 v136, v136, v144
    v_add_f32 v137, v137, v145
    v_fmac_f32 v140, v144, v144
    v_fmac_f32 v141, v145, v145
    v_lshlrev_b32 v142, 16, v18
    v_and_b32 v143, s33, v18
    v_add_f32 v136, v136, v142
    v_add_f32 v137, v137, v143
    v_mfma_f32_16x16x32_bf16 v[188:191], v[196:199], v[24:27], v[188:191]
    v_mfma_f32_32x32x16_bf16 v[80:95], v[28:31], v[16:19], v[80:95]
    v_fmac_f32 v140, v142, v142
    v_fmac_f32 v141, v143, v143
    v_lshlrev_b32 v144, 16, v19
    v_and_b32 v145, s33, v19
    v_add_f32 v136, v136, v144
    v_add_f32 v137, v137, v145
    v_fmac_f32 v140, v144, v144
    v_fmac_f32 v141, v145, v145
    v_mfma_f32_16x16x32_bf16 v[192:195], v[196:199], v[28:31], v[192:195]
    s_waitcnt lgkmcnt(7)
    ds_read_b128 v[112:115], v7 offset:16384
    ds_read_b64_tr_b16 v[116:117], v207 offset:12288
    ds_read_b64_tr_b16 v[118:119], v207 offset:13056
    ds_read_b64_tr_b16 v[120:121], v207 offset:12344
    ds_read_b64_tr_b16 v[122:123], v207 offset:13112
    ds_read_b64_tr_b16 v[124:125], v211 offset:12288
    ds_read_b64_tr_b16 v[126:127], v211 offset:13056
    v_mfma_f32_32x32x16_bf16 v[48:63], v[36:39], v[32:35], v[48:63]
    s_add_u32 m0, s74, 3072
    s_add_u32 s75, s73, 22272
    buffer_load_dwordx4 v2, s[24:27], s75 offen  lds
    v_lshlrev_b32 v142, 16, v32
    v_and_b32 v143, s33, v32
    v_add_f32 v136, v136, v142
    v_add_f32 v137, v137, v143
    v_fmac_f32 v140, v142, v142
    v_fmac_f32 v141, v143, v143
    v_lshlrev_b32 v144, 16, v33
    v_and_b32 v145, s33, v33
    v_mfma_f32_32x32x16_bf16 v[64:79], v[40:43], v[32:35], v[64:79]
    v_add_f32 v136, v136, v144
    v_add_f32 v137, v137, v145
    v_fmac_f32 v140, v144, v144
    v_fmac_f32 v141, v145, v145
    v_lshlrev_b32 v142, 16, v34
    v_and_b32 v143, s33, v34
    v_add_f32 v136, v136, v142
    v_add_f32 v137, v137, v143
    v_mfma_f32_32x32x16_bf16 v[80:95], v[44:47], v[32:35], v[80:95]
    v_fmac_f32 v140, v142, v142
    v_fmac_f32 v141, v143, v143
    v_lshlrev_b32 v144, 16, v35
    v_and_b32 v145, s33, v35
    v_add_f32 v136, v136, v144
    v_add_f32 v137, v137, v145
    v_fmac_f32 v140, v144, v144
    v_fmac_f32 v141, v145, v145
    s_waitcnt vmcnt(4) lgkmcnt(0)
    s_barrier
    ds_read_b128 v[16:19], v4 offset:32768
    ds_read_b64_tr_b16 v[20:21], v204 offset:24576
    ds_read_b64_tr_b16 v[22:23], v204 offset:25344
    ds_read_b64_tr_b16 v[24:25], v204 offset:24632
    ds_read_b64_tr_b16 v[26:27], v204 offset:25400
    ds_read_b64_tr_b16 v[28:29], v208 offset:24576
    ds_read_b64_tr_b16 v[30:31], v208 offset:25344
    ds_read_b128 v[32:35], v5 offset:32768
    ds_read_b64_tr_b16 v[36:37], v205 offset:24576
    ds_read_b64_tr_b16 v[38:39], v205 offset:25344
    ds_read_b64_tr_b16 v[40:41], v205 offset:24632
    ds_read_b64_tr_b16 v[42:43], v205 offset:25400
    ds_read_b64_tr_b16 v[44:45], v209 offset:24576
    ds_read_b64_tr_b16 v[46:47], v209 offset:25344
    v_mfma_f32_32x32x16_bf16 v[48:63], v[100:103], v[96:99], v[48:63]
    buffer_store_dwordx4 v[152:155], v3, s[52:55], s35 offen sc1
    v_lshlrev_b32 v142, 16, v96
    v_and_b32 v143, s33, v96
    v_add_f32 v136, v136, v142
    v_add_f32 v137, v137, v143
    v_fmac_f32 v140, v142, v142
    v_fmac_f32 v141, v143, v143
    v_lshlrev_b32 v144, 16, v97
    v_and_b32 v145, s33, v97
    v_mfma_f32_32x32x16_bf16 v[64:79], v[104:107], v[96:99], v[64:79]
    v_add_f32 v136, v136, v144
    v_add_f32 v137, v137, v145
    v_fmac_f32 v140, v144, v144
    v_fmac_f32 v141, v145, v145
    v_lshlrev_b32 v142, 16, v98
    v_and_b32 v143, s33, v98
    v_add_f32 v136, v136, v142
    v_add_f32 v137, v137, v143
    v_mfma_f32_32x32x16_bf16 v[80:95], v[108:111], v[96:99], v[80:95]
    v_fmac_f32 v140, v142, v142
    v_fmac_f32 v141, v143, v143
    v_lshlrev_b32 v144, 16, v99
    v_and_b32 v145, s33, v99
    v_add_f32 v136, v136, v144
    v_add_f32 v137, v137, v145
    v_fmac_f32 v140, v144, v144
    v_fmac_f32 v141, v145, v145
    v_mfma_f32_32x32x16_bf16 v[48:63], v[116:119], v[112:115], v[48:63]
    buffer_store_dwordx4 v[152:155], v3, s[52:55], s35 offen offset:1024 sc1
    v_lshlrev_b32 v142, 16, v112
    v_and_b32 v143, s33, v112
    v_add_f32 v136, v136, v142
    v_add_f32 v137, v137, v143
    v_fmac_f32 v140, v142, v142
    v_fmac_f32 v141, v143, v143
    v_lshlrev_b32 v144, 16, v113
    v_and_b32 v145, s33, v113
    v_mfma_f32_32x32x16_bf16 v[64:79], v[120:123], v[112:115], v[64:79]
    v_add_f32 v136, v136, v144
    v_add_f32 v137, v137, v145
    v_fmac_f32 v140, v144, v144
    v_fmac_f32 v141, v145, v145
    v_lshlrev_b32 v142, 16, v114
    v_and_b32 v143, s33, v114
    v_add_f32 v136, v136, v142
    v_add_f32 v137, v137, v143
    v_mfma_f32_32x32x16_bf16 v[80:95], v[124:127], v[112:115], v[80:95]
    v_fmac_f32 v140, v142, v142
    v_fmac_f32 v141, v143, v143
    v_lshlrev_b32 v144, 16, v115
    v_and_b32 v145, s33, v115
    v_add_f32 v136, v136, v144
    v_add_f32 v137, v137, v145
    v_fmac_f32 v140, v144, v144
    v_fmac_f32 v141, v145, v145
    s_waitcnt lgkmcnt(7)
    ds_read_b128 v[96:99], v6 offset:32768
    ds_read_b64_tr_b16 v[100:101], v206 offset:24576
    ds_read_b64_tr_b16 v[102:103], v206 offset:25344
    ds_read_b64_tr_b16 v[104:105], v206 offset:24632
    ds_read_b64_tr_b16 v[106:107], v206 offset:25400
    ds_read_b64_tr_b16 v[108:109], v210 offset:24576
    ds_read_b64_tr_b16 v[110:111], v210 offset:25344
    v_mfma_f32_32x32x16_bf16 v[48:63], v[20:23], v[16:19], v[48:63]
    v_lshlrev_b32 v142, 16, v16
    v_and_b32 v143, s33, v16
    v_add_f32 v136, v136, v142
    v_add_f32 v137, v137, v143
    v_fmac_f32 v140, v142, v142
    v_fmac_f32 v141, v143, v143
    v_lshlrev_b32 v144, 16, v17
    v_and_b32 v145, s33, v17
    v_mfma_f32_16x16x32_bf16 v[184:187], v[196:199], v[20:23], v[184:187]
    v_mfma_f32_32x32x16_bf16 v[64:79], v[24:27], v[16:19], v[64:79]
    v_add_f32 v136, v136, v144
    v_add_f32 v137, v137, v145
    v_fmac_f32 v140, v144, v144
    v_fmac_f32 v141, v145, v145
    v_lshlrev_b32 v142, 16, v18
    v_and_b32 v143, s33, v18
    v_add_f32 v136, v136, v142
    v_add_f32 v137, v137, v143
    v_mfma_f32_16x16x32_bf16 v[188:191], v[196:199], v[24:27], v[188:191]
    v_mfma_f32_32x32x16_bf16 v[80:95], v[28:31], v[16:19], v[80:95]
    v_fmac_f32 v140, v142, v142
    v_fmac_f32 v141, v143, v143
    v_lshlrev_b32 v144, 16, v19
    v_and_b32 v145, s33, v19
    v_add_f32 v136, v136, v144
    v_add_f32 v137, v137, v145
    v_fmac_f32 v140, v144, v144
    v_fmac_f32 v141, v145, v145
    v_mfma_f32_16x16x32_bf16 v[192:195], v[196:199], v[28:31], v[192:195]
    s_waitcnt lgkmcnt(7)
    ds_read_b128 v[112:115], v7 offset:32768
    ds_read_b64_tr_b16 v[116:117], v207 offset:24576
    ds_read_b64_tr_b16 v[118:119], v207 offset:25344
    ds_read_b64_tr_b16 v[120:121], v207 offset:24632
    ds_read_b64_tr_b16 v[122:123], v207 offset:25400
    ds_read_b64_tr_b16 v[124:125], v211 offset:24576
    ds_read_b64_tr_b16 v[126:127], v211 offset:25344
    v_mfma_f32_32x32x16_bf16 v[48:63], v[36:39], v[32:35], v[48:63]
    v_lshlrev_b32 v142, 16, v32
    v_and_b32 v143, s33, v32
    v_add_f32 v136, v136, v142
    v_add_f32 v137, v137, v143
    v_fmac_f32 v140, v142, v142
    v_fmac_f32 v141, v143, v143
    v_lshlrev_b32 v144, 16, v33
    v_and_b32 v145, s33, v33
    v_mfma_f32_32x32x16_bf16 v[64:79], v[40:43], v[32:35], v[64:79]
    v_add_f32 v136, v136, v144
    v_add_f32 v137, v137, v145
    v_fmac_f32 v140, v144, v144
    v_fmac_f32 v141, v145, v145
    v_lshlrev_b32 v142, 16, v34
    v_and_b32 v143, s33, v34
    v_add_f32 v136, v136, v142
    v_add_f32 v137, v137, v143
    v_mfma_f32_32x32x16_bf16 v[80:95], v[44:47], v[32:35], v[80:95]
    v_fmac_f32 v140, v142, v142
    v_fmac_f32 v141, v143, v143
    v_lshlrev_b32 v144, 16, v35
    v_and_b32 v145, s33, v35
    v_add_f32 v136, v136, v144
    v_add_f32 v137, v137, v145
    v_fmac_f32 v140, v144, v144
    v_fmac_f32 v141, v145, v145
    s_waitcnt vmcnt(2) lgkmcnt(0)
    s_barrier
    ds_read_b128 v[16:19], v4 offset:0
    ds_read_b64_tr_b16 v[20:21], v204 offset:0
    ds_read_b64_tr_b16 v[22:23], v204 offset:768
    ds_read_b64_tr_b16 v[24:25], v204 offset:56
    ds_read_b64_tr_b16 v[26:27], v204 offset:824
    ds_read_b64_tr_b16 v[28:29], v208 offset:0
    ds_read_b64_tr_b16 v[30:31], v208 offset:768
    ds_read_b128 v[32:35], v5 offset:0
    ds_read_b64_tr_b16 v[36:37], v205 offset:0
    ds_read_b64_tr_b16 v[38:39], v205 offset:768
    ds_read_b64_tr_b16 v[40:41], v205 offset:56
    ds_read_b64_tr_b16 v[42:43], v205 offset:824
    ds_read_b64_tr_b16 v[44:45], v209 offset:0
    ds_read_b64_tr_b16 v[46:47], v209 offset:768
    v_mfma_f32_32x32x16_bf16 v[48:63], v[100:103], v[96:99], v[48:63]
    v_lshlrev_b32 v142, 16, v96
    v_and_b32 v143, s33, v96
    v_add_f32 v136, v136, v142
    v_add_f32 v137, v137, v143
    v_fmac_f32 v140, v142, v142
    v_fmac_f32 v141, v143, v143
    v_lshlrev_b32 v144, 16, v97
    v_and_b32 v145, s33, v97
    v_mfma_f32_32x32x16_bf16 v[64:79], v[104:107], v[96:99], v[64:79]
    v_add_f32 v136, v136, v144
    v_add_f32 v137, v137, v145
    v_fmac_f32 v140, v144, v144
    v_fmac_f32 v141, v145, v145
    v_lshlrev_b32 v142, 16, v98
    v_and_b32 v143, s33, v98
    v_add_f32 v136, v136, v142
    v_add_f32 v137, v137, v143
    v_mfma_f32_32x32x16_bf16 v[80:95], v[108:111], v[96:99], v[80:95]
    v_fmac_f32 v140, v142, v142
    v_fmac_f32 v141, v143, v143
    v_lshlrev_b32 v144, 16, v99
    v_and_b32 v145, s33, v99
    v_add_f32 v136, v136, v144
    v_add_f32 v137, v137, v145
    v_fmac_f32 v140, v144, v144
    v_fmac_f32 v141, v145, v145
    v_mfma_f32_32x32x16_bf16 v[48:63], v[116:119], v[112:115], v[48:63]
    v_lshlrev_b32 v142, 16, v112
    v_and_b32 v143, s33, v112
    v_add_f32 v136, v136, v142
    v_add_f32 v137, v137, v143
    v_fmac_f32 v140, v142, v142
    v_fmac_f32 v141, v143, v143
    v_lshlrev_b32 v144, 16, v113
    v_and_b32 v145, s33, v113
    v_mfma_f32_32x32x16_bf16 v[64:79], v[120:123], v[112:115], v[64:79]
    v_add_f32 v136, v136, v144
    v_add_f32 v137, v137, v145
    v_fmac_f32 v140, v144, v144
    v_fmac_f32 v141, v145, v145
    v_lshlrev_b32 v142, 16, v114
    v_and_b32 v143, s33, v114
    v_add_f32 v136, v136, v142
    v_add_f32 v137, v137, v143
    v_mfma_f32_32x32x16_bf16 v[80:95], v[124:127], v[112:115], v[80:95]
    v_fmac_f32 v140, v142, v142
    v_fmac_f32 v141, v143, v143
    v_lshlrev_b32 v144, 16, v115
    v_and_b32 v145, s33, v115
    v_add_f32 v136, v136, v144
    v_add_f32 v137, v137, v145
    v_fmac_f32 v140, v144, v144
    v_fmac_f32 v141, v145, v145
    s_waitcnt lgkmcnt(7)
    ds_read_b128 v[96:99], v6 offset:0
    ds_read_b64_tr_b16 v[100:101], v206 offset:0
    ds_read_b64_tr_b16 v[102:103], v206 offset:768
    ds_read_b64_tr_b16 v[104:105], v206 offset:56
    ds_read_b64_tr_b16 v[106:107], v206 offset:824
    ds_read_b64_tr_b16 v[108:109], v210 offset:0
    ds_read_b64_tr_b16 v[110:111], v210 offset:768
    v_mfma_f32_32x32x16_bf16 v[48:63], v[20:23], v[16:19], v[48:63]
    v_lshlrev_b32 v142, 16, v16
    v_and_b32 v143, s33, v16
    v_add_f32 v136, v136, v142
    v_add_f32 v137, v137, v143
    v_fmac_f32 v140, v142, v142
    v_fmac_f32 v141, v143, v143
    v_lshlrev_b32 v144, 16, v17
    v_and_b32 v145, s33, v17
    v_mfma_f32_16x16x32_bf16 v[184:187], v[196:199], v[20:23], v[184:187]
    v_mfma_f32_32x32x16_bf16 v[64:79], v[24:27], v[16:19], v[64:79]
    v_add_f32 v136, v136, v144
    v_add_f32 v137, v137, v145
    v_fmac_f32 v140, v144, v144
    v_fmac_f32 v141, v145, v145
    v_lshlrev_b32 v142, 16, v18
    v_and_b32 v143, s33, v18
    v_add_f32 v136, v136, v142
    v_add_f32 v137, v137, v143
    v_mfma_f32_16x16x32_bf16 v[188:191], v[196:199], v[24:27], v[188:191]
    v_mfma_f32_32x32x16_bf16 v[80:95], v[28:31], v[16:19], v[80:95]
    v_fmac_f32 v140, v142, v142
    v_fmac_f32 v141, v143, v143
    v_lshlrev_b32 v144, 16, v19
    v_and_b32 v145, s33, v19
    v_add_f32 v136, v136, v144
    v_add_f32 v137, v137, v145
    v_fmac_f32 v140, v144, v144
    v_fmac_f32 v141, v145, v145
    v_mfma_f32_16x16x32_bf16 v[192:195], v[196:199], v[28:31], v[192:195]
    s_waitcnt lgkmcnt(7)
    ds_read_b128 v[112:115], v7 offset:0
    ds_read_b64_tr_b16 v[116:117], v207 offset:0
    ds_read_b64_tr_b16 v[118:119], v207 offset:768
    ds_read_b64_tr_b16 v[120:121], v207 offset:56
    ds_read_b64_tr_b16 v[122:123], v207 offset:824
    ds_read_b64_tr_b16 v[124:125], v211 offset:0
    ds_read_b64_tr_b16 v[126:127], v211 offset:768
    v_mfma_f32_32x32x16_bf16 v[48:63], v[36:39], v[32:35], v[48:63]
    v_lshlrev_b32 v142, 16, v32
    v_and_b32 v143, s33, v32
    v_add_f32 v136, v136, v142
    v_add_f32 v137, v137, v143
    v_fmac_f32 v140, v142, v142
    v_fmac_f32 v141, v143, v143
    v_lshlrev_b32 v144, 16, v33
    v_and_b32 v145, s33, v33
    v_mfma_f32_32x32x16_bf16 v[64:79], v[40:43], v[32:35], v[64:79]
    v_add_f32 v136, v136, v144
    v_add_f32 v137, v137, v145
    v_fmac_f32 v140, v144, v144
    v_fmac_f32 v141, v145, v145
    v_lshlrev_b32 v142, 16, v34
    v_and_b32 v143, s33, v34
    v_add_f32 v136, v136, v142
    v_add_f32 v137, v137, v143
    v_mfma_f32_32x32x16_bf16 v[80:95], v[44:47], v[32:35], v[80:95]
    v_fmac_f32 v140, v142, v142
    v_fmac_f32 v141, v143, v143
    v_lshlrev_b32 v144, 16, v35
    v_and_b32 v145, s33, v35
    v_add_f32 v136, v136, v144
    v_add_f32 v137, v137, v145
    v_fmac_f32 v140, v144, v144
    v_fmac_f32 v141, v145, v145
    s_waitcnt lgkmcnt(7)
    v_mfma_f32_32x32x16_bf16 v[48:63], v[100:103], v[96:99], v[48:63]
    v_lshlrev_b32 v142, 16, v96
    v_and_b32 v143, s33, v96
    v_add_f32 v136, v136, v142
    v_add_f32 v137, v137, v143
    v_fmac_f32 v140, v142, v142
    v_fmac_f32 v141, v143, v143
    v_lshlrev_b32 v144, 16, v97
    v_and_b32 v145, s33, v97
    v_mfma_f32_32x32x16_bf16 v[64:79], v[104:107], v[96:99], v[64:79]
    v_add_f32 v136, v136, v144
    v_add_f32 v137, v137, v145
    v_fmac_f32 v140, v144, v144
    v_fmac_f32 v141, v145, v145
    v_lshlrev_b32 v142, 16, v98
    v_and_b32 v143, s33, v98
    v_add_f32 v136, v136, v142
    v_add_f32 v137, v137, v143
    v_mfma_f32_32x32x16_bf16 v[80:95], v[108:111], v[96:99], v[80:95]
    v_fmac_f32 v140, v142, v142
    v_fmac_f32 v141, v143, v143
    v_lshlrev_b32 v144, 16, v99
    v_and_b32 v145, s33, v99
    v_add_f32 v136, v136, v144
    v_add_f32 v137, v137, v145
    v_fmac_f32 v140, v144, v144
    v_fmac_f32 v141, v145, v145
    s_setprio 3
    s_waitcnt lgkmcnt(0)
    v_lshlrev_b32 v142, 16, v112
    v_and_b32 v143, s33, v112
    v_add_f32 v136, v136, v142
    v_add_f32 v137, v137, v143
    v_fmac_f32 v140, v142, v142
    v_fmac_f32 v141, v143, v143
    v_lshlrev_b32 v144, 16, v113
    v_and_b32 v145, s33, v113
    v_add_f32 v136, v136, v144
    v_add_f32 v137, v137, v145
    v_fmac_f32 v140, v144, v144
    v_fmac_f32 v141, v145, v145
    v_lshlrev_b32 v142, 16, v114
    v_and_b32 v143, s33, v114
    v_add_f32 v136, v136, v142
    v_add_f32 v137, v137, v143
    v_fmac_f32 v140, v142, v142
    v_fmac_f32 v141, v143, v143
    v_lshlrev_b32 v144, 16, v115
    v_and_b32 v145, s33, v115
    v_add_f32 v136, v136, v144
    v_add_f32 v137, v137, v145
    v_fmac_f32 v140, v144, v144
    v_fmac_f32 v141, v145, v145
    v_mfma_f32_32x32x16_bf16 v[48:63], v[116:119], v[112:115], v[48:63]
    v_add_f32 v14, v136, v137
    v_add_f32 v15, v140, v141
    v_mov_b32 v136, v14
    v_mov_b32 v140, v15
    v_mfma_f32_32x32x16_bf16 v[64:79], v[120:123], v[112:115], v[64:79]
    v_cmp_ne_u32 vcc, 0, v11
    v_permlane32_swap_b32 v14, v136
    v_permlane32_swap_b32 v15, v140
    v_add_f32 v14, v14, v136
    v_add_f32 v15, v15, v140
    v_mfma_f32_32x32x16_bf16 v[80:95], v[124:127], v[112:115], v[80:95]
    s_mov_b64 exec, 0xffff
    ds_write_b32 v200, v184 offset:0
    ds_write_b32 v200, v185 offset:256
    ds_write_b32 v200, v188 offset:512
    ds_write_b32 v200, v189 offset:768
    ds_write_b32 v200, v192 offset:1024
    ds_write_b32 v200, v193 offset:1280
    s_mov_b64 exec, -1
    v_mul_f32 v14, 0x3b124925, v14
    v_mul_f32 v15, 0x3b124925, v15
    v_fma_f32 v15, -v14, v14, v15
    v_max_f32 v15, 0, v15
    v_add_f32 v15, 0x3727c5ac, v15
    v_rsq_f32 v15, v15
    v_mov_b32 v1, 161152
    v_mov_b32 v2, 1
    v_cndmask_b32 v136, v14, v15, vcc
    ds_write_b32 v177, v136
    s_waitcnt lgkmcnt(0)
    s_barrier
    ds_read_b128 v[128:131], v176 offset:0
    ds_read_b128 v[132:135], v176 offset:512
    ds_read_b128 v[136:139], v176 offset:1024
    v_cvt_pk_bf16_f32 v99, v14, v14
    v_lshlrev_b32 v99, 16, v99
    v_sub_f32 v100, v14, v99
    v_cndmask_b32 v99, v99, v100, vcc
    v_cvt_pk_bf16_f32 v160, -v99, -v99
    s_waitcnt lgkmcnt(2)
    v_add_f32 v128, v128, v129
    v_add_f32 v130, v130, v131
    v_add_f32 v96, v128, v130
    v_cvt_pk_bf16_f32 v100, v96, v96
    v_lshlrev_b32 v100, 16, v100
    v_sub_f32 v100, v96, v100
    v_cvt_pk_bf16_f32 v164, v96, v100
    s_waitcnt lgkmcnt(1)
    v_add_f32 v132, v132, v133
    v_add_f32 v134, v134, v135
    v_add_f32 v97, v132, v134
    v_cvt_pk_bf16_f32 v100, v97, v97
    v_lshlrev_b32 v100, 16, v100
    v_sub_f32 v100, v97, v100
    v_cvt_pk_bf16_f32 v168, v97, v100
    v_mfma_f32_32x32x16_bf16 v[48:63], v[164:167], v[160:163], v[48:63]
    s_waitcnt lgkmcnt(0)
    v_add_f32 v136, v136, v137
    v_add_f32 v138, v138, v139
    v_add_f32 v98, v136, v138
    v_cvt_pk_bf16_f32 v100, v98, v98
    v_lshlrev_b32 v100, 16, v100
    v_sub_f32 v100, v98, v100
    v_cvt_pk_bf16_f32 v172, v98, v100
    v_mfma_f32_32x32x16_bf16 v[64:79], v[168:171], v[160:163], v[64:79]
    v_mul_f32 v120, s43, v15
    v_mul_f32 v121, s44, v15
    v_mfma_f32_32x32x16_bf16 v[80:95], v[172:175], v[160:163], v[80:95]
    v_mul_f32 v122, s45, v15
    v_mul_f32 v48, v120, v48
    v_mul_f32 v49, v120, v49
    v_mul_f32 v50, v120, v50
    v_mul_f32 v51, v120, v51
    v_cvt_pk_bf16_f32 v96, v48, v49
    v_mul_f32 v52, v120, v52
    v_mul_f32 v53, v120, v53
    v_cvt_pk_bf16_f32 v97, v50, v51
    v_mul_f32 v54, v120, v54
    v_mul_f32 v55, v120, v55
    v_cvt_pk_bf16_f32 v98, v52, v53
    v_mul_f32 v56, v120, v56
    v_mul_f32 v57, v120, v57
    v_cvt_pk_bf16_f32 v99, v54, v55
    v_mul_f32 v58, v120, v58
    v_mul_f32 v59, v120, v59
    v_cvt_pk_bf16_f32 v100, v56, v57
    v_mul_f32 v60, v120, v60
    v_mul_f32 v61, v120, v61
    v_cvt_pk_bf16_f32 v101, v58, v59
    v_mul_f32 v62, v120, v62
    v_mul_f32 v63, v120, v63
    v_cvt_pk_bf16_f32 v102, v60, v61
    v_cvt_pk_bf16_f32 v103, v62, v63
    s_mov_b32 exec_lo, 0
    v_mov_b32 v102, s46
    v_mov_b32 v103, s47
    s_mov_b32 exec_lo, -1
    s_cmp_ge_u32 s82, 32
    s_cbranch_scc1 LV_6
    buffer_store_dwordx4 v[96:99], v3, s[52:55], s40 offen sc1
    buffer_store_dwordx4 v[100:103], v3, s[52:55], s40 offen offset:1024 sc1
    s_branch LE_7
LV_6:
    ds_write_b64 v178, v[96:97] offset:0
    ds_write_b64 v178, v[98:99] offset:16
    ds_write_b64 v178, v[100:101] offset:32
    ds_write_b64 v178, v[102:103] offset:48
    ds_read_b64_tr_b16 v[96:97], v179 offset:0
    ds_read_b64_tr_b16 v[98:99], v179 offset:576
    ds_read_b64_tr_b16 v[100:101], v179 offset:1152
    ds_read_b64_tr_b16 v[102:103], v179 offset:1728
LE_7:
    v_mul_f32 v64, v121, v64
    v_mul_f32 v65, v121, v65
    v_mul_f32 v66, v121, v66
    v_mul_f32 v67, v121, v67
    v_cvt_pk_bf16_f32 v104, v64, v65
    v_mul_f32 v68, v121, v68
    v_mul_f32 v69, v121, v69
    v_cvt_pk_bf16_f32 v105, v66, v67
    v_mul_f32 v70, v121, v70
    v_mul_f32 v71, v121, v71
    v_cvt_pk_bf16_f32 v106, v68, v69
    v_mul_f32 v72, v121, v72
    v_mul_f32 v73, v121, v73
    v_cvt_pk_bf16_f32 v107, v70, v71
    v_mul_f32 v74, v121, v74
    v_mul_f32 v75, v121, v75
    v_cvt_pk_bf16_f32 v108, v72, v73
    v_mul_f32 v76, v121, v76
    v_mul_f32 v77, v121, v77
    v_cvt_pk_bf16_f32 v109, v74, v75
    v_mul_f32 v78, v121, v78
    v_mul_f32 v79, v121, v79
    v_cvt_pk_bf16_f32 v110, v76, v77
    v_cvt_pk_bf16_f32 v111, v78, v79
    s_mov_b32 exec_lo, 0
    v_mov_b32 v110, s48
    v_mov_b32 v111, s49
    s_mov_b32 exec_lo, -1
    s_cmp_ge_u32 s82, 31
    s_cbranch_scc1 LV_8
    buffer_store_dwordx4 v[104:107], v3, s[52:55], s41 offen sc1
    buffer_store_dwordx4 v[108:111], v3, s[52:55], s41 offen offset:1024 sc1
    s_branch LE_9
LV_8:
    ds_write_b64 v178, v[104:105] offset:0
    ds_write_b64 v178, v[106:107] offset:16
    ds_write_b64 v178, v[108:109] offset:32
    ds_write_b64 v178, v[110:111] offset:48
    ds_read_b64_tr_b16 v[104:105], v179 offset:0
    ds_read_b64_tr_b16 v[106:107], v179 offset:576
    ds_read_b64_tr_b16 v[108:109], v179 offset:1152
    ds_read_b64_tr_b16 v[110:111], v179 offset:1728
    s_cmp_lt_u32 s82, 32
    s_cbranch_scc1 LP_10
    s_waitcnt lgkmcnt(8)
    buffer_store_dwordx4 v[96:99], v3, s[52:55], s40 offen sc1
    buffer_store_dwordx4 v[100:103], v3, s[52:55], s40 offen offset:1024 sc1
LP_10:
LE_9:
    v_mul_f32 v80, v122, v80
    v_mul_f32 v81, v122, v81
    v_mul_f32 v82, v122, v82
    v_mul_f32 v83, v122, v83
    v_cvt_pk_bf16_f32 v112, v80, v81
    v_mul_f32 v84, v122, v84
    v_mul_f32 v85, v122, v85
    v_cvt_pk_bf16_f32 v113, v82, v83
    v_mul_f32 v86, v122, v86
    v_mul_f32 v87, v122, v87
    v_cvt_pk_bf16_f32 v114, v84, v85
    v_mul_f32 v88, v122, v88
    v_mul_f32 v89, v122, v89
    v_cvt_pk_bf16_f32 v115, v86, v87
    v_mul_f32 v90, v122, v90
    v_mul_f32 v91, v122, v91
    v_cvt_pk_bf16_f32 v116, v88, v89
    v_mul_f32 v92, v122, v92
    v_mul_f32 v93, v122, v93
    v_cvt_pk_bf16_f32 v117, v90, v91
    v_mul_f32 v94, v122, v94
    v_mul_f32 v95, v122, v95
    v_cvt_pk_bf16_f32 v118, v92, v93
    v_cvt_pk_bf16_f32 v119, v94, v95
    s_mov_b32 exec_lo, 0
    v_mov_b32 v118, s50
    v_mov_b32 v119, s51
    s_mov_b32 exec_lo, -1
    s_cmp_ge_u32 s82, 30
    s_cbranch_scc1 LV_11
    buffer_store_dwordx4 v[112:115], v3, s[52:55], s42 offen sc1
    buffer_store_dwordx4 v[116:119], v3, s[52:55], s42 offen offset:1024 sc1
    s_branch LE_12
LV_11:
    ds_write_b64 v178, v[112:113] offset:0
    ds_write_b64 v178, v[114:115] offset:16
    ds_write_b64 v178, v[116:117] offset:32
    ds_write_b64 v178, v[118:119] offset:48
    ds_read_b64_tr_b16 v[112:113], v179 offset:0
    ds_read_b64_tr_b16 v[114:115], v179 offset:576
    ds_read_b64_tr_b16 v[116:117], v179 offset:1152
    ds_read_b64_tr_b16 v[118:119], v179 offset:1728
    s_cmp_lt_u32 s82, 31
    s_cbranch_scc1 LP_13
    s_waitcnt lgkmcnt(8)
    buffer_store_dwordx4 v[104:107], v3, s[52:55], s41 offen sc1
    buffer_store_dwordx4 v[108:111], v3, s[52:55], s41 offen offset:1024 sc1
LP_13:
    s_waitcnt lgkmcnt(0)
    buffer_store_dwordx4 v[112:115], v3, s[52:55], s42 offen sc1
    buffer_store_dwordx4 v[116:119], v3, s[52:55], s42 offen offset:1024 sc1
LE_12:
    s_mov_b32 s77, s82
    s_setprio 0
    v_readfirstlane_b32 s69, v212
    s_mul_i32 s69, s69, 0x9e3779b1
    s_add_u32 s69, s69, 0x7f4a7c15
    v_mov_b32 v8, 128
    buffer_load_dword v8, v8, s[52:55], 0 offen sc1
    s_add_u32 s72, s65, 16
    s_lshl_b32 s72, s72, 11
    s_add_u32 s72, s72, 262144
    s_lshl_b32 s73, s65, 4
    s_add_u32 s73, s73, s66
    s_lshl_b32 s73, s73, 7
    s_add_u32 s73, s73, 262144
    v_and_b32 v4, 15, v0
    v_lshlrev_b32 v4, 7, v4
    v_bfe_u32 v5, v0, 4, 1
    v_lshl_add_u32 v4, v5, 15, v4
    v_add_u32 v4, s72, v4
    s_mov_b32 exec_lo, 0
    v_mov_b32 v4, s73
    s_mov_b32 exec_lo, -1
    s_lshl_b32 s72, s77, 4
    s_add_u32 s72, s72, s62
    s_lshl_b32 s72, s72, 7
    s_add_u32 s72, s72, 262144
    v_lshl_add_u32 v10, v0, 11, s72
    v_add_u32 v5, s77, v0
    v_and_b32 v5, 15, v5
    v_lshlrev_b32 v5, 7, v5
    v_add_u32 v5, 256, v5
    v_mov_b32 v6, s69
    s_mov_b32 s21, 4
    s_lshl_b32 s72, s65, 6
    s_lshl_b32 s73, s66, 2
    s_add_u32 s73, s73, s72
    s_add_u32 s73, s73, s61
    s_lshl_b32 s73, s73, 11
    s_add_u32 s80, s73, 1048576
    s_xor_b32 s72, s61, 0
    s_lshl_b32 s72, s72, 11
    s_add_u32 s72, s72, 0
    v_add_u32 v12, s72, v3
    s_xor_b32 s72, s61, 1
    s_lshl_b32 s72, s72, 11
    s_add_u32 s72, s72, 0
    v_add_u32 v13, s72, v3
    s_xor_b32 s72, s61, 2
    s_lshl_b32 s72, s72, 11
    s_add_u32 s72, s72, 0
    v_add_u32 v14, s72, v3
    s_xor_b32 s72, s61, 3
    s_lshl_b32 s72, s72, 11
    s_add_u32 s72, s72, 0
    v_add_u32 v15, s72, v3
    s_lshl_b32 s76, s65, 18
    s_add_u32 s76, s76, 4194304
    s_lshl_b32 s77, s61, 16
    s_add_u32 s77, s77, s76
    s_waitcnt vmcnt(0)
    s_mov_b64 exec, 1
    ds_add_rtn_u32 v7, v1, v2 offset:0
    s_waitcnt lgkmcnt(0)
    v_readfirstlane_b32 s75, v7
    s_cmp_lg_u32 s75, 3
    s_cbranch_scc1 L_14
    s_setprio 3
    s_mov_b64 exec, 7
    buffer_store_dword v6, v10, s[52:55], 0 offen sc1
    s_mov_b64 exec, 1
    s_setprio 0
L_14:
    s_cmp_lg_u32 s75, 3
    s_cbranch_scc1 L_17
    v_readfirstlane_b32 s71, v8
    s_cmp_eq_u32 s71, s69
    s_cbranch_scc1 LI_18
    v_mov_b32 v8, 128
    s_mov_b32 s3, 32768
GP_19:
    buffer_load_dword v7, v8, s[52:55], 0 offen sc1
    s_waitcnt vmcnt(0)
    v_cmp_ne_u32 vcc, s69, v7
    s_cbranch_vccz GD_20
    s_sleep 2
    s_sub_u32 s3, s3, 1
    s_cmp_lg_u32 s3, 0
    s_cbranch_scc1 GP_19
GD_20:
LI_18:
    s_mov_b64 exec, 7
    v_mov_b32 v7, 1
    buffer_atomic_add v7, v5, s[52:55], 0 offen sc0 sc1
    s_waitcnt vmcnt(0)
    v_cmp_eq_u32 vcc, 47, v7
    v_add_u32 v5, 6144, v5
    s_and_b64 exec, exec, vcc
    s_cbranch_execz LI_21
    buffer_store_dword v6, v5, s[52:55], 0 offen sc1
LI_21:
    s_mov_b64 exec, 1
L_17:
    s_mov_b64 exec, -1
    s_sub_u32 s72, s75, 1
    s_cmp_ge_u32 s72, 2
    s_cbranch_scc1 L_22
    s_lshl_b32 s73, s2, 1
    s_add_u32 s73, s73, s72
    s_mov_b32 s38, s12
    s_mov_b32 s39, s13
    s_add_u32 s74, s73, 196
    s_sub_u32 s72, s73, -196
    s_cmp_ge_u32 s73, 0
    s_cselect_b32 s38, s14, s38
    s_cselect_b32 s39, s15, s39
    s_cselect_b32 s74, s72, s74
    s_sub_u32 s72, s73, 0
    s_cmp_ge_u32 s73, 0
    s_cselect_b32 s38, s16, s38
    s_cselect_b32 s39, s17, s39
    s_cselect_b32 s74, s72, s74
    s_sub_u32 s72, s73, 196
    s_cmp_ge_u32 s73, 196
    s_cselect_b32 s38, s8, s38
    s_cselect_b32 s39, s9, s39
    s_cselect_b32 s74, s72, s74
    s_cmp_ge_u32 s73, 245
    s_cbranch_scc1 L_22
    s_lshl_b32 s74, s74, 13
    v_lshlrev_b32 v8, 7, v0
    v_add_u32 v8, s74, v8
    global_load_dword v9, v8, s[38:39]
L_22:
    s_cmp_lg_u32 s75, 0
    s_cbranch_scc1 L_15
    s_mov_b32 s3, 32768
    s_mov_b32 exec_hi, 1
GP_23:
    buffer_load_dword v7, v4, s[52:55], 0 offen sc1
    s_waitcnt vmcnt(0)
    v_cmp_ne_u32 vcc, s69, v7
    s_and_b64 exec, exec, vcc
    s_cbranch_execz GD_24
    s_sleep 4
    s_sub_u32 s3, s3, 1
    s_cmp_lg_u32 s3, 0
    s_cbranch_scc1 GP_23
GD_24:
    s_mov_b64 exec, -1
    ds_write_b32 v1, v2 offset:4
    s_branch L_16
L_15:
    s_mov_b32 s3, 0x40000
LW_25:
    ds_read_b32 v7, v1 offset:4
    s_waitcnt lgkmcnt(0)
    v_readfirstlane_b32 s71, v7
    s_cmp_ge_u32 s71, 1
    s_cbranch_scc1 LD_26
    s_sleep 3
    s_sub_u32 s3, s3, 1
    s_cmp_lg_u32 s3, 0
    s_cbranch_scc1 LW_25
LD_26:
L_16:
    s_setprio 3
    buffer_load_dwordx4 v[224:227], v3, s[52:55], s76 offen sc1
    buffer_load_dwordx4 v[16:19], v3, s[52:55], s80 offen sc1
    buffer_load_dwordx4 v[228:231], v3, s[52:55], s76 offen offset:1024 sc1
    buffer_load_dwordx4 v[20:23], v3, s[52:55], s80 offen offset:1024 sc1
    buffer_load_dwordx4 v[160:163], v3, s[52:55], s77 offen offset:0 sc1
    buffer_load_dwordx4 v[164:167], v3, s[52:55], s77 offen offset:1024 sc1
    buffer_load_dwordx4 v[168:171], v3, s[52:55], s77 offen offset:2048 sc1
    buffer_load_dwordx4 v[172:175], v3, s[52:55], s77 offen offset:3072 sc1
    s_add_u32 s78, s77, 4096
    buffer_load_dwordx4 v[176:179], v3, s[52:55], s78 offen offset:0 sc1
    buffer_load_dwordx4 v[180:183], v3, s[52:55], s78 offen offset:1024 sc1
    buffer_load_dwordx4 v[184:187], v3, s[52:55], s78 offen offset:2048 sc1
    buffer_load_dwordx4 v[188:191], v3, s[52:55], s78 offen offset:3072 sc1
    s_add_u32 s78, s77, 8192
    buffer_load_dwordx4 v[192:195], v3, s[52:55], s78 offen offset:0 sc1
    buffer_load_dwordx4 v[196:199], v3, s[52:55], s78 offen offset:1024 sc1
    buffer_load_dwordx4 v[200:203], v3, s[52:55], s78 offen offset:2048 sc1
    buffer_load_dwordx4 v[204:207], v3, s[52:55], s78 offen offset:3072 sc1
    s_waitcnt vmcnt(14)
    v_mfma_f32_32x32x16_bf16 v[128:143], v[224:227], v[16:19], 0
    s_waitcnt vmcnt(12)
    v_mfma_f32_32x32x16_bf16 v[128:143], v[228:231], v[20:23], v[128:143]
    ds_write_b128 v12, v[16:19]
    s_nop 10
    v_max3_f32 v248, v128, v129, v130
    v_max3_f32 v249, v131, v132, v133
    v_max3_f32 v250, v134, v135, v136
    v_max3_f32 v251, v137, v138, v139
    v_max3_f32 v248, v248, v140, v141
    v_max3_f32 v249, v249, v142, v143
    v_max3_f32 v248, v248, v249, v250
    v_max_f32 v248, v248, v251
    v_mov_b32 v252, v248
    s_nop 1
    v_permlane32_swap_b32 v248, v252
    s_mov_b32 exec_lo, 0
    s_mov_b32 s72, 0xc2c80000
    v_max_f32 v248, v248, v252
    v_sub_f32 v248, s72, v248
    v_cvt_pk_bf16_f32 v252, v248, v248
    v_lshlrev_b32 v252, 16, v252
    v_sub_f32 v252, v248, v252
    v_cvt_pk_bf16_f32 v22, v248, v252
    v_and_b32 v248, 0xffff0000, v22
    v_sub_f32 v252, v252, v248
    v_cvt_pk_bf16_f32 v23, v252, 0
    s_mov_b32 exec_lo, -1
    ds_write_b128 v12, v[20:23] offset:1024
    s_mov_b64 exec, 1
    ds_add_u32 v1, v2 offset:24
    s_mov_b64 exec, -1
L_attn_start:
    s_waitcnt vmcnt(8)
    v_mfma_f32_32x32x16_bf16 v[112:127], v[160:163], v[16:19], 0
    v_mfma_f32_32x32x16_bf16 v[112:127], v[164:167], v[20:23], v[112:127]
    s_add_u32 s78, s77, 12288
    buffer_load_dwordx4 v[208:211], v3, s[52:55], s78 offen offset:0 sc1
    buffer_load_dwordx4 v[212:215], v3, s[52:55], s78 offen offset:1024 sc1
    buffer_load_dwordx4 v[216:219], v3, s[52:55], s78 offen offset:2048 sc1
    buffer_load_dwordx4 v[220:223], v3, s[52:55], s78 offen offset:3072 sc1
    s_setprio 1
    s_nop 5
    s_add_u32 s78, s78, 4096
.p2align 3
    s_waitcnt vmcnt(8)
    s_nop 0
    v_mfma_f32_32x32x16_bf16 v[128:143], v[176:179], v[16:19], 0
    buffer_load_dwordx4 v[224:227], v3, s[52:55], s78 offen offset:0 sc1
    v_exp_f32 v112, v112
    v_exp_f32 v113, v113
    v_exp_f32 v114, v114
    v_exp_f32 v115, v115
    buffer_load_dwordx4 v[228:231], v3, s[52:55], s78 offen offset:1024 sc1
    v_exp_f32 v116, v116
    v_exp_f32 v117, v117
    v_exp_f32 v118, v118
    v_exp_f32 v119, v119
    v_cvt_pk_bf16_f32 v144, v112, v113
    v_cvt_pk_bf16_f32 v145, v114, v115
    v_mfma_f32_32x32x16_bf16 v[128:143], v[180:183], v[20:23], v[128:143]
    buffer_load_dwordx4 v[232:235], v3, s[52:55], s78 offen offset:2048 sc1
    v_exp_f32 v120, v120
    v_exp_f32 v121, v121
    v_exp_f32 v122, v122
    v_exp_f32 v123, v123
    v_cvt_pk_bf16_f32 v146, v116, v117
    v_cvt_pk_bf16_f32 v147, v118, v119
    buffer_load_dwordx4 v[236:239], v3, s[52:55], s78 offen offset:3072 sc1
    s_add_u32 s78, s78, 4096
    ds_read_b32 v7, v1 offset:24
    v_exp_f32 v124, v124
    v_exp_f32 v125, v125
    v_exp_f32 v126, v126
    v_exp_f32 v127, v127
    v_cvt_pk_bf16_f32 v148, v120, v121
    v_cvt_pk_bf16_f32 v149, v122, v123
    v_cvt_pk_bf16_f32 v150, v124, v125
    v_cvt_pk_bf16_f32 v151, v126, v127
    s_waitcnt vmcnt(8)
    s_nop 0
    v_mfma_f32_32x32x16_bf16 v[112:127], v[192:195], v[16:19], 0
    buffer_load_dwordx4 v[240:243], v3, s[52:55], s78 offen offset:0 sc1
    v_exp_f32 v128, v128
    v_exp_f32 v129, v129
    v_exp_f32 v130, v130
    v_exp_f32 v131, v131
    v_mfma_f32_32x32x16_bf16 v[48:63], v[168:171], v[144:147], 0
    buffer_load_dwordx4 v[244:247], v3, s[52:55], s78 offen offset:1024 sc1
    s_waitcnt lgkmcnt(0)
    v_readfirstlane_b32 s71, v7
    s_cmp_ge_u32 s71, 4
    s_cbranch_scc1 LD_27
    s_mov_b32 s3, 0x40000
LW_28:
    ds_read_b32 v7, v1 offset:24
    s_waitcnt lgkmcnt(0)
    v_readfirstlane_b32 s71, v7
    s_cmp_ge_u32 s71, 4
    s_cbranch_scc1 LD_29
    s_sub_u32 s3, s3, 1
    s_cmp_lg_u32 s3, 0
    s_cbranch_scc1 LW_28
LD_29:
LD_27:
    s_cmp_lg_u32 s21, 4
    s_cbranch_scc1 LD_30
    ds_read_b128 v[24:27], v13
    ds_read_b128 v[28:31], v13 offset:1024
    ds_read_b128 v[32:35], v14
    ds_read_b128 v[36:39], v14 offset:1024
    ds_read_b128 v[40:43], v15
    ds_read_b128 v[44:47], v15 offset:1024
LD_30:
    v_exp_f32 v132, v132
    v_exp_f32 v133, v133
    v_exp_f32 v134, v134
    v_exp_f32 v135, v135
    v_cvt_pk_bf16_f32 v152, v128, v129
    v_cvt_pk_bf16_f32 v153, v130, v131
    v_mfma_f32_32x32x16_bf16 v[112:127], v[196:199], v[20:23], v[112:127]
    buffer_load_dwordx4 v[248:251], v3, s[52:55], s78 offen offset:2048 sc1
    v_exp_f32 v136, v136
    v_exp_f32 v137, v137
    v_exp_f32 v138, v138
    v_exp_f32 v139, v139
    v_cvt_pk_bf16_f32 v154, v132, v133
    v_cvt_pk_bf16_f32 v155, v134, v135
    v_mfma_f32_32x32x16_bf16 v[48:63], v[172:175], v[148:151], v[48:63]
    buffer_load_dwordx4 v[252:255], v3, s[52:55], s78 offen offset:3072 sc1
    s_add_u32 s78, s78, 4096
    v_exp_f32 v140, v140
    v_exp_f32 v141, v141
    v_exp_f32 v142, v142
    v_exp_f32 v143, v143
    v_cvt_pk_bf16_f32 v156, v136, v137
    v_cvt_pk_bf16_f32 v157, v138, v139
    v_cvt_pk_bf16_f32 v158, v140, v141
    v_cvt_pk_bf16_f32 v159, v142, v143
    s_waitcnt lgkmcnt(0)
    s_nop 0
    v_mfma_f32_32x32x16_bf16 v[128:143], v[160:163], v[24:27], 0
    v_exp_f32 v112, v112
    v_exp_f32 v113, v113
    v_exp_f32 v114, v114
    v_exp_f32 v115, v115
    v_mfma_f32_32x32x16_bf16 v[48:63], v[184:187], v[152:155], v[48:63]
    v_exp_f32 v116, v116
    v_exp_f32 v117, v117
    v_exp_f32 v118, v118
    v_exp_f32 v119, v119
    v_cvt_pk_bf16_f32 v144, v112, v113
    v_cvt_pk_bf16_f32 v145, v114, v115
    v_mfma_f32_32x32x16_bf16 v[128:143], v[164:167], v[28:31], v[128:143]
    v_exp_f32 v120, v120
    v_exp_f32 v121, v121
    v_exp_f32 v122, v122
    v_exp_f32 v123, v123
    v_cvt_pk_bf16_f32 v146, v116, v117
    v_cvt_pk_bf16_f32 v147, v118, v119
    v_mfma_f32_32x32x16_bf16 v[48:63], v[188:191], v[156:159], v[48:63]
    v_exp_f32 v124, v124
    v_exp_f32 v125, v125
    v_exp_f32 v126, v126
    v_exp_f32 v127, v127
    v_cvt_pk_bf16_f32 v148, v120, v121
    v_cvt_pk_bf16_f32 v149, v122, v123
    v_cvt_pk_bf16_f32 v150, v124, v125
    v_cvt_pk_bf16_f32 v151, v126, v127
    v_mfma_f32_32x32x16_bf16 v[112:127], v[160:163], v[32:35], 0
    v_exp_f32 v128, v128
    v_exp_f32 v129, v129
    v_exp_f32 v130, v130
    v_exp_f32 v131, v131
    v_mfma_f32_32x32x16_bf16 v[48:63], v[200:203], v[144:147], v[48:63]
    v_exp_f32 v132, v132
    v_exp_f32 v133, v133
    v_exp_f32 v134, v134
    v_exp_f32 v135, v135
    v_cvt_pk_bf16_f32 v152, v128, v129
    v_cvt_pk_bf16_f32 v153, v130, v131
    v_mfma_f32_32x32x16_bf16 v[112:127], v[164:167], v[36:39], v[112:127]
    v_exp_f32 v136, v136
    v_exp_f32 v137, v137
    v_exp_f32 v138, v138
    v_exp_f32 v139, v139
    v_cvt_pk_bf16_f32 v154, v132, v133
    v_cvt_pk_bf16_f32 v155, v134, v135
    v_mfma_f32_32x32x16_bf16 v[48:63], v[204:207], v[148:151], v[48:63]
    v_exp_f32 v140, v140
    v_exp_f32 v141, v141
    v_exp_f32 v142, v142
    v_exp_f32 v143, v143
    v_cvt_pk_bf16_f32 v156, v136, v137
    v_cvt_pk_bf16_f32 v157, v138, v139
    v_cvt_pk_bf16_f32 v158, v140, v141
    v_cvt_pk_bf16_f32 v159, v142, v143
    v_mfma_f32_32x32x16_bf16 v[128:143], v[160:163], v[40:43], 0
    v_exp_f32 v112, v112
    v_exp_f32 v113, v113
    v_exp_f32 v114, v114
    v_exp_f32 v115, v115
    v_mfma_f32_32x32x16_bf16 v[64:79], v[168:171], v[152:155], 0
    v_exp_f32 v116, v116
    v_exp_f32 v117, v117
    v_exp_f32 v118, v118
    v_exp_f32 v119, v119
    v_cvt_pk_bf16_f32 v144, v112, v113
    v_cvt_pk_bf16_f32 v145, v114, v115
    v_mfma_f32_32x32x16_bf16 v[128:143], v[164:167], v[44:47], v[128:143]
    v_exp_f32 v120, v120
    v_exp_f32 v121, v121
    v_exp_f32 v122, v122
    v_exp_f32 v123, v123
    v_cvt_pk_bf16_f32 v146, v116, v117
    v_cvt_pk_bf16_f32 v147, v118, v119
    v_mfma_f32_32x32x16_bf16 v[64:79], v[172:175], v[156:159], v[64:79]
    v_exp_f32 v124, v124
    v_exp_f32 v125, v125
    v_exp_f32 v126, v126
    v_exp_f32 v127, v127
    v_cvt_pk_bf16_f32 v148, v120, v121
    v_cvt_pk_bf16_f32 v149, v122, v123
    v_cvt_pk_bf16_f32 v150, v124, v125
    v_cvt_pk_bf16_f32 v151, v126, v127
    v_mfma_f32_32x32x16_bf16 v[112:127], v[176:179], v[24:27], 0
    v_exp_f32 v128, v128
    v_exp_f32 v129, v129
    v_exp_f32 v130, v130
    v_exp_f32 v131, v131
    v_mfma_f32_32x32x16_bf16 v[80:95], v[168:171], v[144:147], 0
    v_exp_f32 v132, v132
    v_exp_f32 v133, v133
    v_exp_f32 v134, v134
    v_exp_f32 v135, v135
    v_cvt_pk_bf16_f32 v152, v128, v129
    v_cvt_pk_bf16_f32 v153, v130, v131
    v_mfma_f32_32x32x16_bf16 v[112:127], v[180:183], v[28:31], v[112:127]
    v_exp_f32 v136, v136
    v_exp_f32 v137, v137
    v_exp_f32 v138, v138
    v_exp_f32 v139, v139
    v_cvt_pk_bf16_f32 v154, v132, v133
    v_cvt_pk_bf16_f32 v155, v134, v135
    v_mfma_f32_32x32x16_bf16 v[80:95], v[172:175], v[148:151], v[80:95]
    v_exp_f32 v140, v140
    v_exp_f32 v141, v141
    v_exp_f32 v142, v142
    v_exp_f32 v143, v143
    v_cvt_pk_bf16_f32 v156, v136, v137
    v_cvt_pk_bf16_f32 v157, v138, v139
    v_cvt_pk_bf16_f32 v158, v140, v141
    v_cvt_pk_bf16_f32 v159, v142, v143
    v_mfma_f32_32x32x16_bf16 v[128:143], v[176:179], v[32:35], 0
    v_exp_f32 v112, v112
    v_exp_f32 v113, v113
    v_exp_f32 v114, v114
    v_exp_f32 v115, v115
    v_mfma_f32_32x32x16_bf16 v[96:111], v[168:171], v[152:155], 0
    v_exp_f32 v116, v116
    v_exp_f32 v117, v117
    v_exp_f32 v118, v118
    v_exp_f32 v119, v119
    v_cvt_pk_bf16_f32 v144, v112, v113
    v_cvt_pk_bf16_f32 v145, v114, v115
    v_mfma_f32_32x32x16_bf16 v[128:143], v[180:183], v[36:39], v[128:143]
    v_exp_f32 v120, v120
    v_exp_f32 v121, v121
    v_exp_f32 v122, v122
    v_exp_f32 v123, v123
    v_cvt_pk_bf16_f32 v146, v116, v117
    v_cvt_pk_bf16_f32 v147, v118, v119
    v_mfma_f32_32x32x16_bf16 v[96:111], v[172:175], v[156:159], v[96:111]
    v_exp_f32 v124, v124
    v_exp_f32 v125, v125
    v_exp_f32 v126, v126
    v_exp_f32 v127, v127
    v_cvt_pk_bf16_f32 v148, v120, v121
    v_cvt_pk_bf16_f32 v149, v122, v123
    v_cvt_pk_bf16_f32 v150, v124, v125
    v_cvt_pk_bf16_f32 v151, v126, v127
    v_mfma_f32_32x32x16_bf16 v[112:127], v[176:179], v[40:43], 0
    buffer_load_dwordx4 v[160:163], v3, s[52:55], s78 offen offset:0 sc1
    v_exp_f32 v128, v128
    v_exp_f32 v129, v129
    v_exp_f32 v130, v130
    v_exp_f32 v131, v131
    v_mfma_f32_32x32x16_bf16 v[64:79], v[184:187], v[144:147], v[64:79]
    buffer_load_dwordx4 v[164:167], v3, s[52:55], s78 offen offset:1024 sc1
    v_exp_f32 v132, v132
    v_exp_f32 v133, v133
    v_exp_f32 v134, v134
    v_exp_f32 v135, v135
    v_cvt_pk_bf16_f32 v152, v128, v129
    v_cvt_pk_bf16_f32 v153, v130, v131
    v_mfma_f32_32x32x16_bf16 v[112:127], v[180:183], v[44:47], v[112:127]
    buffer_load_dwordx4 v[168:171], v3, s[52:55], s78 offen offset:2048 sc1
    v_exp_f32 v136, v136
    v_exp_f32 v137, v137
    v_exp_f32 v138, v138
    v_exp_f32 v139, v139
    v_cvt_pk_bf16_f32 v154, v132, v133
    v_cvt_pk_bf16_f32 v155, v134, v135
    v_mfma_f32_32x32x16_bf16 v[64:79], v[188:191], v[148:151], v[64:79]
    buffer_load_dwordx4 v[172:175], v3, s[52:55], s78 offen offset:3072 sc1
    s_add_u32 s78, s78, 4096
    v_exp_f32 v140, v140
    v_exp_f32 v141, v141
    v_exp_f32 v142, v142
    v_exp_f32 v143, v143
    v_cvt_pk_bf16_f32 v156, v136, v137
    v_cvt_pk_bf16_f32 v157, v138, v139
    v_cvt_pk_bf16_f32 v158, v140, v141
    v_cvt_pk_bf16_f32 v159, v142, v143
    v_mfma_f32_32x32x16_bf16 v[128:143], v[192:195], v[24:27], 0
    v_exp_f32 v112, v112
    v_exp_f32 v113, v113
    v_exp_f32 v114, v114
    v_exp_f32 v115, v115
    v_mfma_f32_32x32x16_bf16 v[80:95], v[184:187], v[152:155], v[80:95]
    v_exp_f32 v116, v116
    v_exp_f32 v117, v117
    v_exp_f32 v118, v118
    v_exp_f32 v119, v119
    v_cvt_pk_bf16_f32 v144, v112, v113
    v_cvt_pk_bf16_f32 v145, v114, v115
    v_mfma_f32_32x32x16_bf16 v[128:143], v[196:199], v[28:31], v[128:143]
    v_exp_f32 v120, v120
    v_exp_f32 v121, v121
    v_exp_f32 v122, v122
    v_exp_f32 v123, v123
    v_cvt_pk_bf16_f32 v146, v116, v117
    v_cvt_pk_bf16_f32 v147, v118, v119
    v_mfma_f32_32x32x16_bf16 v[80:95], v[188:191], v[156:159], v[80:95]
    v_exp_f32 v124, v124
    v_exp_f32 v125, v125
    v_exp_f32 v126, v126
    v_exp_f32 v127, v127
    v_cvt_pk_bf16_f32 v148, v120, v121
    v_cvt_pk_bf16_f32 v149, v122, v123
    v_cvt_pk_bf16_f32 v150, v124, v125
    v_cvt_pk_bf16_f32 v151, v126, v127
    v_mfma_f32_32x32x16_bf16 v[112:127], v[192:195], v[32:35], 0
    v_exp_f32 v128, v128
    v_exp_f32 v129, v129
    v_exp_f32 v130, v130
    v_exp_f32 v131, v131
    v_mfma_f32_32x32x16_bf16 v[96:111], v[184:187], v[144:147], v[96:111]
    v_exp_f32 v132, v132
    v_exp_f32 v133, v133
    v_exp_f32 v134, v134
    v_exp_f32 v135, v135
    v_cvt_pk_bf16_f32 v152, v128, v129
    v_cvt_pk_bf16_f32 v153, v130, v131
    v_mfma_f32_32x32x16_bf16 v[112:127], v[196:199], v[36:39], v[112:127]
    v_exp_f32 v136, v136
    v_exp_f32 v137, v137
    v_exp_f32 v138, v138
    v_exp_f32 v139, v139
    v_cvt_pk_bf16_f32 v154, v132, v133
    v_cvt_pk_bf16_f32 v155, v134, v135
    v_mfma_f32_32x32x16_bf16 v[96:111], v[188:191], v[148:151], v[96:111]
    v_exp_f32 v140, v140
    v_exp_f32 v141, v141
    v_exp_f32 v142, v142
    v_exp_f32 v143, v143
    v_cvt_pk_bf16_f32 v156, v136, v137
    v_cvt_pk_bf16_f32 v157, v138, v139
    v_cvt_pk_bf16_f32 v158, v140, v141
    v_cvt_pk_bf16_f32 v159, v142, v143
    v_mfma_f32_32x32x16_bf16 v[128:143], v[192:195], v[40:43], 0
    buffer_load_dwordx4 v[176:179], v3, s[52:55], s78 offen offset:0 sc1
    v_exp_f32 v112, v112
    v_exp_f32 v113, v113
    v_exp_f32 v114, v114
    v_exp_f32 v115, v115
    v_mfma_f32_32x32x16_bf16 v[64:79], v[200:203], v[152:155], v[64:79]
    buffer_load_dwordx4 v[180:183], v3, s[52:55], s78 offen offset:1024 sc1
    v_exp_f32 v116, v116
    v_exp_f32 v117, v117
    v_exp_f32 v118, v118
    v_exp_f32 v119, v119
    v_cvt_pk_bf16_f32 v144, v112, v113
    v_cvt_pk_bf16_f32 v145, v114, v115
    v_mfma_f32_32x32x16_bf16 v[128:143], v[196:199], v[44:47], v[128:143]
    buffer_load_dwordx4 v[184:187], v3, s[52:55], s78 offen offset:2048 sc1
    v_exp_f32 v120, v120
    v_exp_f32 v121, v121
    v_exp_f32 v122, v122
    v_exp_f32 v123, v123
    v_cvt_pk_bf16_f32 v146, v116, v117
    v_cvt_pk_bf16_f32 v147, v118, v119
    v_mfma_f32_32x32x16_bf16 v[64:79], v[204:207], v[156:159], v[64:79]
    buffer_load_dwordx4 v[188:191], v3, s[52:55], s78 offen offset:3072 sc1
    s_add_u32 s78, s78, 4096
    v_exp_f32 v124, v124
    v_exp_f32 v125, v125
    v_exp_f32 v126, v126
    v_exp_f32 v127, v127
    v_cvt_pk_bf16_f32 v148, v120, v121
    v_cvt_pk_bf16_f32 v149, v122, v123
    v_cvt_pk_bf16_f32 v150, v124, v125
    v_cvt_pk_bf16_f32 v151, v126, v127
    s_waitcnt vmcnt(16)
    s_nop 0
    v_mfma_f32_32x32x16_bf16 v[112:127], v[208:211], v[16:19], 0
    v_exp_f32 v128, v128
    v_exp_f32 v129, v129
    v_exp_f32 v130, v130
    v_exp_f32 v131, v131
    v_mfma_f32_32x32x16_bf16 v[80:95], v[200:203], v[144:147], v[80:95]
    v_exp_f32 v132, v132
    v_exp_f32 v133, v133
    v_exp_f32 v134, v134
    v_exp_f32 v135, v135
    v_cvt_pk_bf16_f32 v152, v128, v129
    v_cvt_pk_bf16_f32 v153, v130, v131
    v_mfma_f32_32x32x16_bf16 v[112:127], v[212:215], v[20:23], v[112:127]
    v_exp_f32 v136, v136
    v_exp_f32 v137, v137
    v_exp_f32 v138, v138
    v_exp_f32 v139, v139
    v_cvt_pk_bf16_f32 v154, v132, v133
    v_cvt_pk_bf16_f32 v155, v134, v135
    v_mfma_f32_32x32x16_bf16 v[80:95], v[204:207], v[148:151], v[80:95]
    v_exp_f32 v140, v140
    v_exp_f32 v141, v141
    v_exp_f32 v142, v142
    v_exp_f32 v143, v143
    v_cvt_pk_bf16_f32 v156, v136, v137
    v_cvt_pk_bf16_f32 v157, v138, v139
    v_cvt_pk_bf16_f32 v158, v140, v141
    v_cvt_pk_bf16_f32 v159, v142, v143
    v_mfma_f32_32x32x16_bf16 v[128:143], v[208:211], v[24:27], 0
    v_exp_f32 v112, v112
    v_exp_f32 v113, v113
    v_exp_f32 v114, v114
    v_exp_f32 v115, v115
    v_mfma_f32_32x32x16_bf16 v[96:111], v[200:203], v[152:155], v[96:111]
    v_exp_f32 v116, v116
    v_exp_f32 v117, v117
    v_exp_f32 v118, v118
    v_exp_f32 v119, v119
    v_cvt_pk_bf16_f32 v144, v112, v113
    v_cvt_pk_bf16_f32 v145, v114, v115
    v_mfma_f32_32x32x16_bf16 v[128:143], v[212:215], v[28:31], v[128:143]
    v_exp_f32 v120, v120
    v_exp_f32 v121, v121
    v_exp_f32 v122, v122
    v_exp_f32 v123, v123
    v_cvt_pk_bf16_f32 v146, v116, v117
    v_cvt_pk_bf16_f32 v147, v118, v119
    v_mfma_f32_32x32x16_bf16 v[96:111], v[204:207], v[156:159], v[96:111]
    v_exp_f32 v124, v124
    v_exp_f32 v125, v125
    v_exp_f32 v126, v126
    v_exp_f32 v127, v127
    v_cvt_pk_bf16_f32 v148, v120, v121
    v_cvt_pk_bf16_f32 v149, v122, v123
    v_cvt_pk_bf16_f32 v150, v124, v125
    v_cvt_pk_bf16_f32 v151, v126, v127
    v_mfma_f32_32x32x16_bf16 v[112:127], v[208:211], v[32:35], 0
    buffer_load_dwordx4 v[192:195], v3, s[52:55], s78 offen offset:0 sc1
    v_exp_f32 v128, v128
    v_exp_f32 v129, v129
    v_exp_f32 v130, v130
    v_exp_f32 v131, v131
    v_mfma_f32_32x32x16_bf16 v[48:63], v[216:219], v[144:147], v[48:63]
    buffer_load_dwordx4 v[196:199], v3, s[52:55], s78 offen offset:1024 sc1
    v_exp_f32 v132, v132
    v_exp_f32 v133, v133
    v_exp_f32 v134, v134
    v_exp_f32 v135, v135
    v_cvt_pk_bf16_f32 v152, v128, v129
    v_cvt_pk_bf16_f32 v153, v130, v131
    v_mfma_f32_32x32x16_bf16 v[112:127], v[212:215], v[36:39], v[112:127]
    buffer_load_dwordx4 v[200:203], v3, s[52:55], s78 offen offset:2048 sc1
    v_exp_f32 v136, v136
    v_exp_f32 v137, v137
    v_exp_f32 v138, v138
    v_exp_f32 v139, v139
    v_cvt_pk_bf16_f32 v154, v132, v133
    v_cvt_pk_bf16_f32 v155, v134, v135
    v_mfma_f32_32x32x16_bf16 v[48:63], v[220:223], v[148:151], v[48:63]
    buffer_load_dwordx4 v[204:207], v3, s[52:55], s78 offen offset:3072 sc1
    s_add_u32 s78, s78, 4096
    v_exp_f32 v140, v140
    v_exp_f32 v141, v141
    v_exp_f32 v142, v142
    v_exp_f32 v143, v143
    v_cvt_pk_bf16_f32 v156, v136, v137
    v_cvt_pk_bf16_f32 v157, v138, v139
    v_cvt_pk_bf16_f32 v158, v140, v141
    v_cvt_pk_bf16_f32 v159, v142, v143
    v_mfma_f32_32x32x16_bf16 v[128:143], v[208:211], v[40:43], 0
    v_exp_f32 v112, v112
    v_exp_f32 v113, v113
    v_exp_f32 v114, v114
    v_exp_f32 v115, v115
    v_mfma_f32_32x32x16_bf16 v[64:79], v[216:219], v[152:155], v[64:79]
    v_exp_f32 v116, v116
    v_exp_f32 v117, v117
    v_exp_f32 v118, v118
    v_exp_f32 v119, v119
    v_cvt_pk_bf16_f32 v144, v112, v113
    v_cvt_pk_bf16_f32 v145, v114, v115
    v_mfma_f32_32x32x16_bf16 v[128:143], v[212:215], v[44:47], v[128:143]
    v_exp_f32 v120, v120
    v_exp_f32 v121, v121
    v_exp_f32 v122, v122
    v_exp_f32 v123, v123
    v_cvt_pk_bf16_f32 v146, v116, v117
    v_cvt_pk_bf16_f32 v147, v118, v119
    v_mfma_f32_32x32x16_bf16 v[64:79], v[220:223], v[156:159], v[64:79]
    v_exp_f32 v124, v124
    v_exp_f32 v125, v125
    v_exp_f32 v126, v126
    v_exp_f32 v127, v127
    v_cvt_pk_bf16_f32 v148, v120, v121
    v_cvt_pk_bf16_f32 v149, v122, v123
    v_cvt_pk_bf16_f32 v150, v124, v125
    v_cvt_pk_bf16_f32 v151, v126, v127
    s_waitcnt vmcnt(16)
    s_nop 0
    v_mfma_f32_32x32x16_bf16 v[112:127], v[224:227], v[16:19], 0
    v_exp_f32 v128, v128
    v_exp_f32 v129, v129
    v_exp_f32 v130, v130
    v_exp_f32 v131, v131
    v_mfma_f32_32x32x16_bf16 v[80:95], v[216:219], v[144:147], v[80:95]
    v_exp_f32 v132, v132
    v_exp_f32 v133, v133
    v_exp_f32 v134, v134
    v_exp_f32 v135, v135
    v_cvt_pk_bf16_f32 v152, v128, v129
    v_cvt_pk_bf16_f32 v153, v130, v131
    v_mfma_f32_32x32x16_bf16 v[112:127], v[228:231], v[20:23], v[112:127]
    v_exp_f32 v136, v136
    v_exp_f32 v137, v137
    v_exp_f32 v138, v138
    v_exp_f32 v139, v139
    v_cvt_pk_bf16_f32 v154, v132, v133
    v_cvt_pk_bf16_f32 v155, v134, v135
    v_mfma_f32_32x32x16_bf16 v[80:95], v[220:223], v[148:151], v[80:95]
    v_exp_f32 v140, v140
    v_exp_f32 v141, v141
    v_exp_f32 v142, v142
    v_exp_f32 v143, v143
    v_cvt_pk_bf16_f32 v156, v136, v137
    v_cvt_pk_bf16_f32 v157, v138, v139
    v_cvt_pk_bf16_f32 v158, v140, v141
    v_cvt_pk_bf16_f32 v159, v142, v143
    v_mfma_f32_32x32x16_bf16 v[128:143], v[224:227], v[24:27], 0
    v_exp_f32 v112, v112
    v_exp_f32 v113, v113
    v_exp_f32 v114, v114
    v_exp_f32 v115, v115
    v_mfma_f32_32x32x16_bf16 v[96:111], v[216:219], v[152:155], v[96:111]
    v_exp_f32 v116, v116
    v_exp_f32 v117, v117
    v_exp_f32 v118, v118
    v_exp_f32 v119, v119
    v_cvt_pk_bf16_f32 v144, v112, v113
    v_cvt_pk_bf16_f32 v145, v114, v115
    v_mfma_f32_32x32x16_bf16 v[128:143], v[228:231], v[28:31], v[128:143]
    v_exp_f32 v120, v120
    v_exp_f32 v121, v121
    v_exp_f32 v122, v122
    v_exp_f32 v123, v123
    v_cvt_pk_bf16_f32 v146, v116, v117
    v_cvt_pk_bf16_f32 v147, v118, v119
    v_mfma_f32_32x32x16_bf16 v[96:111], v[220:223], v[156:159], v[96:111]
    v_exp_f32 v124, v124
    v_exp_f32 v125, v125
    v_exp_f32 v126, v126
    v_exp_f32 v127, v127
    v_cvt_pk_bf16_f32 v148, v120, v121
    v_cvt_pk_bf16_f32 v149, v122, v123
    v_cvt_pk_bf16_f32 v150, v124, v125
    v_cvt_pk_bf16_f32 v151, v126, v127
    v_mfma_f32_32x32x16_bf16 v[112:127], v[224:227], v[32:35], 0
    buffer_load_dwordx4 v[208:211], v3, s[52:55], s78 offen offset:0 sc1
    v_exp_f32 v128, v128
    v_exp_f32 v129, v129
    v_exp_f32 v130, v130
    v_exp_f32 v131, v131
    v_mfma_f32_32x32x16_bf16 v[48:63], v[232:235], v[144:147], v[48:63]
    buffer_load_dwordx4 v[212:215], v3, s[52:55], s78 offen offset:1024 sc1
    v_exp_f32 v132, v132
    v_exp_f32 v133, v133
    v_exp_f32 v134, v134
    v_exp_f32 v135, v135
    v_cvt_pk_bf16_f32 v152, v128, v129
    v_cvt_pk_bf16_f32 v153, v130, v131
    v_mfma_f32_32x32x16_bf16 v[112:127], v[228:231], v[36:39], v[112:127]
    buffer_load_dwordx4 v[216:219], v3, s[52:55], s78 offen offset:2048 sc1
    v_exp_f32 v136, v136
    v_exp_f32 v137, v137
    v_exp_f32 v138, v138
    v_exp_f32 v139, v139
    v_cvt_pk_bf16_f32 v154, v132, v133
    v_cvt_pk_bf16_f32 v155, v134, v135
    v_mfma_f32_32x32x16_bf16 v[48:63], v[236:239], v[148:151], v[48:63]
    buffer_load_dwordx4 v[220:223], v3, s[52:55], s78 offen offset:3072 sc1
    s_add_u32 s78, s78, 4096
    v_exp_f32 v140, v140
    v_exp_f32 v141, v141
    v_exp_f32 v142, v142
    v_exp_f32 v143, v143
    v_cvt_pk_bf16_f32 v156, v136, v137
    v_cvt_pk_bf16_f32 v157, v138, v139
    v_cvt_pk_bf16_f32 v158, v140, v141
    v_cvt_pk_bf16_f32 v159, v142, v143
    v_mfma_f32_32x32x16_bf16 v[128:143], v[224:227], v[40:43], 0
    v_exp_f32 v112, v112
    v_exp_f32 v113, v113
    v_exp_f32 v114, v114
    v_exp_f32 v115, v115
    v_mfma_f32_32x32x16_bf16 v[64:79], v[232:235], v[152:155], v[64:79]
    v_exp_f32 v116, v116
    v_exp_f32 v117, v117
    v_exp_f32 v118, v118
    v_exp_f32 v119, v119
    v_cvt_pk_bf16_f32 v144, v112, v113
    v_cvt_pk_bf16_f32 v145, v114, v115
    v_mfma_f32_32x32x16_bf16 v[128:143], v[228:231], v[44:47], v[128:143]
    v_exp_f32 v120, v120
    v_exp_f32 v121, v121
    v_exp_f32 v122, v122
    v_exp_f32 v123, v123
    v_cvt_pk_bf16_f32 v146, v116, v117
    v_cvt_pk_bf16_f32 v147, v118, v119
    v_mfma_f32_32x32x16_bf16 v[64:79], v[236:239], v[156:159], v[64:79]
    v_exp_f32 v124, v124
    v_exp_f32 v125, v125
    v_exp_f32 v126, v126
    v_exp_f32 v127, v127
    v_cvt_pk_bf16_f32 v148, v120, v121
    v_cvt_pk_bf16_f32 v149, v122, v123
    v_cvt_pk_bf16_f32 v150, v124, v125
    v_cvt_pk_bf16_f32 v151, v126, v127
    s_waitcnt vmcnt(16)
    s_nop 0
    v_mfma_f32_32x32x16_bf16 v[112:127], v[240:243], v[16:19], 0
    v_exp_f32 v128, v128
    v_exp_f32 v129, v129
    v_exp_f32 v130, v130
    v_exp_f32 v131, v131
    v_mfma_f32_32x32x16_bf16 v[80:95], v[232:235], v[144:147], v[80:95]
    v_exp_f32 v132, v132
    v_exp_f32 v133, v133
    v_exp_f32 v134, v134
    v_exp_f32 v135, v135
    v_cvt_pk_bf16_f32 v152, v128, v129
    v_cvt_pk_bf16_f32 v153, v130, v131
    v_mfma_f32_32x32x16_bf16 v[112:127], v[244:247], v[20:23], v[112:127]
    v_exp_f32 v136, v136
    v_exp_f32 v137, v137
    v_exp_f32 v138, v138
    v_exp_f32 v139, v139
    v_cvt_pk_bf16_f32 v154, v132, v133
    v_cvt_pk_bf16_f32 v155, v134, v135
    v_mfma_f32_32x32x16_bf16 v[80:95], v[236:239], v[148:151], v[80:95]
    v_exp_f32 v140, v140
    v_exp_f32 v141, v141
    v_exp_f32 v142, v142
    v_exp_f32 v143, v143
    v_cvt_pk_bf16_f32 v156, v136, v137
    v_cvt_pk_bf16_f32 v157, v138, v139
    v_cvt_pk_bf16_f32 v158, v140, v141
    v_cvt_pk_bf16_f32 v159, v142, v143
    v_mfma_f32_32x32x16_bf16 v[128:143], v[240:243], v[24:27], 0
    v_exp_f32 v112, v112
    v_exp_f32 v113, v113
    v_exp_f32 v114, v114
    v_exp_f32 v115, v115
    v_mfma_f32_32x32x16_bf16 v[96:111], v[232:235], v[152:155], v[96:111]
    v_exp_f32 v116, v116
    v_exp_f32 v117, v117
    v_exp_f32 v118, v118
    v_exp_f32 v119, v119
    v_cvt_pk_bf16_f32 v144, v112, v113
    v_cvt_pk_bf16_f32 v145, v114, v115
    v_mfma_f32_32x32x16_bf16 v[128:143], v[244:247], v[28:31], v[128:143]
    v_exp_f32 v120, v120
    v_exp_f32 v121, v121
    v_exp_f32 v122, v122
    v_exp_f32 v123, v123
    v_cvt_pk_bf16_f32 v146, v116, v117
    v_cvt_pk_bf16_f32 v147, v118, v119
    v_mfma_f32_32x32x16_bf16 v[96:111], v[236:239], v[156:159], v[96:111]
    v_exp_f32 v124, v124
    v_exp_f32 v125, v125
    v_exp_f32 v126, v126
    v_exp_f32 v127, v127
    v_cvt_pk_bf16_f32 v148, v120, v121
    v_cvt_pk_bf16_f32 v149, v122, v123
    v_cvt_pk_bf16_f32 v150, v124, v125
    v_cvt_pk_bf16_f32 v151, v126, v127
    v_mfma_f32_32x32x16_bf16 v[112:127], v[240:243], v[32:35], 0
    buffer_load_dwordx4 v[224:227], v3, s[52:55], s78 offen offset:0 sc1
    v_exp_f32 v128, v128
    v_exp_f32 v129, v129
    v_exp_f32 v130, v130
    v_exp_f32 v131, v131
    v_mfma_f32_32x32x16_bf16 v[48:63], v[248:251], v[144:147], v[48:63]
    buffer_load_dwordx4 v[228:231], v3, s[52:55], s78 offen offset:1024 sc1
    v_exp_f32 v132, v132
    v_exp_f32 v133, v133
    v_exp_f32 v134, v134
    v_exp_f32 v135, v135
    v_cvt_pk_bf16_f32 v152, v128, v129
    v_cvt_pk_bf16_f32 v153, v130, v131
    v_mfma_f32_32x32x16_bf16 v[112:127], v[244:247], v[36:39], v[112:127]
    buffer_load_dwordx4 v[232:235], v3, s[52:55], s78 offen offset:2048 sc1
    v_exp_f32 v136, v136
    v_exp_f32 v137, v137
    v_exp_f32 v138, v138
    v_exp_f32 v139, v139
    v_cvt_pk_bf16_f32 v154, v132, v133
    v_cvt_pk_bf16_f32 v155, v134, v135
    v_mfma_f32_32x32x16_bf16 v[48:63], v[252:255], v[148:151], v[48:63]
    buffer_load_dwordx4 v[236:239], v3, s[52:55], s78 offen offset:3072 sc1
    s_add_u32 s78, s78, 4096
    v_exp_f32 v140, v140
    v_exp_f32 v141, v141
    v_exp_f32 v142, v142
    v_exp_f32 v143, v143
    v_cvt_pk_bf16_f32 v156, v136, v137
    v_cvt_pk_bf16_f32 v157, v138, v139
    v_cvt_pk_bf16_f32 v158, v140, v141
    v_cvt_pk_bf16_f32 v159, v142, v143
    v_mfma_f32_32x32x16_bf16 v[128:143], v[240:243], v[40:43], 0
    v_exp_f32 v112, v112
    v_exp_f32 v113, v113
    v_exp_f32 v114, v114
    v_exp_f32 v115, v115
    v_mfma_f32_32x32x16_bf16 v[64:79], v[248:251], v[152:155], v[64:79]
    v_exp_f32 v116, v116
    v_exp_f32 v117, v117
    v_exp_f32 v118, v118
    v_exp_f32 v119, v119
    v_cvt_pk_bf16_f32 v144, v112, v113
    v_cvt_pk_bf16_f32 v145, v114, v115
    v_mfma_f32_32x32x16_bf16 v[128:143], v[244:247], v[44:47], v[128:143]
    v_exp_f32 v120, v120
    v_exp_f32 v121, v121
    v_exp_f32 v122, v122
    v_exp_f32 v123, v123
    v_cvt_pk_bf16_f32 v146, v116, v117
    v_cvt_pk_bf16_f32 v147, v118, v119
    v_mfma_f32_32x32x16_bf16 v[64:79], v[252:255], v[156:159], v[64:79]
    v_exp_f32 v124, v124
    v_exp_f32 v125, v125
    v_exp_f32 v126, v126
    v_exp_f32 v127, v127
    v_cvt_pk_bf16_f32 v148, v120, v121
    v_cvt_pk_bf16_f32 v149, v122, v123
    v_cvt_pk_bf16_f32 v150, v124, v125
    v_cvt_pk_bf16_f32 v151, v126, v127
    s_waitcnt vmcnt(16)
    s_nop 0
    v_mfma_f32_32x32x16_bf16 v[112:127], v[160:163], v[16:19], 0
    v_exp_f32 v128, v128
    v_exp_f32 v129, v129
    v_exp_f32 v130, v130
    v_exp_f32 v131, v131
    v_mfma_f32_32x32x16_bf16 v[80:95], v[248:251], v[144:147], v[80:95]
    v_exp_f32 v132, v132
    v_exp_f32 v133, v133
    v_exp_f32 v134, v134
    v_exp_f32 v135, v135
    v_cvt_pk_bf16_f32 v152, v128, v129
    v_cvt_pk_bf16_f32 v153, v130, v131
    v_mfma_f32_32x32x16_bf16 v[112:127], v[164:167], v[20:23], v[112:127]
    v_exp_f32 v136, v136
    v_exp_f32 v137, v137
    v_exp_f32 v138, v138
    v_exp_f32 v139, v139
    v_cvt_pk_bf16_f32 v154, v132, v133
    v_cvt_pk_bf16_f32 v155, v134, v135
    v_mfma_f32_32x32x16_bf16 v[80:95], v[252:255], v[148:151], v[80:95]
    v_exp_f32 v140, v140
    v_exp_f32 v141, v141
    v_exp_f32 v142, v142
    v_exp_f32 v143, v143
    v_cvt_pk_bf16_f32 v156, v136, v137
    v_cvt_pk_bf16_f32 v157, v138, v139
    v_cvt_pk_bf16_f32 v158, v140, v141
    v_cvt_pk_bf16_f32 v159, v142, v143
    v_mfma_f32_32x32x16_bf16 v[128:143], v[160:163], v[24:27], 0
    v_exp_f32 v112, v112
    v_exp_f32 v113, v113
    v_exp_f32 v114, v114
    v_exp_f32 v115, v115
    v_mfma_f32_32x32x16_bf16 v[96:111], v[248:251], v[152:155], v[96:111]
    v_exp_f32 v116, v116
    v_exp_f32 v117, v117
    v_exp_f32 v118, v118
    v_exp_f32 v119, v119
    v_cvt_pk_bf16_f32 v144, v112, v113
    v_cvt_pk_bf16_f32 v145, v114, v115
    v_mfma_f32_32x32x16_bf16 v[128:143], v[164:167], v[28:31], v[128:143]
    v_exp_f32 v120, v120
    v_exp_f32 v121, v121
    v_exp_f32 v122, v122
    v_exp_f32 v123, v123
    v_cvt_pk_bf16_f32 v146, v116, v117
    v_cvt_pk_bf16_f32 v147, v118, v119
    v_mfma_f32_32x32x16_bf16 v[96:111], v[252:255], v[156:159], v[96:111]
    v_exp_f32 v124, v124
    v_exp_f32 v125, v125
    v_exp_f32 v126, v126
    v_exp_f32 v127, v127
    v_cvt_pk_bf16_f32 v148, v120, v121
    v_cvt_pk_bf16_f32 v149, v122, v123
    v_cvt_pk_bf16_f32 v150, v124, v125
    v_cvt_pk_bf16_f32 v151, v126, v127
    v_mfma_f32_32x32x16_bf16 v[112:127], v[160:163], v[32:35], 0
    buffer_load_dwordx4 v[240:243], v3, s[52:55], s78 offen offset:0 sc1
    v_exp_f32 v128, v128
    v_exp_f32 v129, v129
    v_exp_f32 v130, v130
    v_exp_f32 v131, v131
    v_mfma_f32_32x32x16_bf16 v[48:63], v[168:171], v[144:147], v[48:63]
    buffer_load_dwordx4 v[244:247], v3, s[52:55], s78 offen offset:1024 sc1
    v_exp_f32 v132, v132
    v_exp_f32 v133, v133
    v_exp_f32 v134, v134
    v_exp_f32 v135, v135
    v_cvt_pk_bf16_f32 v152, v128, v129
    v_cvt_pk_bf16_f32 v153, v130, v131
    v_mfma_f32_32x32x16_bf16 v[112:127], v[164:167], v[36:39], v[112:127]
    buffer_load_dwordx4 v[248:251], v3, s[52:55], s78 offen offset:2048 sc1
    v_exp_f32 v136, v136
    v_exp_f32 v137, v137
    v_exp_f32 v138, v138
    v_exp_f32 v139, v139
    v_cvt_pk_bf16_f32 v154, v132, v133
    v_cvt_pk_bf16_f32 v155, v134, v135
    v_mfma_f32_32x32x16_bf16 v[48:63], v[172:175], v[148:151], v[48:63]
    buffer_load_dwordx4 v[252:255], v3, s[52:55], s78 offen offset:3072 sc1
    s_add_u32 s78, s78, 4096
    v_exp_f32 v140, v140
    v_exp_f32 v141, v141
    v_exp_f32 v142, v142
    v_exp_f32 v143, v143
    v_cvt_pk_bf16_f32 v156, v136, v137
    v_cvt_pk_bf16_f32 v157, v138, v139
    v_cvt_pk_bf16_f32 v158, v140, v141
    v_cvt_pk_bf16_f32 v159, v142, v143
    v_mfma_f32_32x32x16_bf16 v[128:143], v[160:163], v[40:43], 0
    v_exp_f32 v112, v112
    v_exp_f32 v113, v113
    v_exp_f32 v114, v114
    v_exp_f32 v115, v115
    v_mfma_f32_32x32x16_bf16 v[64:79], v[168:171], v[152:155], v[64:79]
    v_exp_f32 v116, v116
    v_exp_f32 v117, v117
    v_exp_f32 v118, v118
    v_exp_f32 v119, v119
    v_cvt_pk_bf16_f32 v144, v112, v113
    v_cvt_pk_bf16_f32 v145, v114, v115
    v_mfma_f32_32x32x16_bf16 v[128:143], v[164:167], v[44:47], v[128:143]
    v_exp_f32 v120, v120
    v_exp_f32 v121, v121
    v_exp_f32 v122, v122
    v_exp_f32 v123, v123
    v_cvt_pk_bf16_f32 v146, v116, v117
    v_cvt_pk_bf16_f32 v147, v118, v119
    v_mfma_f32_32x32x16_bf16 v[64:79], v[172:175], v[156:159], v[64:79]
    v_exp_f32 v124, v124
    v_exp_f32 v125, v125
    v_exp_f32 v126, v126
    v_exp_f32 v127, v127
    v_cvt_pk_bf16_f32 v148, v120, v121
    v_cvt_pk_bf16_f32 v149, v122, v123
    v_cvt_pk_bf16_f32 v150, v124, v125
    v_cvt_pk_bf16_f32 v151, v126, v127
    s_waitcnt vmcnt(16)
    s_nop 0
    v_mfma_f32_32x32x16_bf16 v[112:127], v[176:179], v[16:19], 0
    v_exp_f32 v128, v128
    v_exp_f32 v129, v129
    v_exp_f32 v130, v130
    v_exp_f32 v131, v131
    v_mfma_f32_32x32x16_bf16 v[80:95], v[168:171], v[144:147], v[80:95]
    v_exp_f32 v132, v132
    v_exp_f32 v133, v133
    v_exp_f32 v134, v134
    v_exp_f32 v135, v135
    v_cvt_pk_bf16_f32 v152, v128, v129
    v_cvt_pk_bf16_f32 v153, v130, v131
    v_mfma_f32_32x32x16_bf16 v[112:127], v[180:183], v[20:23], v[112:127]
    v_exp_f32 v136, v136
    v_exp_f32 v137, v137
    v_exp_f32 v138, v138
    v_exp_f32 v139, v139
    v_cvt_pk_bf16_f32 v154, v132, v133
    v_cvt_pk_bf16_f32 v155, v134, v135
    v_mfma_f32_32x32x16_bf16 v[80:95], v[172:175], v[148:151], v[80:95]
    v_exp_f32 v140, v140
    v_exp_f32 v141, v141
    v_exp_f32 v142, v142
    v_exp_f32 v143, v143
    v_cvt_pk_bf16_f32 v156, v136, v137
    v_cvt_pk_bf16_f32 v157, v138, v139
    v_cvt_pk_bf16_f32 v158, v140, v141
    v_cvt_pk_bf16_f32 v159, v142, v143
    v_mfma_f32_32x32x16_bf16 v[128:143], v[176:179], v[24:27], 0
    v_exp_f32 v112, v112
    v_exp_f32 v113, v113
    v_exp_f32 v114, v114
    v_exp_f32 v115, v115
    v_mfma_f32_32x32x16_bf16 v[96:111], v[168:171], v[152:155], v[96:111]
    v_exp_f32 v116, v116
    v_exp_f32 v117, v117
    v_exp_f32 v118, v118
    v_exp_f32 v119, v119
    v_cvt_pk_bf16_f32 v144, v112, v113
    v_cvt_pk_bf16_f32 v145, v114, v115
    v_mfma_f32_32x32x16_bf16 v[128:143], v[180:183], v[28:31], v[128:143]
    v_exp_f32 v120, v120
    v_exp_f32 v121, v121
    v_exp_f32 v122, v122
    v_exp_f32 v123, v123
    v_cvt_pk_bf16_f32 v146, v116, v117
    v_cvt_pk_bf16_f32 v147, v118, v119
    v_mfma_f32_32x32x16_bf16 v[96:111], v[172:175], v[156:159], v[96:111]
    v_exp_f32 v124, v124
    v_exp_f32 v125, v125
    v_exp_f32 v126, v126
    v_exp_f32 v127, v127
    v_cvt_pk_bf16_f32 v148, v120, v121
    v_cvt_pk_bf16_f32 v149, v122, v123
    v_cvt_pk_bf16_f32 v150, v124, v125
    v_cvt_pk_bf16_f32 v151, v126, v127
    v_mfma_f32_32x32x16_bf16 v[112:127], v[176:179], v[32:35], 0
    buffer_load_dwordx4 v[160:163], v3, s[52:55], s78 offen offset:0 sc1
    v_exp_f32 v128, v128
    v_exp_f32 v129, v129
    v_exp_f32 v130, v130
    v_exp_f32 v131, v131
    v_mfma_f32_32x32x16_bf16 v[48:63], v[184:187], v[144:147], v[48:63]
    buffer_load_dwordx4 v[164:167], v3, s[52:55], s78 offen offset:1024 sc1
    v_exp_f32 v132, v132
    v_exp_f32 v133, v133
    v_exp_f32 v134, v134
    v_exp_f32 v135, v135
    v_cvt_pk_bf16_f32 v152, v128, v129
    v_cvt_pk_bf16_f32 v153, v130, v131
    v_mfma_f32_32x32x16_bf16 v[112:127], v[180:183], v[36:39], v[112:127]
    buffer_load_dwordx4 v[168:171], v3, s[52:55], s78 offen offset:2048 sc1
    v_exp_f32 v136, v136
    v_exp_f32 v137, v137
    v_exp_f32 v138, v138
    v_exp_f32 v139, v139
    v_cvt_pk_bf16_f32 v154, v132, v133
    v_cvt_pk_bf16_f32 v155, v134, v135
    v_mfma_f32_32x32x16_bf16 v[48:63], v[188:191], v[148:151], v[48:63]
    buffer_load_dwordx4 v[172:175], v3, s[52:55], s78 offen offset:3072 sc1
    s_add_u32 s78, s78, 4096
    v_exp_f32 v140, v140
    v_exp_f32 v141, v141
    v_exp_f32 v142, v142
    v_exp_f32 v143, v143
    v_cvt_pk_bf16_f32 v156, v136, v137
    v_cvt_pk_bf16_f32 v157, v138, v139
    v_cvt_pk_bf16_f32 v158, v140, v141
    v_cvt_pk_bf16_f32 v159, v142, v143
    v_mfma_f32_32x32x16_bf16 v[128:143], v[176:179], v[40:43], 0
    v_exp_f32 v112, v112
    v_exp_f32 v113, v113
    v_exp_f32 v114, v114
    v_exp_f32 v115, v115
    v_mfma_f32_32x32x16_bf16 v[64:79], v[184:187], v[152:155], v[64:79]
    v_exp_f32 v116, v116
    v_exp_f32 v117, v117
    v_exp_f32 v118, v118
    v_exp_f32 v119, v119
    v_cvt_pk_bf16_f32 v144, v112, v113
    v_cvt_pk_bf16_f32 v145, v114, v115
    v_mfma_f32_32x32x16_bf16 v[128:143], v[180:183], v[44:47], v[128:143]
    v_exp_f32 v120, v120
    v_exp_f32 v121, v121
    v_exp_f32 v122, v122
    v_exp_f32 v123, v123
    v_cvt_pk_bf16_f32 v146, v116, v117
    v_cvt_pk_bf16_f32 v147, v118, v119
    v_mfma_f32_32x32x16_bf16 v[64:79], v[188:191], v[156:159], v[64:79]
    v_exp_f32 v124, v124
    v_exp_f32 v125, v125
    v_exp_f32 v126, v126
    v_exp_f32 v127, v127
    v_cvt_pk_bf16_f32 v148, v120, v121
    v_cvt_pk_bf16_f32 v149, v122, v123
    v_cvt_pk_bf16_f32 v150, v124, v125
    v_cvt_pk_bf16_f32 v151, v126, v127
    s_waitcnt vmcnt(16)
    s_nop 0
    v_mfma_f32_32x32x16_bf16 v[112:127], v[192:195], v[16:19], 0
    v_exp_f32 v128, v128
    v_exp_f32 v129, v129
    v_exp_f32 v130, v130
    v_exp_f32 v131, v131
    v_mfma_f32_32x32x16_bf16 v[80:95], v[184:187], v[144:147], v[80:95]
    v_exp_f32 v132, v132
    v_exp_f32 v133, v133
    v_exp_f32 v134, v134
    v_exp_f32 v135, v135
    v_cvt_pk_bf16_f32 v152, v128, v129
    v_cvt_pk_bf16_f32 v153, v130, v131
    v_mfma_f32_32x32x16_bf16 v[112:127], v[196:199], v[20:23], v[112:127]
    v_exp_f32 v136, v136
    v_exp_f32 v137, v137
    v_exp_f32 v138, v138
    v_exp_f32 v139, v139
    v_cvt_pk_bf16_f32 v154, v132, v133
    v_cvt_pk_bf16_f32 v155, v134, v135
    v_mfma_f32_32x32x16_bf16 v[80:95], v[188:191], v[148:151], v[80:95]
    v_exp_f32 v140, v140
    v_exp_f32 v141, v141
    v_exp_f32 v142, v142
    v_exp_f32 v143, v143
    v_cvt_pk_bf16_f32 v156, v136, v137
    v_cvt_pk_bf16_f32 v157, v138, v139
    v_cvt_pk_bf16_f32 v158, v140, v141
    v_cvt_pk_bf16_f32 v159, v142, v143
    v_mfma_f32_32x32x16_bf16 v[128:143], v[192:195], v[24:27], 0
    v_exp_f32 v112, v112
    v_exp_f32 v113, v113
    v_exp_f32 v114, v114
    v_exp_f32 v115, v115
    v_mfma_f32_32x32x16_bf16 v[96:111], v[184:187], v[152:155], v[96:111]
    v_exp_f32 v116, v116
    v_exp_f32 v117, v117
    v_exp_f32 v118, v118
    v_exp_f32 v119, v119
    v_cvt_pk_bf16_f32 v144, v112, v113
    v_cvt_pk_bf16_f32 v145, v114, v115
    v_mfma_f32_32x32x16_bf16 v[128:143], v[196:199], v[28:31], v[128:143]
    v_exp_f32 v120, v120
    v_exp_f32 v121, v121
    v_exp_f32 v122, v122
    v_exp_f32 v123, v123
    v_cvt_pk_bf16_f32 v146, v116, v117
    v_cvt_pk_bf16_f32 v147, v118, v119
    v_mfma_f32_32x32x16_bf16 v[96:111], v[188:191], v[156:159], v[96:111]
    v_exp_f32 v124, v124
    v_exp_f32 v125, v125
    v_exp_f32 v126, v126
    v_exp_f32 v127, v127
    v_cvt_pk_bf16_f32 v148, v120, v121
    v_cvt_pk_bf16_f32 v149, v122, v123
    v_cvt_pk_bf16_f32 v150, v124, v125
    v_cvt_pk_bf16_f32 v151, v126, v127
    v_mfma_f32_32x32x16_bf16 v[112:127], v[192:195], v[32:35], 0
    buffer_load_dwordx4 v[176:179], v3, s[52:55], s78 offen offset:0 sc1
    v_exp_f32 v128, v128
    v_exp_f32 v129, v129
    v_exp_f32 v130, v130
    v_exp_f32 v131, v131
    v_mfma_f32_32x32x16_bf16 v[48:63], v[200:203], v[144:147], v[48:63]
    buffer_load_dwordx4 v[180:183], v3, s[52:55], s78 offen offset:1024 sc1
    v_exp_f32 v132, v132
    v_exp_f32 v133, v133
    v_exp_f32 v134, v134
    v_exp_f32 v135, v135
    v_cvt_pk_bf16_f32 v152, v128, v129
    v_cvt_pk_bf16_f32 v153, v130, v131
    v_mfma_f32_32x32x16_bf16 v[112:127], v[196:199], v[36:39], v[112:127]
    buffer_load_dwordx4 v[184:187], v3, s[52:55], s78 offen offset:2048 sc1
    v_exp_f32 v136, v136
    v_exp_f32 v137, v137
    v_exp_f32 v138, v138
    v_exp_f32 v139, v139
    v_cvt_pk_bf16_f32 v154, v132, v133
    v_cvt_pk_bf16_f32 v155, v134, v135
    v_mfma_f32_32x32x16_bf16 v[48:63], v[204:207], v[148:151], v[48:63]
    buffer_load_dwordx4 v[188:191], v3, s[52:55], s78 offen offset:3072 sc1
    s_add_u32 s78, s78, 4096
    v_exp_f32 v140, v140
    v_exp_f32 v141, v141
    v_exp_f32 v142, v142
    v_exp_f32 v143, v143
    v_cvt_pk_bf16_f32 v156, v136, v137
    v_cvt_pk_bf16_f32 v157, v138, v139
    v_cvt_pk_bf16_f32 v158, v140, v141
    v_cvt_pk_bf16_f32 v159, v142, v143
    v_mfma_f32_32x32x16_bf16 v[128:143], v[192:195], v[40:43], 0
    v_exp_f32 v112, v112
    v_exp_f32 v113, v113
    v_exp_f32 v114, v114
    v_exp_f32 v115, v115
    v_mfma_f32_32x32x16_bf16 v[64:79], v[200:203], v[152:155], v[64:79]
    v_exp_f32 v116, v116
    v_exp_f32 v117, v117
    v_exp_f32 v118, v118
    v_exp_f32 v119, v119
    v_cvt_pk_bf16_f32 v144, v112, v113
    v_cvt_pk_bf16_f32 v145, v114, v115
    v_mfma_f32_32x32x16_bf16 v[128:143], v[196:199], v[44:47], v[128:143]
    v_exp_f32 v120, v120
    v_exp_f32 v121, v121
    v_exp_f32 v122, v122
    v_exp_f32 v123, v123
    v_cvt_pk_bf16_f32 v146, v116, v117
    v_cvt_pk_bf16_f32 v147, v118, v119
    v_mfma_f32_32x32x16_bf16 v[64:79], v[204:207], v[156:159], v[64:79]
    v_exp_f32 v124, v124
    v_exp_f32 v125, v125
    v_exp_f32 v126, v126
    v_exp_f32 v127, v127
    v_cvt_pk_bf16_f32 v148, v120, v121
    v_cvt_pk_bf16_f32 v149, v122, v123
    v_cvt_pk_bf16_f32 v150, v124, v125
    v_cvt_pk_bf16_f32 v151, v126, v127
    s_waitcnt vmcnt(16)
    s_nop 0
    v_mfma_f32_32x32x16_bf16 v[112:127], v[208:211], v[16:19], 0
    v_exp_f32 v128, v128
    v_exp_f32 v129, v129
    v_exp_f32 v130, v130
    v_exp_f32 v131, v131
    v_mfma_f32_32x32x16_bf16 v[80:95], v[200:203], v[144:147], v[80:95]
    v_exp_f32 v132, v132
    v_exp_f32 v133, v133
    v_exp_f32 v134, v134
    v_exp_f32 v135, v135
    v_cvt_pk_bf16_f32 v152, v128, v129
    v_cvt_pk_bf16_f32 v153, v130, v131
    v_mfma_f32_32x32x16_bf16 v[112:127], v[212:215], v[20:23], v[112:127]
    v_exp_f32 v136, v136
    v_exp_f32 v137, v137
    v_exp_f32 v138, v138
    v_exp_f32 v139, v139
    v_cvt_pk_bf16_f32 v154, v132, v133
    v_cvt_pk_bf16_f32 v155, v134, v135
    v_mfma_f32_32x32x16_bf16 v[80:95], v[204:207], v[148:151], v[80:95]
    v_exp_f32 v140, v140
    v_exp_f32 v141, v141
    v_exp_f32 v142, v142
    v_exp_f32 v143, v143
    v_cvt_pk_bf16_f32 v156, v136, v137
    v_cvt_pk_bf16_f32 v157, v138, v139
    v_cvt_pk_bf16_f32 v158, v140, v141
    v_cvt_pk_bf16_f32 v159, v142, v143
    v_mfma_f32_32x32x16_bf16 v[128:143], v[208:211], v[24:27], 0
    v_exp_f32 v112, v112
    v_exp_f32 v113, v113
    v_exp_f32 v114, v114
    v_exp_f32 v115, v115
    v_mfma_f32_32x32x16_bf16 v[96:111], v[200:203], v[152:155], v[96:111]
    v_exp_f32 v116, v116
    v_exp_f32 v117, v117
    v_exp_f32 v118, v118
    v_exp_f32 v119, v119
    v_cvt_pk_bf16_f32 v144, v112, v113
    v_cvt_pk_bf16_f32 v145, v114, v115
    v_mfma_f32_32x32x16_bf16 v[128:143], v[212:215], v[28:31], v[128:143]
    v_exp_f32 v120, v120
    v_exp_f32 v121, v121
    v_exp_f32 v122, v122
    v_exp_f32 v123, v123
    v_cvt_pk_bf16_f32 v146, v116, v117
    v_cvt_pk_bf16_f32 v147, v118, v119
    v_mfma_f32_32x32x16_bf16 v[96:111], v[204:207], v[156:159], v[96:111]
    v_exp_f32 v124, v124
    v_exp_f32 v125, v125
    v_exp_f32 v126, v126
    v_exp_f32 v127, v127
    v_cvt_pk_bf16_f32 v148, v120, v121
    v_cvt_pk_bf16_f32 v149, v122, v123
    v_cvt_pk_bf16_f32 v150, v124, v125
    v_cvt_pk_bf16_f32 v151, v126, v127
    v_mfma_f32_32x32x16_bf16 v[112:127], v[208:211], v[32:35], 0
    buffer_load_dwordx4 v[192:195], v3, s[52:55], s78 offen offset:0 sc1
    v_exp_f32 v128, v128
    v_exp_f32 v129, v129
    v_exp_f32 v130, v130
    v_exp_f32 v131, v131
    v_mfma_f32_32x32x16_bf16 v[48:63], v[216:219], v[144:147], v[48:63]
    buffer_load_dwordx4 v[196:199], v3, s[52:55], s78 offen offset:1024 sc1
    v_exp_f32 v132, v132
    v_exp_f32 v133, v133
    v_exp_f32 v134, v134
    v_exp_f32 v135, v135
    v_cvt_pk_bf16_f32 v152, v128, v129
    v_cvt_pk_bf16_f32 v153, v130, v131
    v_mfma_f32_32x32x16_bf16 v[112:127], v[212:215], v[36:39], v[112:127]
    buffer_load_dwordx4 v[200:203], v3, s[52:55], s78 offen offset:2048 sc1
    v_exp_f32 v136, v136
    v_exp_f32 v137, v137
    v_exp_f32 v138, v138
    v_exp_f32 v139, v139
    v_cvt_pk_bf16_f32 v154, v132, v133
    v_cvt_pk_bf16_f32 v155, v134, v135
    v_mfma_f32_32x32x16_bf16 v[48:63], v[220:223], v[148:151], v[48:63]
    buffer_load_dwordx4 v[204:207], v3, s[52:55], s78 offen offset:3072 sc1
    s_add_u32 s78, s78, 4096
    v_exp_f32 v140, v140
    v_exp_f32 v141, v141
    v_exp_f32 v142, v142
    v_exp_f32 v143, v143
    v_cvt_pk_bf16_f32 v156, v136, v137
    v_cvt_pk_bf16_f32 v157, v138, v139
    v_cvt_pk_bf16_f32 v158, v140, v141
    v_cvt_pk_bf16_f32 v159, v142, v143
    v_mfma_f32_32x32x16_bf16 v[128:143], v[208:211], v[40:43], 0
    v_exp_f32 v112, v112
    v_exp_f32 v113, v113
    v_exp_f32 v114, v114
    v_exp_f32 v115, v115
    v_mfma_f32_32x32x16_bf16 v[64:79], v[216:219], v[152:155], v[64:79]
    v_exp_f32 v116, v116
    v_exp_f32 v117, v117
    v_exp_f32 v118, v118
    v_exp_f32 v119, v119
    v_cvt_pk_bf16_f32 v144, v112, v113
    v_cvt_pk_bf16_f32 v145, v114, v115
    v_mfma_f32_32x32x16_bf16 v[128:143], v[212:215], v[44:47], v[128:143]
    v_exp_f32 v120, v120
    v_exp_f32 v121, v121
    v_exp_f32 v122, v122
    v_exp_f32 v123, v123
    v_cvt_pk_bf16_f32 v146, v116, v117
    v_cvt_pk_bf16_f32 v147, v118, v119
    v_mfma_f32_32x32x16_bf16 v[64:79], v[220:223], v[156:159], v[64:79]
    v_exp_f32 v124, v124
    v_exp_f32 v125, v125
    v_exp_f32 v126, v126
    v_exp_f32 v127, v127
    v_cvt_pk_bf16_f32 v148, v120, v121
    v_cvt_pk_bf16_f32 v149, v122, v123
    v_cvt_pk_bf16_f32 v150, v124, v125
    v_cvt_pk_bf16_f32 v151, v126, v127
    s_waitcnt vmcnt(16)
    s_nop 0
    v_mfma_f32_32x32x16_bf16 v[112:127], v[224:227], v[16:19], 0
    v_exp_f32 v128, v128
    v_exp_f32 v129, v129
    v_exp_f32 v130, v130
    v_exp_f32 v131, v131
    v_mfma_f32_32x32x16_bf16 v[80:95], v[216:219], v[144:147], v[80:95]
    v_exp_f32 v132, v132
    v_exp_f32 v133, v133
    v_exp_f32 v134, v134
    v_exp_f32 v135, v135
    v_cvt_pk_bf16_f32 v152, v128, v129
    v_cvt_pk_bf16_f32 v153, v130, v131
    v_mfma_f32_32x32x16_bf16 v[112:127], v[228:231], v[20:23], v[112:127]
    v_exp_f32 v136, v136
    v_exp_f32 v137, v137
    v_exp_f32 v138, v138
    v_exp_f32 v139, v139
    v_cvt_pk_bf16_f32 v154, v132, v133
    v_cvt_pk_bf16_f32 v155, v134, v135
    v_mfma_f32_32x32x16_bf16 v[80:95], v[220:223], v[148:151], v[80:95]
    v_exp_f32 v140, v140
    v_exp_f32 v141, v141
    v_exp_f32 v142, v142
    v_exp_f32 v143, v143
    v_cvt_pk_bf16_f32 v156, v136, v137
    v_cvt_pk_bf16_f32 v157, v138, v139
    v_cvt_pk_bf16_f32 v158, v140, v141
    v_cvt_pk_bf16_f32 v159, v142, v143
    v_mfma_f32_32x32x16_bf16 v[128:143], v[224:227], v[24:27], 0
    v_exp_f32 v112, v112
    v_exp_f32 v113, v113
    v_exp_f32 v114, v114
    v_exp_f32 v115, v115
    v_mfma_f32_32x32x16_bf16 v[96:111], v[216:219], v[152:155], v[96:111]
    v_exp_f32 v116, v116
    v_exp_f32 v117, v117
    v_exp_f32 v118, v118
    v_exp_f32 v119, v119
    v_cvt_pk_bf16_f32 v144, v112, v113
    v_cvt_pk_bf16_f32 v145, v114, v115
    v_mfma_f32_32x32x16_bf16 v[128:143], v[228:231], v[28:31], v[128:143]
    v_exp_f32 v120, v120
    v_exp_f32 v121, v121
    v_exp_f32 v122, v122
    v_exp_f32 v123, v123
    v_cvt_pk_bf16_f32 v146, v116, v117
    v_cvt_pk_bf16_f32 v147, v118, v119
    v_mfma_f32_32x32x16_bf16 v[96:111], v[220:223], v[156:159], v[96:111]
    v_exp_f32 v124, v124
    v_exp_f32 v125, v125
    v_exp_f32 v126, v126
    v_exp_f32 v127, v127
    v_cvt_pk_bf16_f32 v148, v120, v121
    v_cvt_pk_bf16_f32 v149, v122, v123
    v_cvt_pk_bf16_f32 v150, v124, v125
    v_cvt_pk_bf16_f32 v151, v126, v127
    v_mfma_f32_32x32x16_bf16 v[112:127], v[224:227], v[32:35], 0
    buffer_load_dwordx4 v[208:211], v3, s[52:55], s78 offen offset:0 sc1
    v_exp_f32 v128, v128
    v_exp_f32 v129, v129
    v_exp_f32 v130, v130
    v_exp_f32 v131, v131
    v_mfma_f32_32x32x16_bf16 v[48:63], v[232:235], v[144:147], v[48:63]
    buffer_load_dwordx4 v[212:215], v3, s[52:55], s78 offen offset:1024 sc1
    v_exp_f32 v132, v132
    v_exp_f32 v133, v133
    v_exp_f32 v134, v134
    v_exp_f32 v135, v135
    v_cvt_pk_bf16_f32 v152, v128, v129
    v_cvt_pk_bf16_f32 v153, v130, v131
    v_mfma_f32_32x32x16_bf16 v[112:127], v[228:231], v[36:39], v[112:127]
    buffer_load_dwordx4 v[216:219], v3, s[52:55], s78 offen offset:2048 sc1
    v_exp_f32 v136, v136
    v_exp_f32 v137, v137
    v_exp_f32 v138, v138
    v_exp_f32 v139, v139
    v_cvt_pk_bf16_f32 v154, v132, v133
    v_cvt_pk_bf16_f32 v155, v134, v135
    v_mfma_f32_32x32x16_bf16 v[48:63], v[236:239], v[148:151], v[48:63]
    buffer_load_dwordx4 v[220:223], v3, s[52:55], s78 offen offset:3072 sc1
    s_add_u32 s78, s78, 4096
    v_exp_f32 v140, v140
    v_exp_f32 v141, v141
    v_exp_f32 v142, v142
    v_exp_f32 v143, v143
    v_cvt_pk_bf16_f32 v156, v136, v137
    v_cvt_pk_bf16_f32 v157, v138, v139
    v_cvt_pk_bf16_f32 v158, v140, v141
    v_cvt_pk_bf16_f32 v159, v142, v143
    v_mfma_f32_32x32x16_bf16 v[128:143], v[224:227], v[40:43], 0
    v_exp_f32 v112, v112
    v_exp_f32 v113, v113
    v_exp_f32 v114, v114
    v_exp_f32 v115, v115
    v_mfma_f32_32x32x16_bf16 v[64:79], v[232:235], v[152:155], v[64:79]
    v_exp_f32 v116, v116
    v_exp_f32 v117, v117
    v_exp_f32 v118, v118
    v_exp_f32 v119, v119
    v_cvt_pk_bf16_f32 v144, v112, v113
    v_cvt_pk_bf16_f32 v145, v114, v115
    v_mfma_f32_32x32x16_bf16 v[128:143], v[228:231], v[44:47], v[128:143]
    v_exp_f32 v120, v120
    v_exp_f32 v121, v121
    v_exp_f32 v122, v122
    v_exp_f32 v123, v123
    v_cvt_pk_bf16_f32 v146, v116, v117
    v_cvt_pk_bf16_f32 v147, v118, v119
    v_mfma_f32_32x32x16_bf16 v[64:79], v[236:239], v[156:159], v[64:79]
    v_exp_f32 v124, v124
    v_exp_f32 v125, v125
    v_exp_f32 v126, v126
    v_exp_f32 v127, v127
    v_cvt_pk_bf16_f32 v148, v120, v121
    v_cvt_pk_bf16_f32 v149, v122, v123
    v_cvt_pk_bf16_f32 v150, v124, v125
    v_cvt_pk_bf16_f32 v151, v126, v127
    s_waitcnt vmcnt(16)
    s_nop 0
    v_mfma_f32_32x32x16_bf16 v[112:127], v[240:243], v[16:19], 0
    v_exp_f32 v128, v128
    v_exp_f32 v129, v129
    v_exp_f32 v130, v130
    v_exp_f32 v131, v131
    v_mfma_f32_32x32x16_bf16 v[80:95], v[232:235], v[144:147], v[80:95]
    v_exp_f32 v132, v132
    v_exp_f32 v133, v133
    v_exp_f32 v134, v134
    v_exp_f32 v135, v135
    v_cvt_pk_bf16_f32 v152, v128, v129
    v_cvt_pk_bf16_f32 v153, v130, v131
    v_mfma_f32_32x32x16_bf16 v[112:127], v[244:247], v[20:23], v[112:127]
    v_exp_f32 v136, v136
    v_exp_f32 v137, v137
    v_exp_f32 v138, v138
    v_exp_f32 v139, v139
    v_cvt_pk_bf16_f32 v154, v132, v133
    v_cvt_pk_bf16_f32 v155, v134, v135
    v_mfma_f32_32x32x16_bf16 v[80:95], v[236:239], v[148:151], v[80:95]
    v_exp_f32 v140, v140
    v_exp_f32 v141, v141
    v_exp_f32 v142, v142
    v_exp_f32 v143, v143
    v_cvt_pk_bf16_f32 v156, v136, v137
    v_cvt_pk_bf16_f32 v157, v138, v139
    v_cvt_pk_bf16_f32 v158, v140, v141
    v_cvt_pk_bf16_f32 v159, v142, v143
    v_mfma_f32_32x32x16_bf16 v[128:143], v[240:243], v[24:27], 0
    v_exp_f32 v112, v112
    v_exp_f32 v113, v113
    v_exp_f32 v114, v114
    v_exp_f32 v115, v115
    v_mfma_f32_32x32x16_bf16 v[96:111], v[232:235], v[152:155], v[96:111]
    v_exp_f32 v116, v116
    v_exp_f32 v117, v117
    v_exp_f32 v118, v118
    v_exp_f32 v119, v119
    v_cvt_pk_bf16_f32 v144, v112, v113
    v_cvt_pk_bf16_f32 v145, v114, v115
    v_mfma_f32_32x32x16_bf16 v[128:143], v[244:247], v[28:31], v[128:143]
    v_exp_f32 v120, v120
    v_exp_f32 v121, v121
    v_exp_f32 v122, v122
    v_exp_f32 v123, v123
    v_cvt_pk_bf16_f32 v146, v116, v117
    v_cvt_pk_bf16_f32 v147, v118, v119
    v_mfma_f32_32x32x16_bf16 v[96:111], v[236:239], v[156:159], v[96:111]
    v_exp_f32 v124, v124
    v_exp_f32 v125, v125
    v_exp_f32 v126, v126
    v_exp_f32 v127, v127
    v_cvt_pk_bf16_f32 v148, v120, v121
    v_cvt_pk_bf16_f32 v149, v122, v123
    v_cvt_pk_bf16_f32 v150, v124, v125
    v_cvt_pk_bf16_f32 v151, v126, v127
    v_mfma_f32_32x32x16_bf16 v[112:127], v[240:243], v[32:35], 0
    v_exp_f32 v128, v128
    v_exp_f32 v129, v129
    v_exp_f32 v130, v130
    v_exp_f32 v131, v131
    v_mfma_f32_32x32x16_bf16 v[48:63], v[248:251], v[144:147], v[48:63]
    v_exp_f32 v132, v132
    v_exp_f32 v133, v133
    v_exp_f32 v134, v134
    v_exp_f32 v135, v135
    v_cvt_pk_bf16_f32 v152, v128, v129
    v_cvt_pk_bf16_f32 v153, v130, v131
    v_mfma_f32_32x32x16_bf16 v[112:127], v[244:247], v[36:39], v[112:127]
    v_exp_f32 v136, v136
    v_exp_f32 v137, v137
    v_exp_f32 v138, v138
    v_exp_f32 v139, v139
    v_cvt_pk_bf16_f32 v154, v132, v133
    v_cvt_pk_bf16_f32 v155, v134, v135
    v_mfma_f32_32x32x16_bf16 v[48:63], v[252:255], v[148:151], v[48:63]
    v_exp_f32 v140, v140
    v_exp_f32 v141, v141
    v_exp_f32 v142, v142
    v_exp_f32 v143, v143
    v_cvt_pk_bf16_f32 v156, v136, v137
    v_cvt_pk_bf16_f32 v157, v138, v139
    v_cvt_pk_bf16_f32 v158, v140, v141
    v_cvt_pk_bf16_f32 v159, v142, v143
    v_mfma_f32_32x32x16_bf16 v[128:143], v[240:243], v[40:43], 0
    v_exp_f32 v112, v112
    v_exp_f32 v113, v113
    v_exp_f32 v114, v114
    v_exp_f32 v115, v115
    v_mfma_f32_32x32x16_bf16 v[64:79], v[248:251], v[152:155], v[64:79]
    v_exp_f32 v116, v116
    v_exp_f32 v117, v117
    v_exp_f32 v118, v118
    v_exp_f32 v119, v119
    v_cvt_pk_bf16_f32 v144, v112, v113
    v_cvt_pk_bf16_f32 v145, v114, v115
    v_mfma_f32_32x32x16_bf16 v[128:143], v[244:247], v[44:47], v[128:143]
    v_exp_f32 v120, v120
    v_exp_f32 v121, v121
    v_exp_f32 v122, v122
    v_exp_f32 v123, v123
    v_cvt_pk_bf16_f32 v146, v116, v117
    v_cvt_pk_bf16_f32 v147, v118, v119
    v_mfma_f32_32x32x16_bf16 v[64:79], v[252:255], v[156:159], v[64:79]
    v_exp_f32 v124, v124
    v_exp_f32 v125, v125
    v_exp_f32 v126, v126
    v_exp_f32 v127, v127
    v_cvt_pk_bf16_f32 v148, v120, v121
    v_cvt_pk_bf16_f32 v149, v122, v123
    v_cvt_pk_bf16_f32 v150, v124, v125
    v_cvt_pk_bf16_f32 v151, v126, v127
    s_waitcnt vmcnt(12)
    s_nop 0
    v_mfma_f32_32x32x16_bf16 v[112:127], v[160:163], v[16:19], 0
    v_exp_f32 v128, v128
    v_exp_f32 v129, v129
    v_exp_f32 v130, v130
    v_exp_f32 v131, v131
    v_mfma_f32_32x32x16_bf16 v[80:95], v[248:251], v[144:147], v[80:95]
    v_exp_f32 v132, v132
    v_exp_f32 v133, v133
    v_exp_f32 v134, v134
    v_exp_f32 v135, v135
    v_cvt_pk_bf16_f32 v152, v128, v129
    v_cvt_pk_bf16_f32 v153, v130, v131
    v_mfma_f32_32x32x16_bf16 v[112:127], v[164:167], v[20:23], v[112:127]
    v_exp_f32 v136, v136
    v_exp_f32 v137, v137
    v_exp_f32 v138, v138
    v_exp_f32 v139, v139
    v_cvt_pk_bf16_f32 v154, v132, v133
    v_cvt_pk_bf16_f32 v155, v134, v135
    v_mfma_f32_32x32x16_bf16 v[80:95], v[252:255], v[148:151], v[80:95]
    v_exp_f32 v140, v140
    v_exp_f32 v141, v141
    v_exp_f32 v142, v142
    v_exp_f32 v143, v143
    v_cvt_pk_bf16_f32 v156, v136, v137
    v_cvt_pk_bf16_f32 v157, v138, v139
    v_cvt_pk_bf16_f32 v158, v140, v141
    v_cvt_pk_bf16_f32 v159, v142, v143
    v_mfma_f32_32x32x16_bf16 v[128:143], v[160:163], v[24:27], 0
    v_exp_f32 v112, v112
    v_exp_f32 v113, v113
    v_exp_f32 v114, v114
    v_exp_f32 v115, v115
    v_mfma_f32_32x32x16_bf16 v[96:111], v[248:251], v[152:155], v[96:111]
    v_exp_f32 v116, v116
    v_exp_f32 v117, v117
    v_exp_f32 v118, v118
    v_exp_f32 v119, v119
    v_cvt_pk_bf16_f32 v144, v112, v113
    v_cvt_pk_bf16_f32 v145, v114, v115
    v_mfma_f32_32x32x16_bf16 v[128:143], v[164:167], v[28:31], v[128:143]
    v_exp_f32 v120, v120
    v_exp_f32 v121, v121
    v_exp_f32 v122, v122
    v_exp_f32 v123, v123
    v_cvt_pk_bf16_f32 v146, v116, v117
    v_cvt_pk_bf16_f32 v147, v118, v119
    v_mfma_f32_32x32x16_bf16 v[96:111], v[252:255], v[156:159], v[96:111]
    v_exp_f32 v124, v124
    v_exp_f32 v125, v125
    v_exp_f32 v126, v126
    v_exp_f32 v127, v127
    v_cvt_pk_bf16_f32 v148, v120, v121
    v_cvt_pk_bf16_f32 v149, v122, v123
    v_cvt_pk_bf16_f32 v150, v124, v125
    v_cvt_pk_bf16_f32 v151, v126, v127
    v_mfma_f32_32x32x16_bf16 v[112:127], v[160:163], v[32:35], 0
    s_mov_b64 exec, 1
    ds_add_u32 v1, v2 offset:56
    s_mov_b64 exec, -1
    v_exp_f32 v128, v128
    v_exp_f32 v129, v129
    v_exp_f32 v130, v130
    v_exp_f32 v131, v131
    v_mfma_f32_32x32x16_bf16 v[48:63], v[168:171], v[144:147], v[48:63]
    v_exp_f32 v132, v132
    v_exp_f32 v133, v133
    v_exp_f32 v134, v134
    v_exp_f32 v135, v135
    v_cvt_pk_bf16_f32 v152, v128, v129
    v_cvt_pk_bf16_f32 v153, v130, v131
    v_mfma_f32_32x32x16_bf16 v[112:127], v[164:167], v[36:39], v[112:127]
    v_exp_f32 v136, v136
    v_exp_f32 v137, v137
    v_exp_f32 v138, v138
    v_exp_f32 v139, v139
    v_cvt_pk_bf16_f32 v154, v132, v133
    v_cvt_pk_bf16_f32 v155, v134, v135
    v_mfma_f32_32x32x16_bf16 v[48:63], v[172:175], v[148:151], v[48:63]
    v_exp_f32 v140, v140
    v_exp_f32 v141, v141
    v_exp_f32 v142, v142
    v_exp_f32 v143, v143
    v_cvt_pk_bf16_f32 v156, v136, v137
    v_cvt_pk_bf16_f32 v157, v138, v139
    v_cvt_pk_bf16_f32 v158, v140, v141
    v_cvt_pk_bf16_f32 v159, v142, v143
    v_mfma_f32_32x32x16_bf16 v[128:143], v[160:163], v[40:43], 0
    v_exp_f32 v112, v112
    v_exp_f32 v113, v113
    v_exp_f32 v114, v114
    v_exp_f32 v115, v115
    v_mfma_f32_32x32x16_bf16 v[64:79], v[168:171], v[152:155], v[64:79]
    v_exp_f32 v116, v116
    v_exp_f32 v117, v117
    v_exp_f32 v118, v118
    v_exp_f32 v119, v119
    v_cvt_pk_bf16_f32 v144, v112, v113
    v_cvt_pk_bf16_f32 v145, v114, v115
    v_mfma_f32_32x32x16_bf16 v[128:143], v[164:167], v[44:47], v[128:143]
    v_exp_f32 v120, v120
    v_exp_f32 v121, v121
    v_exp_f32 v122, v122
    v_exp_f32 v123, v123
    v_cvt_pk_bf16_f32 v146, v116, v117
    v_cvt_pk_bf16_f32 v147, v118, v119
    v_mfma_f32_32x32x16_bf16 v[64:79], v[172:175], v[156:159], v[64:79]
    v_exp_f32 v124, v124
    v_exp_f32 v125, v125
    v_exp_f32 v126, v126
    v_exp_f32 v127, v127
    v_cvt_pk_bf16_f32 v148, v120, v121
    v_cvt_pk_bf16_f32 v149, v122, v123
    v_cvt_pk_bf16_f32 v150, v124, v125
    v_cvt_pk_bf16_f32 v151, v126, v127
    s_waitcnt vmcnt(8)
    s_nop 0
    v_mfma_f32_32x32x16_bf16 v[112:127], v[176:179], v[16:19], 0
    v_exp_f32 v128, v128
    v_exp_f32 v129, v129
    v_exp_f32 v130, v130
    v_exp_f32 v131, v131
    v_mfma_f32_32x32x16_bf16 v[80:95], v[168:171], v[144:147], v[80:95]
    v_exp_f32 v132, v132
    v_exp_f32 v133, v133
    v_exp_f32 v134, v134
    v_exp_f32 v135, v135
    v_cvt_pk_bf16_f32 v152, v128, v129
    v_cvt_pk_bf16_f32 v153, v130, v131
    v_mfma_f32_32x32x16_bf16 v[112:127], v[180:183], v[20:23], v[112:127]
    v_exp_f32 v136, v136
    v_exp_f32 v137, v137
    v_exp_f32 v138, v138
    v_exp_f32 v139, v139
    v_cvt_pk_bf16_f32 v154, v132, v133
    v_cvt_pk_bf16_f32 v155, v134, v135
    v_mfma_f32_32x32x16_bf16 v[80:95], v[172:175], v[148:151], v[80:95]
    v_exp_f32 v140, v140
    v_exp_f32 v141, v141
    v_exp_f32 v142, v142
    v_exp_f32 v143, v143
    v_cvt_pk_bf16_f32 v156, v136, v137
    v_cvt_pk_bf16_f32 v157, v138, v139
    v_cvt_pk_bf16_f32 v158, v140, v141
    v_cvt_pk_bf16_f32 v159, v142, v143
    v_mfma_f32_32x32x16_bf16 v[128:143], v[176:179], v[24:27], 0
    v_exp_f32 v112, v112
    v_exp_f32 v113, v113
    v_exp_f32 v114, v114
    v_exp_f32 v115, v115
    v_mfma_f32_32x32x16_bf16 v[96:111], v[168:171], v[152:155], v[96:111]
    v_exp_f32 v116, v116
    v_exp_f32 v117, v117
    v_exp_f32 v118, v118
    v_exp_f32 v119, v119
    v_cvt_pk_bf16_f32 v144, v112, v113
    v_cvt_pk_bf16_f32 v145, v114, v115
    v_mfma_f32_32x32x16_bf16 v[128:143], v[180:183], v[28:31], v[128:143]
    v_exp_f32 v120, v120
    v_exp_f32 v121, v121
    v_exp_f32 v122, v122
    v_exp_f32 v123, v123
    v_cvt_pk_bf16_f32 v146, v116, v117
    v_cvt_pk_bf16_f32 v147, v118, v119
    v_mfma_f32_32x32x16_bf16 v[96:111], v[172:175], v[156:159], v[96:111]
    v_exp_f32 v124, v124
    v_exp_f32 v125, v125
    v_exp_f32 v126, v126
    v_exp_f32 v127, v127
    v_cvt_pk_bf16_f32 v148, v120, v121
    v_cvt_pk_bf16_f32 v149, v122, v123
    v_cvt_pk_bf16_f32 v150, v124, v125
    v_cvt_pk_bf16_f32 v151, v126, v127
    v_mfma_f32_32x32x16_bf16 v[112:127], v[176:179], v[32:35], 0
    v_exp_f32 v128, v128
    v_exp_f32 v129, v129
    v_exp_f32 v130, v130
    v_exp_f32 v131, v131
    v_mfma_f32_32x32x16_bf16 v[48:63], v[184:187], v[144:147], v[48:63]
    v_exp_f32 v132, v132
    v_exp_f32 v133, v133
    v_exp_f32 v134, v134
    v_exp_f32 v135, v135
    v_cvt_pk_bf16_f32 v152, v128, v129
    v_cvt_pk_bf16_f32 v153, v130, v131
    v_mfma_f32_32x32x16_bf16 v[112:127], v[180:183], v[36:39], v[112:127]
    v_exp_f32 v136, v136
    v_exp_f32 v137, v137
    v_exp_f32 v138, v138
    v_exp_f32 v139, v139
    v_cvt_pk_bf16_f32 v154, v132, v133
    v_cvt_pk_bf16_f32 v155, v134, v135
    v_mfma_f32_32x32x16_bf16 v[48:63], v[188:191], v[148:151], v[48:63]
    v_exp_f32 v140, v140
    v_exp_f32 v141, v141
    v_exp_f32 v142, v142
    v_exp_f32 v143, v143
    v_cvt_pk_bf16_f32 v156, v136, v137
    v_cvt_pk_bf16_f32 v157, v138, v139
    v_cvt_pk_bf16_f32 v158, v140, v141
    v_cvt_pk_bf16_f32 v159, v142, v143
    v_mfma_f32_32x32x16_bf16 v[128:143], v[176:179], v[40:43], 0
    v_exp_f32 v112, v112
    v_exp_f32 v113, v113
    v_exp_f32 v114, v114
    v_exp_f32 v115, v115
    v_mfma_f32_32x32x16_bf16 v[64:79], v[184:187], v[152:155], v[64:79]
    v_exp_f32 v116, v116
    v_exp_f32 v117, v117
    v_exp_f32 v118, v118
    v_exp_f32 v119, v119
    v_cvt_pk_bf16_f32 v144, v112, v113
    v_cvt_pk_bf16_f32 v145, v114, v115
    v_mfma_f32_32x32x16_bf16 v[128:143], v[180:183], v[44:47], v[128:143]
    v_exp_f32 v120, v120
    v_exp_f32 v121, v121
    v_exp_f32 v122, v122
    v_exp_f32 v123, v123
    v_cvt_pk_bf16_f32 v146, v116, v117
    v_cvt_pk_bf16_f32 v147, v118, v119
    v_mfma_f32_32x32x16_bf16 v[64:79], v[188:191], v[156:159], v[64:79]
    v_exp_f32 v124, v124
    v_exp_f32 v125, v125
    v_exp_f32 v126, v126
    v_exp_f32 v127, v127
    v_cvt_pk_bf16_f32 v148, v120, v121
    v_cvt_pk_bf16_f32 v149, v122, v123
    v_cvt_pk_bf16_f32 v150, v124, v125
    v_cvt_pk_bf16_f32 v151, v126, v127
    s_waitcnt vmcnt(4)
    s_nop 0
    v_mfma_f32_32x32x16_bf16 v[112:127], v[192:195], v[16:19], 0
    v_exp_f32 v128, v128
    v_exp_f32 v129, v129
    v_exp_f32 v130, v130
    v_exp_f32 v131, v131
    v_mfma_f32_32x32x16_bf16 v[80:95], v[184:187], v[144:147], v[80:95]
    v_exp_f32 v132, v132
    v_exp_f32 v133, v133
    v_exp_f32 v134, v134
    v_exp_f32 v135, v135
    v_cvt_pk_bf16_f32 v152, v128, v129
    v_cvt_pk_bf16_f32 v153, v130, v131
    v_mfma_f32_32x32x16_bf16 v[112:127], v[196:199], v[20:23], v[112:127]
    v_exp_f32 v136, v136
    v_exp_f32 v137, v137
    v_exp_f32 v138, v138
    v_exp_f32 v139, v139
    v_cvt_pk_bf16_f32 v154, v132, v133
    v_cvt_pk_bf16_f32 v155, v134, v135
    v_mfma_f32_32x32x16_bf16 v[80:95], v[188:191], v[148:151], v[80:95]
    v_exp_f32 v140, v140
    v_exp_f32 v141, v141
    v_exp_f32 v142, v142
    v_exp_f32 v143, v143
    v_cvt_pk_bf16_f32 v156, v136, v137
    v_cvt_pk_bf16_f32 v157, v138, v139
    v_cvt_pk_bf16_f32 v158, v140, v141
    v_cvt_pk_bf16_f32 v159, v142, v143
    v_mfma_f32_32x32x16_bf16 v[128:143], v[192:195], v[24:27], 0
    v_exp_f32 v112, v112
    v_exp_f32 v113, v113
    v_exp_f32 v114, v114
    v_exp_f32 v115, v115
    v_mfma_f32_32x32x16_bf16 v[96:111], v[184:187], v[152:155], v[96:111]
    v_exp_f32 v116, v116
    v_exp_f32 v117, v117
    v_exp_f32 v118, v118
    v_exp_f32 v119, v119
    v_cvt_pk_bf16_f32 v144, v112, v113
    v_cvt_pk_bf16_f32 v145, v114, v115
    v_mfma_f32_32x32x16_bf16 v[128:143], v[196:199], v[28:31], v[128:143]
    v_exp_f32 v120, v120
    v_exp_f32 v121, v121
    v_exp_f32 v122, v122
    v_exp_f32 v123, v123
    v_cvt_pk_bf16_f32 v146, v116, v117
    v_cvt_pk_bf16_f32 v147, v118, v119
    v_mfma_f32_32x32x16_bf16 v[96:111], v[188:191], v[156:159], v[96:111]
    v_exp_f32 v124, v124
    v_exp_f32 v125, v125
    v_exp_f32 v126, v126
    v_exp_f32 v127, v127
    v_cvt_pk_bf16_f32 v148, v120, v121
    v_cvt_pk_bf16_f32 v149, v122, v123
    v_cvt_pk_bf16_f32 v150, v124, v125
    v_cvt_pk_bf16_f32 v151, v126, v127
    v_mfma_f32_32x32x16_bf16 v[112:127], v[192:195], v[32:35], 0
    v_exp_f32 v128, v128
    v_exp_f32 v129, v129
    v_exp_f32 v130, v130
    v_exp_f32 v131, v131
    v_mfma_f32_32x32x16_bf16 v[48:63], v[200:203], v[144:147], v[48:63]
    v_exp_f32 v132, v132
    v_exp_f32 v133, v133
    v_exp_f32 v134, v134
    v_exp_f32 v135, v135
    v_cvt_pk_bf16_f32 v152, v128, v129
    v_cvt_pk_bf16_f32 v153, v130, v131
    v_mfma_f32_32x32x16_bf16 v[112:127], v[196:199], v[36:39], v[112:127]
    v_exp_f32 v136, v136
    v_exp_f32 v137, v137
    v_exp_f32 v138, v138
    v_exp_f32 v139, v139
    v_cvt_pk_bf16_f32 v154, v132, v133
    v_cvt_pk_bf16_f32 v155, v134, v135
    v_mfma_f32_32x32x16_bf16 v[48:63], v[204:207], v[148:151], v[48:63]
    v_exp_f32 v140, v140
    v_exp_f32 v141, v141
    v_exp_f32 v142, v142
    v_exp_f32 v143, v143
    v_cvt_pk_bf16_f32 v156, v136, v137
    v_cvt_pk_bf16_f32 v157, v138, v139
    v_cvt_pk_bf16_f32 v158, v140, v141
    v_cvt_pk_bf16_f32 v159, v142, v143
    v_mfma_f32_32x32x16_bf16 v[128:143], v[192:195], v[40:43], 0
    ds_read_b32 v7, v1 offset:32
    v_exp_f32 v112, v112
    v_exp_f32 v113, v113
    v_exp_f32 v114, v114
    v_exp_f32 v115, v115
    v_mfma_f32_32x32x16_bf16 v[64:79], v[200:203], v[152:155], v[64:79]
    v_exp_f32 v116, v116
    v_exp_f32 v117, v117
    v_exp_f32 v118, v118
    v_exp_f32 v119, v119
    v_cvt_pk_bf16_f32 v144, v112, v113
    v_cvt_pk_bf16_f32 v145, v114, v115
    v_mfma_f32_32x32x16_bf16 v[128:143], v[196:199], v[44:47], v[128:143]
    v_exp_f32 v120, v120
    v_exp_f32 v121, v121
    v_exp_f32 v122, v122
    v_exp_f32 v123, v123
    v_cvt_pk_bf16_f32 v146, v116, v117
    v_cvt_pk_bf16_f32 v147, v118, v119
    v_mfma_f32_32x32x16_bf16 v[64:79], v[204:207], v[156:159], v[64:79]
    v_exp_f32 v124, v124
    v_exp_f32 v125, v125
    v_exp_f32 v126, v126
    v_exp_f32 v127, v127
    v_cvt_pk_bf16_f32 v148, v120, v121
    v_cvt_pk_bf16_f32 v149, v122, v123
    v_cvt_pk_bf16_f32 v150, v124, v125
    v_cvt_pk_bf16_f32 v151, v126, v127
    s_waitcnt vmcnt(0)
    s_nop 0
    v_mfma_f32_32x32x16_bf16 v[112:127], v[208:211], v[24:27], 0
    s_waitcnt lgkmcnt(0)
    v_readfirstlane_b32 s71, v7
    s_cmp_ge_u32 s71, 40
    s_cbranch_scc1 LD_31
    s_mov_b32 s3, 0x40000
LW_32:
    ds_read_b32 v7, v1 offset:32
    s_waitcnt lgkmcnt(0)
    v_readfirstlane_b32 s71, v7
    s_cmp_ge_u32 s71, 40
    s_cbranch_scc1 LD_33
    s_sleep 1
    s_sub_u32 s3, s3, 1
    s_cmp_lg_u32 s3, 0
    s_cbranch_scc1 LW_32
LD_33:
LD_31:
    s_mul_i32 s72, s61, 12288
    v_add_u32 v4, s72, v3
    v_exp_f32 v128, v128
    v_exp_f32 v129, v129
    v_exp_f32 v130, v130
    v_exp_f32 v131, v131
    v_mfma_f32_32x32x16_bf16 v[80:95], v[200:203], v[144:147], v[80:95]
    v_exp_f32 v132, v132
    v_exp_f32 v133, v133
    v_exp_f32 v134, v134
    v_exp_f32 v135, v135
    v_cvt_pk_bf16_f32 v152, v128, v129
    v_cvt_pk_bf16_f32 v153, v130, v131
    v_mfma_f32_32x32x16_bf16 v[112:127], v[212:215], v[28:31], v[112:127]
    v_exp_f32 v136, v136
    v_exp_f32 v137, v137
    v_exp_f32 v138, v138
    v_exp_f32 v139, v139
    v_cvt_pk_bf16_f32 v154, v132, v133
    v_cvt_pk_bf16_f32 v155, v134, v135
    v_mfma_f32_32x32x16_bf16 v[80:95], v[204:207], v[148:151], v[80:95]
    v_exp_f32 v140, v140
    v_exp_f32 v141, v141
    v_exp_f32 v142, v142
    v_exp_f32 v143, v143
    v_cvt_pk_bf16_f32 v156, v136, v137
    v_cvt_pk_bf16_f32 v157, v138, v139
    v_cvt_pk_bf16_f32 v158, v140, v141
    v_cvt_pk_bf16_f32 v159, v142, v143
    v_mfma_f32_32x32x16_bf16 v[128:143], v[208:211], v[32:35], 0
    v_exp_f32 v112, v112
    v_exp_f32 v113, v113
    v_exp_f32 v114, v114
    v_exp_f32 v115, v115
    v_mfma_f32_32x32x16_bf16 v[96:111], v[200:203], v[152:155], v[96:111]
    v_exp_f32 v116, v116
    v_exp_f32 v117, v117
    v_exp_f32 v118, v118
    v_exp_f32 v119, v119
    v_cvt_pk_bf16_f32 v144, v112, v113
    v_cvt_pk_bf16_f32 v145, v114, v115
    v_mfma_f32_32x32x16_bf16 v[128:143], v[212:215], v[36:39], v[128:143]
    v_exp_f32 v120, v120
    v_exp_f32 v121, v121
    v_exp_f32 v122, v122
    v_exp_f32 v123, v123
    v_cvt_pk_bf16_f32 v146, v116, v117
    v_cvt_pk_bf16_f32 v147, v118, v119
    v_mfma_f32_32x32x16_bf16 v[96:111], v[204:207], v[156:159], v[96:111]
    v_exp_f32 v124, v124
    v_exp_f32 v125, v125
    v_exp_f32 v126, v126
    v_exp_f32 v127, v127
    v_cvt_pk_bf16_f32 v148, v120, v121
    v_cvt_pk_bf16_f32 v149, v122, v123
    v_cvt_pk_bf16_f32 v150, v124, v125
    v_cvt_pk_bf16_f32 v151, v126, v127
    v_mfma_f32_32x32x16_bf16 v[112:127], v[208:211], v[40:43], 0
    v_and_b32 v10, 15, v0
    v_lshlrev_b32 v10, 7, v10
    v_add_u32 v10, 6400, v10
    buffer_load_dword v11, v10, s[52:55], 0 offen sc1
    v_exp_f32 v128, v128
    v_exp_f32 v129, v129
    v_exp_f32 v130, v130
    v_exp_f32 v131, v131
    v_mfma_f32_32x32x16_bf16 v[64:79], v[216:219], v[144:147], v[64:79]
    v_exp_f32 v132, v132
    v_exp_f32 v133, v133
    v_exp_f32 v134, v134
    v_exp_f32 v135, v135
    v_cvt_pk_bf16_f32 v152, v128, v129
    v_cvt_pk_bf16_f32 v153, v130, v131
    v_mfma_f32_32x32x16_bf16 v[112:127], v[212:215], v[44:47], v[112:127]
    v_exp_f32 v136, v136
    v_exp_f32 v137, v137
    v_exp_f32 v138, v138
    v_exp_f32 v139, v139
    v_cvt_pk_bf16_f32 v154, v132, v133
    v_cvt_pk_bf16_f32 v155, v134, v135
    v_mfma_f32_32x32x16_bf16 v[64:79], v[220:223], v[148:151], v[64:79]
    v_exp_f32 v140, v140
    v_exp_f32 v141, v141
    v_exp_f32 v142, v142
    v_exp_f32 v143, v143
    v_cvt_pk_bf16_f32 v156, v136, v137
    v_cvt_pk_bf16_f32 v157, v138, v139
    v_cvt_pk_bf16_f32 v158, v140, v141
    v_cvt_pk_bf16_f32 v159, v142, v143
    v_mfma_f32_32x32x16_bf16 v[128:143], v[208:211], v[16:19], 0
    v_exp_f32 v112, v112
    v_exp_f32 v113, v113
    v_exp_f32 v114, v114
    v_exp_f32 v115, v115
    v_mfma_f32_32x32x16_bf16 v[80:95], v[216:219], v[152:155], v[80:95]
    v_exp_f32 v116, v116
    v_exp_f32 v117, v117
    v_exp_f32 v118, v118
    v_exp_f32 v119, v119
    v_cvt_pk_bf16_f32 v144, v112, v113
    v_cvt_pk_bf16_f32 v145, v114, v115
    v_mfma_f32_32x32x16_bf16 v[128:143], v[212:215], v[20:23], v[128:143]
    ds_write_b128 v4, v[64:67] offset:0
    ds_write_b128 v4, v[68:71] offset:1024
    v_exp_f32 v120, v120
    v_exp_f32 v121, v121
    v_exp_f32 v122, v122
    v_exp_f32 v123, v123
    v_cvt_pk_bf16_f32 v146, v116, v117
    v_cvt_pk_bf16_f32 v147, v118, v119
    v_mfma_f32_32x32x16_bf16 v[80:95], v[220:223], v[156:159], v[80:95]
    ds_write_b128 v4, v[72:75] offset:2048
    ds_write_b128 v4, v[76:79] offset:3072
    v_exp_f32 v124, v124
    v_exp_f32 v125, v125
    v_exp_f32 v126, v126
    v_exp_f32 v127, v127
    v_cvt_pk_bf16_f32 v148, v120, v121
    v_cvt_pk_bf16_f32 v149, v122, v123
    v_cvt_pk_bf16_f32 v150, v124, v125
    v_cvt_pk_bf16_f32 v151, v126, v127
    v_exp_f32 v128, v128
    v_exp_f32 v129, v129
    v_exp_f32 v130, v130
    v_exp_f32 v131, v131
    v_mfma_f32_32x32x16_bf16 v[96:111], v[216:219], v[144:147], v[96:111]
    v_exp_f32 v132, v132
    v_exp_f32 v133, v133
    v_exp_f32 v134, v134
    v_exp_f32 v135, v135
    v_cvt_pk_bf16_f32 v152, v128, v129
    v_cvt_pk_bf16_f32 v153, v130, v131
    ds_write_b128 v4, v[80:83] offset:4096
    ds_write_b128 v4, v[84:87] offset:5120
    v_exp_f32 v136, v136
    v_exp_f32 v137, v137
    v_exp_f32 v138, v138
    v_exp_f32 v139, v139
    v_cvt_pk_bf16_f32 v154, v132, v133
    v_cvt_pk_bf16_f32 v155, v134, v135
    v_mfma_f32_32x32x16_bf16 v[96:111], v[220:223], v[148:151], v[96:111]
    ds_write_b128 v4, v[88:91] offset:6144
    ds_write_b128 v4, v[92:95] offset:7168
    v_exp_f32 v140, v140
    v_exp_f32 v141, v141
    v_exp_f32 v142, v142
    v_exp_f32 v143, v143
    v_cvt_pk_bf16_f32 v156, v136, v137
    v_cvt_pk_bf16_f32 v157, v138, v139
    v_cvt_pk_bf16_f32 v158, v140, v141
    v_cvt_pk_bf16_f32 v159, v142, v143
    s_setprio 3
    v_mfma_f32_32x32x16_bf16 v[48:63], v[216:219], v[152:155], v[48:63]
    v_mfma_f32_32x32x16_bf16 v[48:63], v[220:223], v[156:159], v[48:63]
    ds_write_b128 v4, v[96:99] offset:8192
    ds_write_b128 v4, v[100:103] offset:9216
    ds_write_b128 v4, v[104:107] offset:10240
    ds_write_b128 v4, v[108:111] offset:11264
    s_mov_b32 s73, 0x5f800000
    s_mov_b32 exec_lo, 0
    v_cmp_ngt_f32 vcc, s73, v76
    v_cmp_ngt_f32 s[74:75], s73, v92
    s_or_b64 vcc, vcc, s[74:75]
    v_cmp_ngt_f32 s[74:75], s73, v108
    s_or_b64 vcc, vcc, s[74:75]
    s_nop 2
    v_cmp_ngt_f32 s[74:75], s73, v60
    s_or_b64 vcc, vcc, s[74:75]
    s_mov_b32 exec_lo, -1
    s_cbranch_vccz L_34
    ds_write_b32 v1, v2 offset:12
L_34:
    s_xor_b32 s72, s61, 1
    s_mul_i32 s72, s72, 12288
    s_add_u32 s72, s72, 0
    v_add_u32 v5, s72, v3
    s_xor_b32 s72, s61, 2
    s_mul_i32 s72, s72, 12288
    s_add_u32 s72, s72, 4096
    v_add_u32 v6, s72, v3
    s_xor_b32 s72, s61, 3
    s_mul_i32 s72, s72, 12288
    s_add_u32 s72, s72, 8192
    v_add_u32 v7, s72, v3
    s_mov_b64 exec, 1
    ds_add_u32 v1, v2 offset:8
    s_mov_b64 exec, -1
    s_mov_b32 s3, 0x40000
LW_35:
    ds_read_b64 v[8:9], v1 offset:8
    s_waitcnt lgkmcnt(0)
    v_readfirstlane_b32 s71, v8
    v_readfirstlane_b32 s72, v9
    s_cmp_ge_u32 s71, s21
    s_cbranch_scc1 LD_36
    s_sub_u32 s3, s3, 1
    s_cmp_lg_u32 s3, 0
    s_cbranch_scc1 LW_35
LD_36:
    s_cmp_lg_u32 s21, 4
    s_cbranch_scc1 L_37
    s_cmp_lg_u32 s72, 0
    s_cbranch_scc1 L_redo
L_37:
    ds_read_b128 v[76:79], v5 offset:3072
    ds_read_b128 v[64:67], v5 offset:0
    ds_read_b128 v[68:71], v5 offset:1024
    ds_read_b128 v[72:75], v5 offset:2048
    ds_read_b128 v[92:95], v6 offset:3072
    ds_read_b128 v[80:83], v6 offset:0
    ds_read_b128 v[84:87], v6 offset:1024
    ds_read_b128 v[88:91], v6 offset:2048
    ds_read_b128 v[108:111], v7 offset:3072
    ds_read_b128 v[96:99], v7 offset:0
    ds_read_b128 v[100:103], v7 offset:1024
    ds_read_b128 v[104:107], v7 offset:2048
    s_waitcnt lgkmcnt(8)
    v_add_f32 v60, v60, v76
    v_add_f32 v48, v48, v64
    v_add_f32 v49, v49, v65
    v_add_f32 v50, v50, v66
    v_add_f32 v51, v51, v67
    v_add_f32 v52, v52, v68
    v_add_f32 v53, v53, v69
    v_add_f32 v54, v54, v70
    v_add_f32 v55, v55, v71
    v_add_f32 v56, v56, v72
    v_add_f32 v57, v57, v73
    v_add_f32 v58, v58, v74
    v_add_f32 v59, v59, v75
    v_add_f32 v61, v61, v77
    v_add_f32 v62, v62, v78
    v_add_f32 v63, v63, v79
    s_waitcnt lgkmcnt(4)
    v_add_f32 v60, v60, v92
    v_add_f32 v48, v48, v80
    v_add_f32 v49, v49, v81
    v_add_f32 v50, v50, v82
    v_add_f32 v51, v51, v83
    v_add_f32 v52, v52, v84
    v_add_f32 v53, v53, v85
    v_add_f32 v54, v54, v86
    v_add_f32 v55, v55, v87
    v_add_f32 v56, v56, v88
    v_add_f32 v57, v57, v89
    v_add_f32 v58, v58, v90
    v_add_f32 v59, v59, v91
    v_add_f32 v61, v61, v93
    v_add_f32 v62, v62, v94
    v_add_f32 v63, v63, v95
    s_waitcnt lgkmcnt(0)
    s_mov_b64 exec, 1
    ds_add_u32 v1, v2 offset:16
    s_mov_b64 exec, -1
    v_add_f32 v60, v60, v108
    v_mov_b32 v8, v60
    v_mov_b32 v9, v60
    v_add_f32 v48, v48, v96
    v_add_f32 v49, v49, v97
    v_permlane32_swap_b32 v8, v9
    v_rcp_f32 v8, v9
    v_add_f32 v50, v50, v98
    v_add_f32 v51, v51, v99
    v_mul_f32 v8, 0x2d800000, v8
    v_add_f32 v52, v52, v100
    v_add_f32 v53, v53, v101
    v_add_f32 v54, v54, v102
    v_add_f32 v55, v55, v103
    v_add_f32 v56, v56, v104
    v_add_f32 v57, v57, v105
    v_add_f32 v58, v58, v106
    v_add_f32 v59, v59, v107
    v_add_f32 v61, v61, v109
    v_add_f32 v62, v62, v110
    v_add_f32 v63, v63, v111
    v_mul_f32 v48, v8, v48
    v_mul_f32 v49, v8, v49
    v_mul_f32 v50, v8, v50
    v_mul_f32 v51, v8, v51
    v_cvt_pk_bf16_f32 v144, v48, v49
    v_mul_f32 v52, v8, v52
    v_mul_f32 v53, v8, v53
    v_cvt_pk_bf16_f32 v145, v50, v51
    v_mul_f32 v54, v8, v54
    v_mul_f32 v55, v8, v55
    v_cvt_pk_bf16_f32 v146, v52, v53
    v_mul_f32 v56, v8, v56
    v_mul_f32 v57, v8, v57
    v_cvt_pk_bf16_f32 v147, v54, v55
    buffer_store_dwordx4 v[144:147], v3, s[52:55], s35 offen sc1
    v_mul_f32 v58, v8, v58
    v_mul_f32 v59, v8, v59
    v_cvt_pk_bf16_f32 v148, v56, v57
    v_mul_f32 v60, v8, v60
    v_mul_f32 v61, v8, v61
    v_cvt_pk_bf16_f32 v149, v58, v59
    v_mul_f32 v62, v8, v62
    v_mul_f32 v63, v8, v63
    v_cvt_pk_bf16_f32 v150, v60, v61
    v_cvt_pk_bf16_f32 v151, v62, v63
    s_mov_b32 exec_lo, 0
    v_mov_b32 v150, 0
    v_mov_b32 v151, 0
    s_mov_b32 exec_lo, -1
    buffer_store_dwordx4 v[148:151], v3, s[52:55], s35 offen offset:1024 sc1
    s_cmp_ge_u32 s70, 28
    s_cbranch_scc1 L_attn_end
    s_mov_b32 s44, s8
    s_mov_b32 s45, s9
    s_mov_b32 s46, 401408
    s_mov_b32 s47, 0x20000
    v_lshrrev_b32 v12, 3, v0
    v_mul_u32_u24 v12, 896, v12
    v_and_b32 v13, 7, v0
    v_bfe_u32 v14, v0, 4, 1
    v_lshlrev_b32 v14, 2, v14
    v_xor_b32 v13, v13, v14
    v_lshl_add_u32 v12, v13, 4, v12
    s_mul_i32 s80, s61, 100352
    s_lshl_b32 s72, s68, 7
    s_add_u32 s80, s80, s72
    s_mul_i32 s79, s61, 17408
    s_mov_b32 s3, 0x40000
LW_38:
    ds_read_b32 v7, v1 offset:16
    s_waitcnt lgkmcnt(0)
    v_readfirstlane_b32 s71, v7
    s_cmp_ge_u32 s71, 4
    s_cbranch_scc1 LD_39
    s_sub_u32 s3, s3, 1
    s_cmp_lg_u32 s3, 0
    s_cbranch_scc1 LW_38
LD_39:
    s_add_u32 m0, s79, 0
    s_add_u32 s75, s80, 0
    buffer_load_dwordx4 v12, s[44:47], s75 offen lds
    s_add_u32 m0, s79, 1024
    s_add_u32 s75, s80, 7168
    buffer_load_dwordx4 v12, s[44:47], s75 offen lds
    s_add_u32 m0, s79, 2048
    s_add_u32 s75, s80, 14336
    buffer_load_dwordx4 v12, s[44:47], s75 offen lds
    s_add_u32 m0, s79, 3072
    s_add_u32 s75, s80, 21504
    buffer_load_dwordx4 v12, s[44:47], s75 offen lds
    s_add_u32 m0, s79, 4096
    s_add_u32 s75, s80, 28672
    buffer_load_dwordx4 v12, s[44:47], s75 offen lds
    s_add_u32 m0, s79, 5120
    s_add_u32 s75, s80, 35840
    buffer_load_dwordx4 v12, s[44:47], s75 offen lds
    s_add_u32 m0, s79, 6144
    s_add_u32 s75, s80, 43008
    buffer_load_dwordx4 v12, s[44:47], s75 offen lds
    s_add_u32 m0, s79, 7168
    s_add_u32 s75, s80, 50176
    buffer_load_dwordx4 v12, s[44:47], s75 offen lds
    s_add_u32 m0, s79, 8192
    s_add_u32 s75, s80, 57344
    buffer_load_dwordx4 v12, s[44:47], s75 offen lds
    s_add_u32 m0, s79, 9216
    s_add_u32 s75, s80, 64512
    buffer_load_dwordx4 v12, s[44:47], s75 offen lds
    s_add_u32 m0, s79, 10240
    s_add_u32 s75, s80, 71680
    buffer_load_dwordx4 v12, s[44:47], s75 offen lds
    s_add_u32 m0, s79, 11264
    s_add_u32 s75, s80, 78848
    buffer_load_dwordx4 v12, s[44:47], s75 offen lds
    s_add_u32 m0, s79, 12288
    s_add_u32 s75, s80, 86016
    buffer_load_dwordx4 v12, s[44:47], s75 offen lds
    s_add_u32 m0, s79, 13312
    s_add_u32 s75, s80, 93184
    buffer_load_dwordx4 v12, s[44:47], s75 offen lds
    s_add_u32 m0, s79, 14336
    s_add_u32 s75, s80, 100352
    buffer_load_dwordx4 v12, s[44:47], s75 offen lds
    v_lshrrev_b32 v5, 5, v0
    v_bfe_u32 v6, v0, 2, 2
    v_lshl_add_u32 v13, v5, 2, v6
    v_lshlrev_b32 v13, 7, v13
    v_bfe_u32 v14, v0, 4, 1
    v_and_b32 v6, 2, v6
    v_xor_b32 v6, v6, v14
    v_lshl_add_u32 v13, v6, 5, v13
    v_and_b32 v6, 3, v0
    v_lshl_add_u32 v13, v6, 3, v13
    v_xor_b32 v14, 64, v13
    v_add_u32 v13, s79, v13
    v_add_u32 v14, s79, v14
    v_add_u32 v4, s79, v3
    s_lshl_b32 s72, s61, 3
    s_lshl_b32 s33, s67, 6
    s_add_u32 s33, s33, s72
    s_lshl_b32 s33, s33, 10
    s_add_u32 s33, s33, 16777216
    s_add_u32 s34, s33, 32768
    s_add_u32 s38, s33, 4096
    s_add_u32 s39, s34, 4096
    s_waitcnt vmcnt(17)
    v_cmp_ne_u32 vcc, s69, v11
    s_cbranch_vccz L_40
    s_mov_b32 s3, 32768
GP_41:
    buffer_load_dword v11, v10, s[52:55], 0 offen sc1
    s_waitcnt vmcnt(0)
    v_cmp_ne_u32 vcc, s69, v11
    s_cbranch_vccz GD_42
    s_sleep 2
    s_sub_u32 s3, s3, 1
    s_cmp_lg_u32 s3, 0
    s_cbranch_scc1 GP_41
GD_42:
L_40:
    s_mov_b32 s37, 0
    s_mov_b64 s[74:75], -1
    s_mov_b32 s3, 32768
    buffer_load_dwordx4 v[16:19], v3, s[52:55], s33 offen offset:0 sc1
    buffer_load_dwordx4 v[20:23], v3, s[52:55], s34 offen offset:0 sc1
    buffer_load_dwordx4 v[24:27], v3, s[52:55], s33 offen offset:1024 sc1
    buffer_load_dwordx4 v[28:31], v3, s[52:55], s34 offen offset:1024 sc1
    buffer_load_dwordx4 v[32:35], v3, s[52:55], s33 offen offset:2048 sc1
    buffer_load_dwordx4 v[36:39], v3, s[52:55], s34 offen offset:2048 sc1
    buffer_load_dwordx4 v[40:43], v3, s[52:55], s33 offen offset:3072 sc1
    buffer_load_dwordx4 v[44:47], v3, s[52:55], s34 offen offset:3072 sc1
    buffer_load_dwordx4 v[48:51], v3, s[52:55], s38 offen offset:0 sc1
    buffer_load_dwordx4 v[52:55], v3, s[52:55], s39 offen offset:0 sc1
    buffer_load_dwordx4 v[56:59], v3, s[52:55], s38 offen offset:1024 sc1
    buffer_load_dwordx4 v[60:63], v3, s[52:55], s39 offen offset:1024 sc1
    buffer_load_dwordx4 v[64:67], v3, s[52:55], s38 offen offset:2048 sc1
    buffer_load_dwordx4 v[68:71], v3, s[52:55], s39 offen offset:2048 sc1
    buffer_load_dwordx4 v[72:75], v3, s[52:55], s38 offen offset:3072 sc1
    buffer_load_dwordx4 v[76:79], v3, s[52:55], s39 offen offset:3072 sc1
    v_mov_b32 v80, 0
    v_mov_b32 v81, 0
    v_mov_b32 v82, 0
    v_mov_b32 v83, 0
    v_mov_b32 v84, 0
    v_mov_b32 v85, 0
    v_mov_b32 v86, 0
    v_mov_b32 v87, 0
    v_mov_b32 v88, 0
    v_mov_b32 v89, 0
    v_mov_b32 v90, 0
    v_mov_b32 v91, 0
    v_mov_b32 v92, 0
    v_mov_b32 v93, 0
    v_mov_b32 v94, 0
    v_mov_b32 v95, 0
    v_mov_b32 v96, 0
    v_mov_b32 v97, 0
    v_mov_b32 v98, 0
    v_mov_b32 v99, 0
    v_mov_b32 v100, 0
    v_mov_b32 v101, 0
    v_mov_b32 v102, 0
    v_mov_b32 v103, 0
    v_mov_b32 v104, 0
    v_mov_b32 v105, 0
    v_mov_b32 v106, 0
    v_mov_b32 v107, 0
    v_mov_b32 v108, 0
    v_mov_b32 v109, 0
    v_mov_b32 v110, 0
    v_mov_b32 v111, 0
    v_mov_b32 v112, 0
    v_mov_b32 v113, 0
    v_mov_b32 v114, 0
    v_mov_b32 v115, 0
    v_mov_b32 v116, 0
    v_mov_b32 v117, 0
    v_mov_b32 v118, 0
    v_mov_b32 v119, 0
    v_mov_b32 v120, 0
    v_mov_b32 v121, 0
    v_mov_b32 v122, 0
    v_mov_b32 v123, 0
    v_mov_b32 v124, 0
    v_mov_b32 v125, 0
    v_mov_b32 v126, 0
    v_mov_b32 v127, 0
    v_mov_b32 v128, 0
    v_mov_b32 v129, 0
    v_mov_b32 v130, 0
    v_mov_b32 v131, 0
    v_mov_b32 v132, 0
    v_mov_b32 v133, 0
    v_mov_b32 v134, 0
    v_mov_b32 v135, 0
    v_mov_b32 v136, 0
    v_mov_b32 v137, 0
    v_mov_b32 v138, 0
    v_mov_b32 v139, 0
    v_mov_b32 v140, 0
    v_mov_b32 v141, 0
    v_mov_b32 v142, 0
    v_mov_b32 v143, 0
    s_waitcnt vmcnt(16)
    ds_read_b64_tr_b16 v[160:161], v13 offset:0
    ds_read_b64_tr_b16 v[162:163], v13 offset:1024
    ds_read_b64_tr_b16 v[164:165], v14 offset:0
    ds_read_b64_tr_b16 v[166:167], v14 offset:1024
    ds_read_b64_tr_b16 v[168:169], v13 offset:2048
    ds_read_b64_tr_b16 v[170:171], v13 offset:3072
    ds_read_b64_tr_b16 v[172:173], v14 offset:2048
    ds_read_b64_tr_b16 v[174:175], v14 offset:3072
    s_waitcnt lgkmcnt(4)
    ds_read_b64_tr_b16 v[176:177], v13 offset:3584
    ds_read_b64_tr_b16 v[178:179], v13 offset:4608
    ds_read_b64_tr_b16 v[180:181], v14 offset:3584
    ds_read_b64_tr_b16 v[182:183], v14 offset:4608
    ds_read_b64_tr_b16 v[184:185], v13 offset:5632
    ds_read_b64_tr_b16 v[186:187], v13 offset:6656
    ds_read_b64_tr_b16 v[188:189], v14 offset:5632
    ds_read_b64_tr_b16 v[190:191], v14 offset:6656
    s_waitcnt lgkmcnt(4)
    ds_read_b64_tr_b16 v[192:193], v13 offset:7168
    ds_read_b64_tr_b16 v[194:195], v13 offset:8192
    ds_read_b64_tr_b16 v[196:197], v14 offset:7168
    ds_read_b64_tr_b16 v[198:199], v14 offset:8192
    ds_read_b64_tr_b16 v[200:201], v13 offset:9216
    ds_read_b64_tr_b16 v[202:203], v13 offset:10240
    ds_read_b64_tr_b16 v[204:205], v14 offset:9216
    ds_read_b64_tr_b16 v[206:207], v14 offset:10240
    s_waitcnt lgkmcnt(4)
    ds_read_b64_tr_b16 v[208:209], v13 offset:10752
    ds_read_b64_tr_b16 v[210:211], v13 offset:11776
    ds_read_b64_tr_b16 v[212:213], v14 offset:10752
    ds_read_b64_tr_b16 v[214:215], v14 offset:11776
    ds_read_b64_tr_b16 v[216:217], v13 offset:12800
    ds_read_b64_tr_b16 v[218:219], v13 offset:13824
    ds_read_b64_tr_b16 v[220:221], v14 offset:12800
    ds_read_b64_tr_b16 v[222:223], v14 offset:13824
    s_waitcnt lgkmcnt(0)
    s_waitcnt vmcnt(14)
    v_max3_u32 v8, v16, v17, v18
    v_max3_u32 v9, v19, v20, v21
    v_max3_u32 v8, v8, v22, v23
    v_max_u32 v8, v8, v9
    v_cmp_eq_u32 vcc, -1, v8
    s_and_b64 vcc, vcc, s[74:75]
    s_cbranch_vccnz LO_43
    v_mfma_f32_32x32x16_bf16 v[80:95], v[160:163], v[16:19], v[80:95]
    v_mfma_f32_32x32x16_bf16 v[112:127], v[160:163], v[20:23], v[112:127]
    v_mfma_f32_32x32x16_bf16 v[96:111], v[164:167], v[16:19], v[96:111]
    v_mfma_f32_32x32x16_bf16 v[128:143], v[164:167], v[20:23], v[128:143]
    s_bitset1_b32 s37, 0
LO_43:
    s_waitcnt vmcnt(12)
    v_max3_u32 v8, v24, v25, v26
    v_max3_u32 v9, v27, v28, v29
    v_max3_u32 v8, v8, v30, v31
    v_max_u32 v8, v8, v9
    v_cmp_eq_u32 vcc, -1, v8
    s_and_b64 vcc, vcc, s[74:75]
    s_cbranch_vccnz LO_44
    v_mfma_f32_32x32x16_bf16 v[80:95], v[168:171], v[24:27], v[80:95]
    v_mfma_f32_32x32x16_bf16 v[112:127], v[168:171], v[28:31], v[112:127]
    v_mfma_f32_32x32x16_bf16 v[96:111], v[172:175], v[24:27], v[96:111]
    v_mfma_f32_32x32x16_bf16 v[128:143], v[172:175], v[28:31], v[128:143]
    s_bitset1_b32 s37, 1
LO_44:
    s_waitcnt vmcnt(10)
    v_max3_u32 v8, v32, v33, v34
    v_max3_u32 v9, v35, v36, v37
    v_max3_u32 v8, v8, v38, v39
    v_max_u32 v8, v8, v9
    v_cmp_eq_u32 vcc, -1, v8
    s_and_b64 vcc, vcc, s[74:75]
    s_cbranch_vccnz LO_45
    v_mfma_f32_32x32x16_bf16 v[80:95], v[176:179], v[32:35], v[80:95]
    v_mfma_f32_32x32x16_bf16 v[112:127], v[176:179], v[36:39], v[112:127]
    v_mfma_f32_32x32x16_bf16 v[96:111], v[180:183], v[32:35], v[96:111]
    v_mfma_f32_32x32x16_bf16 v[128:143], v[180:183], v[36:39], v[128:143]
    s_bitset1_b32 s37, 2
LO_45:
    s_waitcnt vmcnt(8)
    v_max3_u32 v8, v40, v41, v42
    v_max3_u32 v9, v43, v44, v45
    v_max3_u32 v8, v8, v46, v47
    v_max_u32 v8, v8, v9
    v_cmp_eq_u32 vcc, -1, v8
    s_and_b64 vcc, vcc, s[74:75]
    s_cbranch_vccnz LO_46
    v_mfma_f32_32x32x16_bf16 v[80:95], v[184:187], v[40:43], v[80:95]
    v_mfma_f32_32x32x16_bf16 v[112:127], v[184:187], v[44:47], v[112:127]
    v_mfma_f32_32x32x16_bf16 v[96:111], v[188:191], v[40:43], v[96:111]
    v_mfma_f32_32x32x16_bf16 v[128:143], v[188:191], v[44:47], v[128:143]
    s_bitset1_b32 s37, 3
LO_46:
    s_waitcnt vmcnt(6)
    v_max3_u32 v8, v48, v49, v50
    v_max3_u32 v9, v51, v52, v53
    v_max3_u32 v8, v8, v54, v55
    v_max_u32 v8, v8, v9
    v_cmp_eq_u32 vcc, -1, v8
    s_and_b64 vcc, vcc, s[74:75]
    s_cbranch_vccnz LO_47
    v_mfma_f32_32x32x16_bf16 v[80:95], v[192:195], v[48:51], v[80:95]
    v_mfma_f32_32x32x16_bf16 v[112:127], v[192:195], v[52:55], v[112:127]
    v_mfma_f32_32x32x16_bf16 v[96:111], v[196:199], v[48:51], v[96:111]
    v_mfma_f32_32x32x16_bf16 v[128:143], v[196:199], v[52:55], v[128:143]
    s_bitset1_b32 s37, 4
LO_47:
    s_waitcnt vmcnt(4)
    v_max3_u32 v8, v56, v57, v58
    v_max3_u32 v9, v59, v60, v61
    v_max3_u32 v8, v8, v62, v63
    v_max_u32 v8, v8, v9
    v_cmp_eq_u32 vcc, -1, v8
    s_and_b64 vcc, vcc, s[74:75]
    s_cbranch_vccnz LO_48
    v_mfma_f32_32x32x16_bf16 v[80:95], v[200:203], v[56:59], v[80:95]
    v_mfma_f32_32x32x16_bf16 v[112:127], v[200:203], v[60:63], v[112:127]
    v_mfma_f32_32x32x16_bf16 v[96:111], v[204:207], v[56:59], v[96:111]
    v_mfma_f32_32x32x16_bf16 v[128:143], v[204:207], v[60:63], v[128:143]
    s_bitset1_b32 s37, 5
LO_48:
    s_waitcnt vmcnt(2)
    v_max3_u32 v8, v64, v65, v66
    v_max3_u32 v9, v67, v68, v69
    v_max3_u32 v8, v8, v70, v71
    v_max_u32 v8, v8, v9
    v_cmp_eq_u32 vcc, -1, v8
    s_and_b64 vcc, vcc, s[74:75]
    s_cbranch_vccnz LO_49
    v_mfma_f32_32x32x16_bf16 v[80:95], v[208:211], v[64:67], v[80:95]
    v_mfma_f32_32x32x16_bf16 v[112:127], v[208:211], v[68:71], v[112:127]
    v_mfma_f32_32x32x16_bf16 v[96:111], v[212:215], v[64:67], v[96:111]
    v_mfma_f32_32x32x16_bf16 v[128:143], v[212:215], v[68:71], v[128:143]
    s_bitset1_b32 s37, 6
LO_49:
    s_waitcnt vmcnt(0)
    v_max3_u32 v8, v72, v73, v74
    v_max3_u32 v9, v75, v76, v77
    v_max3_u32 v8, v8, v78, v79
    v_max_u32 v8, v8, v9
    v_cmp_eq_u32 vcc, -1, v8
    s_and_b64 vcc, vcc, s[74:75]
    s_cbranch_vccnz LO_50
    v_mfma_f32_32x32x16_bf16 v[80:95], v[216:219], v[72:75], v[80:95]
    v_mfma_f32_32x32x16_bf16 v[112:127], v[216:219], v[76:79], v[112:127]
    v_mfma_f32_32x32x16_bf16 v[96:111], v[220:223], v[72:75], v[96:111]
    v_mfma_f32_32x32x16_bf16 v[128:143], v[220:223], v[76:79], v[128:143]
    s_bitset1_b32 s37, 7
LO_50:
L_o_again:
    s_cmp_eq_u32 s37, 0xff
    s_cbranch_scc1 L_o_done
    s_sleep 4
LO_51:
    s_sub_u32 s3, s3, 1
    s_cmp_lg_u32 s3, 0
    s_cselect_b64 s[74:75], -1, 0
    s_bitcmp1_b32 s37, 0
    s_cbranch_scc1 LO_52
    buffer_load_dwordx4 v[16:19], v3, s[52:55], s33 offen offset:0 sc1
    buffer_load_dwordx4 v[20:23], v3, s[52:55], s34 offen offset:0 sc1
LO_52:
    s_bitcmp1_b32 s37, 1
    s_cbranch_scc1 LO_53
    buffer_load_dwordx4 v[24:27], v3, s[52:55], s33 offen offset:1024 sc1
    buffer_load_dwordx4 v[28:31], v3, s[52:55], s34 offen offset:1024 sc1
LO_53:
    s_bitcmp1_b32 s37, 2
    s_cbranch_scc1 LO_54
    buffer_load_dwordx4 v[32:35], v3, s[52:55], s33 offen offset:2048 sc1
    buffer_load_dwordx4 v[36:39], v3, s[52:55], s34 offen offset:2048 sc1
LO_54:
    s_bitcmp1_b32 s37, 3
    s_cbranch_scc1 LO_55
    buffer_load_dwordx4 v[40:43], v3, s[52:55], s33 offen offset:3072 sc1
    buffer_load_dwordx4 v[44:47], v3, s[52:55], s34 offen offset:3072 sc1
LO_55:
    s_bitcmp1_b32 s37, 4
    s_cbranch_scc1 LO_56
    buffer_load_dwordx4 v[48:51], v3, s[52:55], s38 offen offset:0 sc1
    buffer_load_dwordx4 v[52:55], v3, s[52:55], s39 offen offset:0 sc1
LO_56:
    s_bitcmp1_b32 s37, 5
    s_cbranch_scc1 LO_57
    buffer_load_dwordx4 v[56:59], v3, s[52:55], s38 offen offset:1024 sc1
    buffer_load_dwordx4 v[60:63], v3, s[52:55], s39 offen offset:1024 sc1
LO_57:
    s_bitcmp1_b32 s37, 6
    s_cbranch_scc1 LO_58
    buffer_load_dwordx4 v[64:67], v3, s[52:55], s38 offen offset:2048 sc1
    buffer_load_dwordx4 v[68:71], v3, s[52:55], s39 offen offset:2048 sc1
LO_58:
    s_bitcmp1_b32 s37, 7
    s_cbranch_scc1 LO_59
    buffer_load_dwordx4 v[72:75], v3, s[52:55], s38 offen offset:3072 sc1
    buffer_load_dwordx4 v[76:79], v3, s[52:55], s39 offen offset:3072 sc1
LO_59:
    s_waitcnt vmcnt(0)
    s_bitcmp1_b32 s37, 0
    s_cbranch_scc1 LO_60
    v_max3_u32 v8, v16, v17, v18
    v_max3_u32 v9, v19, v20, v21
    v_max3_u32 v8, v8, v22, v23
    v_max_u32 v8, v8, v9
    v_cmp_eq_u32 vcc, -1, v8
    s_and_b64 vcc, vcc, s[74:75]
    s_cbranch_vccnz LO_61
    v_mfma_f32_32x32x16_bf16 v[80:95], v[160:163], v[16:19], v[80:95]
    v_mfma_f32_32x32x16_bf16 v[112:127], v[160:163], v[20:23], v[112:127]
    v_mfma_f32_32x32x16_bf16 v[96:111], v[164:167], v[16:19], v[96:111]
    v_mfma_f32_32x32x16_bf16 v[128:143], v[164:167], v[20:23], v[128:143]
    s_bitset1_b32 s37, 0
LO_61:
LO_60:
    s_bitcmp1_b32 s37, 1
    s_cbranch_scc1 LO_62
    v_max3_u32 v8, v24, v25, v26
    v_max3_u32 v9, v27, v28, v29
    v_max3_u32 v8, v8, v30, v31
    v_max_u32 v8, v8, v9
    v_cmp_eq_u32 vcc, -1, v8
    s_and_b64 vcc, vcc, s[74:75]
    s_cbranch_vccnz LO_63
    v_mfma_f32_32x32x16_bf16 v[80:95], v[168:171], v[24:27], v[80:95]
    v_mfma_f32_32x32x16_bf16 v[112:127], v[168:171], v[28:31], v[112:127]
    v_mfma_f32_32x32x16_bf16 v[96:111], v[172:175], v[24:27], v[96:111]
    v_mfma_f32_32x32x16_bf16 v[128:143], v[172:175], v[28:31], v[128:143]
    s_bitset1_b32 s37, 1
LO_63:
LO_62:
    s_bitcmp1_b32 s37, 2
    s_cbranch_scc1 LO_64
    v_max3_u32 v8, v32, v33, v34
    v_max3_u32 v9, v35, v36, v37
    v_max3_u32 v8, v8, v38, v39
    v_max_u32 v8, v8, v9
    v_cmp_eq_u32 vcc, -1, v8
    s_and_b64 vcc, vcc, s[74:75]
    s_cbranch_vccnz LO_65
    v_mfma_f32_32x32x16_bf16 v[80:95], v[176:179], v[32:35], v[80:95]
    v_mfma_f32_32x32x16_bf16 v[112:127], v[176:179], v[36:39], v[112:127]
    v_mfma_f32_32x32x16_bf16 v[96:111], v[180:183], v[32:35], v[96:111]
    v_mfma_f32_32x32x16_bf16 v[128:143], v[180:183], v[36:39], v[128:143]
    s_bitset1_b32 s37, 2
LO_65:
LO_64:
    s_bitcmp1_b32 s37, 3
    s_cbranch_scc1 LO_66
    v_max3_u32 v8, v40, v41, v42
    v_max3_u32 v9, v43, v44, v45
    v_max3_u32 v8, v8, v46, v47
    v_max_u32 v8, v8, v9
    v_cmp_eq_u32 vcc, -1, v8
    s_and_b64 vcc, vcc, s[74:75]
    s_cbranch_vccnz LO_67
    v_mfma_f32_32x32x16_bf16 v[80:95], v[184:187], v[40:43], v[80:95]
    v_mfma_f32_32x32x16_bf16 v[112:127], v[184:187], v[44:47], v[112:127]
    v_mfma_f32_32x32x16_bf16 v[96:111], v[188:191], v[40:43], v[96:111]
    v_mfma_f32_32x32x16_bf16 v[128:143], v[188:191], v[44:47], v[128:143]
    s_bitset1_b32 s37, 3
LO_67:
LO_66:
    s_bitcmp1_b32 s37, 4
    s_cbranch_scc1 LO_68
    v_max3_u32 v8, v48, v49, v50
    v_max3_u32 v9, v51, v52, v53
    v_max3_u32 v8, v8, v54, v55
    v_max_u32 v8, v8, v9
    v_cmp_eq_u32 vcc, -1, v8
    s_and_b64 vcc, vcc, s[74:75]
    s_cbranch_vccnz LO_69
    v_mfma_f32_32x32x16_bf16 v[80:95], v[192:195], v[48:51], v[80:95]
    v_mfma_f32_32x32x16_bf16 v[112:127], v[192:195], v[52:55], v[112:127]
    v_mfma_f32_32x32x16_bf16 v[96:111], v[196:199], v[48:51], v[96:111]
    v_mfma_f32_32x32x16_bf16 v[128:143], v[196:199], v[52:55], v[128:143]
    s_bitset1_b32 s37, 4
LO_69:
LO_68:
    s_bitcmp1_b32 s37, 5
    s_cbranch_scc1 LO_70
    v_max3_u32 v8, v56, v57, v58
    v_max3_u32 v9, v59, v60, v61
    v_max3_u32 v8, v8, v62, v63
    v_max_u32 v8, v8, v9
    v_cmp_eq_u32 vcc, -1, v8
    s_and_b64 vcc, vcc, s[74:75]
    s_cbranch_vccnz LO_71
    v_mfma_f32_32x32x16_bf16 v[80:95], v[200:203], v[56:59], v[80:95]
    v_mfma_f32_32x32x16_bf16 v[112:127], v[200:203], v[60:63], v[112:127]
    v_mfma_f32_32x32x16_bf16 v[96:111], v[204:207], v[56:59], v[96:111]
    v_mfma_f32_32x32x16_bf16 v[128:143], v[204:207], v[60:63], v[128:143]
    s_bitset1_b32 s37, 5
LO_71:
LO_70:
    s_bitcmp1_b32 s37, 6
    s_cbranch_scc1 LO_72
    v_max3_u32 v8, v64, v65, v66
    v_max3_u32 v9, v67, v68, v69
    v_max3_u32 v8, v8, v70, v71
    v_max_u32 v8, v8, v9
    v_cmp_eq_u32 vcc, -1, v8
    s_and_b64 vcc, vcc, s[74:75]
    s_cbranch_vccnz LO_73
    v_mfma_f32_32x32x16_bf16 v[80:95], v[208:211], v[64:67], v[80:95]
    v_mfma_f32_32x32x16_bf16 v[112:127], v[208:211], v[68:71], v[112:127]
    v_mfma_f32_32x32x16_bf16 v[96:111], v[212:215], v[64:67], v[96:111]
    v_mfma_f32_32x32x16_bf16 v[128:143], v[212:215], v[68:71], v[128:143]
    s_bitset1_b32 s37, 6
LO_73:
LO_72:
    s_bitcmp1_b32 s37, 7
    s_cbranch_scc1 LO_74
    v_max3_u32 v8, v72, v73, v74
    v_max3_u32 v9, v75, v76, v77
    v_max3_u32 v8, v8, v78, v79
    v_max_u32 v8, v8, v9
    v_cmp_eq_u32 vcc, -1, v8
    s_and_b64 vcc, vcc, s[74:75]
    s_cbranch_vccnz LO_75
    v_mfma_f32_32x32x16_bf16 v[80:95], v[216:219], v[72:75], v[80:95]
    v_mfma_f32_32x32x16_bf16 v[112:127], v[216:219], v[76:79], v[112:127]
    v_mfma_f32_32x32x16_bf16 v[96:111], v[220:223], v[72:75], v[96:111]
    v_mfma_f32_32x32x16_bf16 v[128:143], v[220:223], v[76:79], v[128:143]
    s_bitset1_b32 s37, 7
LO_75:
LO_74:
    s_branch L_o_again
L_o_done:
    s_nop 7
    ds_write_b128 v4, v[80:83] offset:0
    ds_write_b128 v4, v[84:87] offset:1088
    ds_write_b128 v4, v[88:91] offset:2176
    ds_write_b128 v4, v[92:95] offset:3264
    ds_write_b128 v4, v[112:115] offset:8704
    ds_write_b128 v4, v[116:119] offset:9792
    ds_write_b128 v4, v[120:123] offset:10880
    ds_write_b128 v4, v[124:127] offset:11968
    ds_write_b128 v4, v[96:99] offset:4352
    ds_write_b128 v4, v[100:103] offset:5440
    ds_write_b128 v4, v[104:107] offset:6528
    ds_write_b128 v4, v[108:111] offset:7616
    ds_write_b128 v4, v[128:131] offset:13056
    ds_write_b128 v4, v[132:135] offset:14144
    ds_write_b128 v4, v[136:139] offset:15232
    ds_write_b128 v4, v[140:143] offset:16320
    s_mov_b64 exec, 1
    ds_add_u32 v1, v2 offset:60
    s_mov_b64 exec, -1
L_attn_end:
    s_lshl_b32 s72, s2, 3
    s_add_u32 s72, s72, s60
    s_cmp_lg_u32 s72, 1
    s_cbranch_scc1 L_76
    v_and_b32 v4, 15, v0
    v_lshlrev_b32 v4, 7, v4
    v_add_u32 v4, 6400, v4
    s_mov_b32 s3, 32768
GP_77:
    buffer_load_dword v8, v4, s[52:55], 0 offen sc1
    s_waitcnt vmcnt(0)
    v_cmp_ne_u32 vcc, s69, v8
    s_cbranch_vccz GD_78
    s_sleep 2
    s_sub_u32 s3, s3, 1
    s_cmp_lg_u32 s3, 0
    s_cbranch_scc1 GP_77
GD_78:
    s_mov_b64 exec, 1
    v_mov_b32 v4, 0
    v_mov_b32 v5, s69
    buffer_store_dword v5, v4, s[52:55], 0 offen sc1
    s_mov_b64 exec, -1
L_76:
    s_endpgm
L_redo:
    s_mov_b32 s21, 8
    s_waitcnt vmcnt(0)
    s_mov_b32 exec_lo, 0
    v_mov_b32 v22, 0
    v_mov_b32 v23, 0
    v_mov_b32 v30, 0
    v_mov_b32 v31, 0
    v_mov_b32 v38, 0
    v_mov_b32 v39, 0
    v_mov_b32 v46, 0
    v_mov_b32 v47, 0
    s_mov_b32 exec_lo, -1
    v_mov_b32 v248, 0xff800000
    v_mov_b32 v249, 0xff800000
    v_mov_b32 v250, 0xff800000
    v_mov_b32 v251, 0xff800000
    s_mov_b32 s78, s77
    s_mov_b32 s80, 16
L_redo_loop:
    buffer_load_dwordx4 v[224:227], v3, s[52:55], s78 offen sc1
    buffer_load_dwordx4 v[228:231], v3, s[52:55], s78 offen offset:1024 sc1
    s_waitcnt vmcnt(0)
    v_mfma_f32_32x32x16_bf16 v[112:127], v[224:227], v[16:19], 0
    v_mfma_f32_32x32x16_bf16 v[112:127], v[228:231], v[20:23], v[112:127]
    v_mfma_f32_32x32x16_bf16 v[128:143], v[224:227], v[24:27], 0
    v_mfma_f32_32x32x16_bf16 v[128:143], v[228:231], v[28:31], v[128:143]
    v_mfma_f32_32x32x16_bf16 v[232:247], v[224:227], v[32:35], 0
    v_mfma_f32_32x32x16_bf16 v[232:247], v[228:231], v[36:39], v[232:247]
    v_mfma_f32_32x32x16_bf16 v[208:223], v[224:227], v[40:43], 0
    v_mfma_f32_32x32x16_bf16 v[208:223], v[228:231], v[44:47], v[208:223]
    s_nop 15
    v_max3_f32 v248, v248, v112, v113
    v_max3_f32 v248, v248, v114, v115
    v_max3_f32 v248, v248, v116, v117
    v_max3_f32 v248, v248, v118, v119
    v_max3_f32 v248, v248, v120, v121
    v_max3_f32 v248, v248, v122, v123
    v_max3_f32 v248, v248, v124, v125
    v_max3_f32 v248, v248, v126, v127
    v_max3_f32 v249, v249, v128, v129
    v_max3_f32 v249, v249, v130, v131
    v_max3_f32 v249, v249, v132, v133
    v_max3_f32 v249, v249, v134, v135
    v_max3_f32 v249, v249, v136, v137
    v_max3_f32 v249, v249, v138, v139
    v_max3_f32 v249, v249, v140, v141
    v_max3_f32 v249, v249, v142, v143
    v_max3_f32 v250, v250, v232, v233
    v_max3_f32 v250, v250, v234, v235
    v_max3_f32 v250, v250, v236, v237
    v_max3_f32 v250, v250, v238, v239
    v_max3_f32 v250, v250, v240, v241
    v_max3_f32 v250, v250, v242, v243
    v_max3_f32 v250, v250, v244, v245
    v_max3_f32 v250, v250, v246, v247
    v_max3_f32 v251, v251, v208, v209
    v_max3_f32 v251, v251, v210, v211
    v_max3_f32 v251, v251, v212, v213
    v_max3_f32 v251, v251, v214, v215
    v_max3_f32 v251, v251, v216, v217
    v_max3_f32 v251, v251, v218, v219
    v_max3_f32 v251, v251, v220, v221
    v_max3_f32 v251, v251, v222, v223
    s_add_u32 s78, s78, 4096
    s_sub_u32 s80, s80, 1
    s_cmp_lg_u32 s80, 0
    s_cbranch_scc1 L_redo_loop
    s_xor_b32 s72, s61, 0
    s_lshl_b32 s72, s72, 10
    s_lshl_b32 s73, s61, 2
    s_add_u32 s72, s72, s73
    v_add_u32 v4, s72, v3
    ds_write_b32 v4, v248
    s_xor_b32 s72, s61, 1
    s_lshl_b32 s72, s72, 10
    s_lshl_b32 s73, s61, 2
    s_add_u32 s72, s72, s73
    v_add_u32 v4, s72, v3
    ds_write_b32 v4, v249
    s_xor_b32 s72, s61, 2
    s_lshl_b32 s72, s72, 10
    s_lshl_b32 s73, s61, 2
    s_add_u32 s72, s72, s73
    v_add_u32 v4, s72, v3
    ds_write_b32 v4, v250
    s_xor_b32 s72, s61, 3
    s_lshl_b32 s72, s72, 10
    s_lshl_b32 s73, s61, 2
    s_add_u32 s72, s72, s73
    v_add_u32 v4, s72, v3
    ds_write_b32 v4, v251
    s_waitcnt lgkmcnt(0)
    s_mov_b64 exec, 1
    ds_add_u32 v1, v2 offset:20
    s_mov_b64 exec, -1
    s_mov_b32 s3, 0x40000
LW_79:
    ds_read_b32 v7, v1 offset:20
    s_waitcnt lgkmcnt(0)
    v_readfirstlane_b32 s71, v7
    s_cmp_ge_u32 s71, 4
    s_cbranch_scc1 LD_80
    s_sleep 1
    s_sub_u32 s3, s3, 1
    s_cmp_lg_u32 s3, 0
    s_cbranch_scc1 LW_79
LD_80:
    s_xor_b32 s72, s61, 0
    s_lshl_b32 s72, s72, 10
    v_add_u32 v4, s72, v3
    ds_read_b128 v[112:115], v4
    s_xor_b32 s72, s61, 1
    s_lshl_b32 s72, s72, 10
    v_add_u32 v4, s72, v3
    ds_read_b128 v[116:119], v4
    s_xor_b32 s72, s61, 2
    s_lshl_b32 s72, s72, 10
    v_add_u32 v4, s72, v3
    ds_read_b128 v[120:123], v4
    s_xor_b32 s72, s61, 3
    s_lshl_b32 s72, s72, 10
    v_add_u32 v4, s72, v3
    ds_read_b128 v[124:127], v4
    buffer_load_dwordx4 v[160:163], v3, s[52:55], s77 offen offset:0 sc1
    buffer_load_dwordx4 v[164:167], v3, s[52:55], s77 offen offset:1024 sc1
    buffer_load_dwordx4 v[168:171], v3, s[52:55], s77 offen offset:2048 sc1
    buffer_load_dwordx4 v[172:175], v3, s[52:55], s77 offen offset:3072 sc1
    s_add_u32 s78, s77, 4096
    buffer_load_dwordx4 v[176:179], v3, s[52:55], s78 offen offset:0 sc1
    buffer_load_dwordx4 v[180:183], v3, s[52:55], s78 offen offset:1024 sc1
    buffer_load_dwordx4 v[184:187], v3, s[52:55], s78 offen offset:2048 sc1
    buffer_load_dwordx4 v[188:191], v3, s[52:55], s78 offen offset:3072 sc1
    s_add_u32 s78, s77, 8192
    buffer_load_dwordx4 v[192:195], v3, s[52:55], s78 offen offset:0 sc1
    buffer_load_dwordx4 v[196:199], v3, s[52:55], s78 offen offset:1024 sc1
    buffer_load_dwordx4 v[200:203], v3, s[52:55], s78 offen offset:2048 sc1
    buffer_load_dwordx4 v[204:207], v3, s[52:55], s78 offen offset:3072 sc1
    s_waitcnt lgkmcnt(0)
    v_max3_f32 v248, v112, v113, v114
    v_max_f32 v248, v248, v115
    v_max3_f32 v249, v116, v117, v118
    v_max_f32 v249, v249, v119
    v_max3_f32 v250, v120, v121, v122
    v_max_f32 v250, v250, v123
    v_max3_f32 v251, v124, v125, v126
    v_max_f32 v251, v251, v127
    s_mov_b64 exec, 1
    ds_add_u32 v1, v2 offset:20
    s_mov_b64 exec, -1
    v_mov_b32 v252, v248
    v_mov_b32 v253, v249
    v_mov_b32 v254, v250
    v_mov_b32 v255, v251
    s_nop 1
    v_permlane32_swap_b32 v248, v252
    v_permlane32_swap_b32 v249, v253
    v_permlane32_swap_b32 v250, v254
    v_permlane32_swap_b32 v251, v255
    s_mov_b32 exec_lo, 0
    s_mov_b32 s72, 0xc2c80000
    v_max_f32 v248, v248, v252
    v_max_f32 v249, v249, v253
    v_max_f32 v250, v250, v254
    v_max_f32 v251, v251, v255
    v_sub_f32 v248, s72, v248
    v_sub_f32 v249, s72, v249
    v_sub_f32 v250, s72, v250
    v_sub_f32 v251, s72, v251
    v_cvt_pk_bf16_f32 v252, v248, v248
    v_cvt_pk_bf16_f32 v253, v249, v249
    v_cvt_pk_bf16_f32 v254, v250, v250
    v_cvt_pk_bf16_f32 v255, v251, v251
    v_lshlrev_b32 v252, 16, v252
    v_lshlrev_b32 v253, 16, v253
    v_lshlrev_b32 v254, 16, v254
    v_lshlrev_b32 v255, 16, v255
    v_sub_f32 v252, v248, v252
    v_sub_f32 v253, v249, v253
    v_sub_f32 v254, v250, v254
    v_sub_f32 v255, v251, v255
    v_cvt_pk_bf16_f32 v22, v248, v252
    v_cvt_pk_bf16_f32 v30, v249, v253
    v_cvt_pk_bf16_f32 v38, v250, v254
    v_cvt_pk_bf16_f32 v46, v251, v255
    v_and_b32 v248, 0xffff0000, v22
    v_and_b32 v249, 0xffff0000, v30
    v_and_b32 v250, 0xffff0000, v38
    v_and_b32 v251, 0xffff0000, v46
    v_sub_f32 v252, v252, v248
    v_sub_f32 v253, v253, v249
    v_sub_f32 v254, v254, v250
    v_sub_f32 v255, v255, v251
    v_cvt_pk_bf16_f32 v23, v252, 0
    v_cvt_pk_bf16_f32 v31, v253, 0
    v_cvt_pk_bf16_f32 v39, v254, 0
    v_cvt_pk_bf16_f32 v47, v255, 0
    s_mov_b32 exec_lo, -1
    s_mov_b32 s3, 0x40000
LW_81:
    ds_read_b32 v7, v1 offset:20
    s_waitcnt lgkmcnt(0)
    v_readfirstlane_b32 s71, v7
    s_cmp_ge_u32 s71, 8
    s_cbranch_scc1 LD_82
    s_sleep 1
    s_sub_u32 s3, s3, 1
    s_cmp_lg_u32 s3, 0
    s_cbranch_scc1 LW_81
LD_82:
    s_branch L_attn_start
L_ffn:
    s_setprio 2
    s_waitcnt lgkmcnt(0)
    s_mov_b32 s24, s4
    s_mov_b32 s25, s5
    s_mov_b32 s26, 1835008
    s_mov_b32 s27, 0x20000
    s_cmp_ge_u32 s61, 2
    s_cselect_b32 s56, s14, s12
    s_cselect_b32 s57, s15, s13
    s_mov_b32 s58, 1605632
    s_mov_b32 s59, 0x20000
    s_mov_b32 s28, s6
    s_mov_b32 s29, s7
    s_mov_b32 s30, 1204224
    s_mov_b32 s31, 0x20000
    s_add_u32 m0, s39, 49152
    s_add_u32 s75, s38, 0
    buffer_load_dwordx4 v180, s[28:31], s75 offen  lds
    s_add_u32 m0, s39, 50176
    s_add_u32 s75, s38, 0
    buffer_load_dwordx4 v181, s[28:31], s75 offen  lds
    s_add_u32 m0, s39, 51200
    s_add_u32 s75, s38, 0
    buffer_load_dwordx4 v182, s[28:31], s75 offen  lds
    s_add_u32 m0, s39, 61440
    s_add_u32 s75, s38, 172032
    buffer_load_dwordx4 v180, s[28:31], s75 offen  lds
    s_add_u32 m0, s39, 62464
    s_add_u32 s75, s38, 172032
    buffer_load_dwordx4 v181, s[28:31], s75 offen  lds
    s_add_u32 m0, s39, 63488
    s_add_u32 s75, s38, 172032
    buffer_load_dwordx4 v182, s[28:31], s75 offen  lds
    s_barrier
    s_mov_b32 s52, s22
    s_mov_b32 s53, s23
    s_mov_b32 s54, 18874368
    s_mov_b32 s55, 0x20000
    v_mov_b32 v255, 0
    buffer_load_dword v255, v255, s[52:55], 0 offen sc1
    s_mov_b32 s40, s16
    s_mov_b32 s41, s17
    s_mov_b32 s42, 1605632
    s_mov_b32 s43, 0x20000
    s_mov_b32 s48, s18
    s_mov_b32 s49, s19
    s_mov_b32 s50, 1835008
    s_mov_b32 s51, 0x20000
    v_and_b32 v10, 31, v0
    v_lshrrev_b32 v11, 5, v0
    s_and_b32 s83, s61, 1
    s_lshr_b32 s34, s61, 1
    v_bfe_u32 v12, v0, 1, 3
    v_lshl_add_u32 v13, s83, 1, v11
    v_lshl_add_u32 v14, v10, 7, s74
    v_xor_b32 v15, 0, v13
    v_xor_b32 v15, v15, v12
    v_lshl_add_u32 v4, v15, 4, v14
    v_xor_b32 v15, 2, v13
    v_xor_b32 v15, v15, v12
    v_lshl_add_u32 v5, v15, 4, v14
    v_xor_b32 v15, 4, v13
    v_xor_b32 v15, v15, v12
    v_lshl_add_u32 v6, v15, 4, v14
    v_xor_b32 v15, 6, v13
    v_xor_b32 v15, v15, v12
    v_lshl_add_u32 v7, v15, 4, v14
    v_and_b32 v12, 15, v0
    v_bfe_u32 v13, v0, 4, 1
    v_cmp_eq_u32 vcc, v12, v13
    v_mov_b32 v12, 0x3f803f80
    v_bfe_u32 v14, v0, 2, 2
    v_lshl_add_u32 v14, v11, 3, v14
    v_and_b32 v15, 3, v0
    v_lshlrev_b32 v15, 3, v15
    v_cndmask_b32 v112, 0, v12, vcc
    v_cndmask_b32 v113, 0, v12, vcc
    v_cndmask_b32 v114, 0, v12, vcc
    v_cndmask_b32 v115, 0, v12, vcc
    v_mul_u32_u24 v14, 224, v14
    v_add_u32 v14, v14, v15
    v_bfe_u32 v13, v0, 4, 1
    v_mul_u32_u24 v13, 7296, v13
    v_add_u32 v14, v14, v13
    v_add_u32 v14, 16384, v14
    s_mul_i32 s72, s83, 3584
    s_sub_u32 s75, 3584, s72
    v_add_u32 v12, s72, v14
    v_add_u32 v13, s75, v14
    v_add_u32 v8, 69632, v12
    v_add_u32 v9, 69632, v13
    v_mov_b32 v1, v183
    v_mov_b32 v2, 161152
    v_mov_b32 v3, 1
    v_mov_b32 v252, v180
    v_mov_b32 v253, v181
    v_mov_b32 v254, v182
    v_mov_b32 v96, 0
    v_mov_b32 v97, 0
    v_mov_b32 v98, 0
    v_mov_b32 v99, 0
    v_mov_b32 v100, 0
    v_mov_b32 v101, 0
    v_mov_b32 v102, 0
    v_mov_b32 v103, 0
    v_mov_b32 v104, 0
    v_mov_b32 v105, 0
    v_mov_b32 v106, 0
    v_mov_b32 v107, 0
    v_mov_b32 v108, 0
    v_mov_b32 v109, 0
    v_mov_b32 v110, 0
    v_mov_b32 v111, 0
    s_waitcnt vmcnt(4)
    s_barrier
    ds_read_b128 v[16:19], v4 offset:0
    ds_read_b128 v[20:23], v5 offset:0
    ds_read_b128 v[24:27], v6 offset:0
    ds_read_b128 v[28:31], v7 offset:0
    s_add_u32 m0, s39, 73728
    s_add_u32 s75, s38, 344064
    buffer_load_dwordx4 v252, s[28:31], s75 offen  lds
    s_add_u32 m0, s39, 74752
    s_add_u32 s75, s38, 344064
    buffer_load_dwordx4 v253, s[28:31], s75 offen  lds
    s_add_u32 m0, s39, 75776
    s_add_u32 s75, s38, 344064
    buffer_load_dwordx4 v254, s[28:31], s75 offen  lds
    s_add_u32 m0, s37, 86016
    s_add_u32 s75, s36, 0
    s_mov_b32 exec_hi, 0xffffff
    buffer_load_dwordx4 v1, s[56:59], s75 offen  lds
    s_mov_b32 exec_hi, -1
    s_add_u32 m0, s37, 86912
    s_add_u32 s75, s36, 14336
    s_mov_b32 exec_hi, 0xffffff
    buffer_load_dwordx4 v1, s[56:59], s75 offen  lds
    s_mov_b32 exec_hi, -1
    s_add_u32 m0, s37, 87808
    s_add_u32 s75, s36, 28672
    s_mov_b32 exec_hi, 0xffffff
    buffer_load_dwordx4 v1, s[56:59], s75 offen  lds
    s_mov_b32 exec_hi, -1
    s_add_u32 m0, s37, 88704
    s_add_u32 s75, s36, 43008
    s_mov_b32 exec_hi, 0xffffff
    buffer_load_dwordx4 v1, s[56:59], s75 offen  lds
    s_mov_b32 exec_hi, -1
    s_waitcnt vmcnt(8)
    s_waitcnt lgkmcnt(0)
    s_barrier
    ds_read_b128 v[32:35], v4 offset:16384
    ds_read_b128 v[36:39], v5 offset:16384
    ds_read_b128 v[40:43], v6 offset:16384
    ds_read_b128 v[44:47], v7 offset:16384
    s_add_u32 m0, s39, 49152
    s_add_u32 s75, s38, 516096
    buffer_load_dwordx4 v252, s[28:31], s75 offen  lds
    s_add_u32 m0, s39, 50176
    s_add_u32 s75, s38, 516096
    buffer_load_dwordx4 v253, s[28:31], s75 offen  lds
    s_add_u32 m0, s39, 51200
    s_add_u32 s75, s38, 516096
    buffer_load_dwordx4 v254, s[28:31], s75 offen  lds
    s_add_u32 m0, s37, 100480
    s_add_u32 s75, s36, 114688
    s_mov_b32 exec_hi, 0xffffff
    buffer_load_dwordx4 v1, s[56:59], s75 offen  lds
    s_mov_b32 exec_hi, -1
    s_add_u32 m0, s37, 101376
    s_add_u32 s75, s36, 129024
    s_mov_b32 exec_hi, 0xffffff
    buffer_load_dwordx4 v1, s[56:59], s75 offen  lds
    s_mov_b32 exec_hi, -1
    s_add_u32 m0, s37, 102272
    s_add_u32 s75, s36, 143360
    s_mov_b32 exec_hi, 0xffffff
    buffer_load_dwordx4 v1, s[56:59], s75 offen  lds
    s_mov_b32 exec_hi, -1
    s_add_u32 m0, s37, 103168
    s_add_u32 s75, s36, 157696
    s_mov_b32 exec_hi, 0xffffff
    buffer_load_dwordx4 v1, s[56:59], s75 offen  lds
    s_mov_b32 exec_hi, -1
    s_waitcnt vmcnt(7)
    s_waitcnt lgkmcnt(0)
    s_barrier
    ds_read_b64_tr_b16 v[116:117], v8 offset:0
    ds_read_b64_tr_b16 v[118:119], v8 offset:896
    ds_read_b128 v[48:51], v4 offset:32768
    ds_read_b128 v[52:55], v5 offset:32768
    ds_read_b128 v[56:59], v6 offset:32768
    ds_read_b128 v[60:63], v7 offset:32768
    ds_read_b64_tr_b16 v[120:121], v8 offset:32
    ds_read_b64_tr_b16 v[122:123], v8 offset:928
    ds_read_b64_tr_b16 v[124:125], v8 offset:64
    ds_read_b64_tr_b16 v[126:127], v8 offset:960
    ds_read_b64_tr_b16 v[240:241], v8 offset:96
    ds_read_b64_tr_b16 v[242:243], v8 offset:992
    s_cmp_lg_u32 s34, 0
    s_cbranch_scc1 L_83
    s_waitcnt lgkmcnt(10)
    v_mfma_f32_32x32x16_bf16 v[128:143], v[116:119], v[16:19], 0
    ds_read_b64_tr_b16 v[244:245], v8 offset:128
    ds_read_b64_tr_b16 v[246:247], v8 offset:1024
    v_mfma_f32_16x16x32_bf16 v[96:99], v[112:115], v[116:119], v[96:99]
    s_add_u32 m0, s39, 61440
    s_add_u32 s75, s38, 688128
    buffer_load_dwordx4 v252, s[28:31], s75 offen  lds
    s_waitcnt lgkmcnt(6)
    v_mfma_f32_32x32x16_bf16 v[144:159], v[120:123], v[16:19], 0
    ds_read_b64_tr_b16 v[248:249], v8 offset:160
    ds_read_b64_tr_b16 v[250:251], v8 offset:1056
    v_mfma_f32_16x16x32_bf16 v[100:103], v[112:115], v[120:123], v[100:103]
    s_add_u32 m0, s39, 62464
    s_add_u32 s75, s38, 688128
    buffer_load_dwordx4 v253, s[28:31], s75 offen  lds
    s_waitcnt lgkmcnt(6)
    v_mfma_f32_32x32x16_bf16 v[160:175], v[124:127], v[16:19], 0
    ds_read_b64_tr_b16 v[116:117], v8 offset:192
    ds_read_b64_tr_b16 v[118:119], v8 offset:1088
    v_mfma_f32_16x16x32_bf16 v[104:107], v[112:115], v[124:127], v[104:107]
    s_waitcnt lgkmcnt(6)
    v_mfma_f32_32x32x16_bf16 v[176:191], v[240:243], v[16:19], 0
    ds_read_b64_tr_b16 v[120:121], v9 offset:0
    ds_read_b64_tr_b16 v[122:123], v9 offset:896
    v_mfma_f32_16x16x32_bf16 v[108:111], v[112:115], v[240:243], v[108:111]
    s_add_u32 m0, s39, 63488
    s_add_u32 s75, s38, 688128
    buffer_load_dwordx4 v254, s[28:31], s75 offen  lds
    s_waitcnt lgkmcnt(6)
    v_mfma_f32_32x32x16_bf16 v[192:207], v[244:247], v[16:19], 0
    ds_read_b64_tr_b16 v[124:125], v9 offset:32
    ds_read_b64_tr_b16 v[126:127], v9 offset:928
    s_waitcnt lgkmcnt(6)
    v_mfma_f32_32x32x16_bf16 v[208:223], v[248:251], v[16:19], 0
    ds_read_b64_tr_b16 v[240:241], v9 offset:64
    ds_read_b64_tr_b16 v[242:243], v9 offset:960
    s_add_u32 m0, s37, 114944
    s_add_u32 s75, s36, 229376
    s_mov_b32 exec_hi, 0xffffff
    buffer_load_dwordx4 v1, s[56:59], s75 offen  lds
    s_mov_b32 exec_hi, -1
    s_waitcnt lgkmcnt(6)
    v_mfma_f32_32x32x16_bf16 v[224:239], v[116:119], v[16:19], 0
    ds_read_b64_tr_b16 v[244:245], v9 offset:96
    ds_read_b64_tr_b16 v[246:247], v9 offset:992
    s_branch L_84
L_83:
    s_waitcnt lgkmcnt(10)
    v_mfma_f32_32x32x16_bf16 v[128:143], v[116:119], v[16:19], 0
    ds_read_b64_tr_b16 v[244:245], v8 offset:128
    ds_read_b64_tr_b16 v[246:247], v8 offset:1024
    s_add_u32 m0, s39, 61440
    s_add_u32 s75, s38, 688128
    buffer_load_dwordx4 v252, s[28:31], s75 offen  lds
    s_waitcnt lgkmcnt(6)
    v_mfma_f32_32x32x16_bf16 v[144:159], v[120:123], v[16:19], 0
    ds_read_b64_tr_b16 v[248:249], v8 offset:160
    ds_read_b64_tr_b16 v[250:251], v8 offset:1056
    s_add_u32 m0, s39, 62464
    s_add_u32 s75, s38, 688128
    buffer_load_dwordx4 v253, s[28:31], s75 offen  lds
    s_waitcnt lgkmcnt(6)
    v_mfma_f32_32x32x16_bf16 v[160:175], v[124:127], v[16:19], 0
    ds_read_b64_tr_b16 v[116:117], v8 offset:192
    ds_read_b64_tr_b16 v[118:119], v8 offset:1088
    s_waitcnt lgkmcnt(6)
    v_mfma_f32_32x32x16_bf16 v[176:191], v[240:243], v[16:19], 0
    ds_read_b64_tr_b16 v[120:121], v9 offset:0
    ds_read_b64_tr_b16 v[122:123], v9 offset:896
    s_add_u32 m0, s39, 63488
    s_add_u32 s75, s38, 688128
    buffer_load_dwordx4 v254, s[28:31], s75 offen  lds
    s_waitcnt lgkmcnt(6)
    v_mfma_f32_32x32x16_bf16 v[192:207], v[244:247], v[16:19], 0
    ds_read_b64_tr_b16 v[124:125], v9 offset:32
    ds_read_b64_tr_b16 v[126:127], v9 offset:928
    v_mfma_f32_16x16x32_bf16 v[96:99], v[112:115], v[244:247], v[96:99]
    s_waitcnt lgkmcnt(6)
    v_mfma_f32_32x32x16_bf16 v[208:223], v[248:251], v[16:19], 0
    ds_read_b64_tr_b16 v[240:241], v9 offset:64
    ds_read_b64_tr_b16 v[242:243], v9 offset:960
    v_mfma_f32_16x16x32_bf16 v[100:103], v[112:115], v[248:251], v[100:103]
    s_add_u32 m0, s37, 114944
    s_add_u32 s75, s36, 229376
    s_mov_b32 exec_hi, 0xffffff
    buffer_load_dwordx4 v1, s[56:59], s75 offen  lds
    s_mov_b32 exec_hi, -1
    s_waitcnt lgkmcnt(6)
    v_mfma_f32_32x32x16_bf16 v[224:239], v[116:119], v[16:19], 0
    ds_read_b64_tr_b16 v[244:245], v9 offset:96
    ds_read_b64_tr_b16 v[246:247], v9 offset:992
    v_mfma_f32_16x16x32_bf16 v[104:107], v[112:115], v[116:119], v[104:107]
L_84:
    s_waitcnt lgkmcnt(6)
    v_mfma_f32_32x32x16_bf16 v[128:143], v[120:123], v[20:23], v[128:143]
    ds_read_b64_tr_b16 v[248:249], v9 offset:128
    ds_read_b64_tr_b16 v[250:251], v9 offset:1024
    s_add_u32 m0, s37, 115840
    s_add_u32 s75, s36, 243712
    s_mov_b32 exec_hi, 0xffffff
    buffer_load_dwordx4 v1, s[56:59], s75 offen  lds
    s_mov_b32 exec_hi, -1
    s_waitcnt lgkmcnt(6)
    v_mfma_f32_32x32x16_bf16 v[144:159], v[124:127], v[20:23], v[144:159]
    ds_read_b64_tr_b16 v[116:117], v9 offset:160
    ds_read_b64_tr_b16 v[118:119], v9 offset:1056
    s_waitcnt lgkmcnt(6)
    v_mfma_f32_32x32x16_bf16 v[160:175], v[240:243], v[20:23], v[160:175]
    ds_read_b64_tr_b16 v[120:121], v9 offset:192
    ds_read_b64_tr_b16 v[122:123], v9 offset:1088
    s_add_u32 m0, s37, 116736
    s_add_u32 s75, s36, 258048
    s_mov_b32 exec_hi, 0xffffff
    buffer_load_dwordx4 v1, s[56:59], s75 offen  lds
    s_mov_b32 exec_hi, -1
    s_waitcnt lgkmcnt(6)
    v_mfma_f32_32x32x16_bf16 v[176:191], v[244:247], v[20:23], v[176:191]
    s_waitcnt vmcnt(6)
    s_barrier
    ds_read_b64_tr_b16 v[124:125], v8 offset:14464
    ds_read_b64_tr_b16 v[126:127], v8 offset:15360
    s_add_u32 m0, s37, 117632
    s_add_u32 s75, s36, 272384
    s_mov_b32 exec_hi, 0xffffff
    buffer_load_dwordx4 v1, s[56:59], s75 offen  lds
    s_mov_b32 exec_hi, -1
    s_waitcnt lgkmcnt(6)
    v_mfma_f32_32x32x16_bf16 v[192:207], v[248:251], v[20:23], v[192:207]
    ds_read_b64_tr_b16 v[240:241], v8 offset:14496
    ds_read_b64_tr_b16 v[242:243], v8 offset:15392
    s_add_u32 m0, s39, 73728
    s_add_u32 s75, s38, 860160
    buffer_load_dwordx4 v252, s[28:31], s75 offen  lds
    s_waitcnt lgkmcnt(6)
    v_mfma_f32_32x32x16_bf16 v[208:223], v[116:119], v[20:23], v[208:223]
    ds_read_b64_tr_b16 v[244:245], v8 offset:14528
    ds_read_b64_tr_b16 v[246:247], v8 offset:15424
    s_waitcnt lgkmcnt(6)
    v_mfma_f32_32x32x16_bf16 v[224:239], v[120:123], v[20:23], v[224:239]
    ds_read_b64_tr_b16 v[248:249], v8 offset:14560
    ds_read_b64_tr_b16 v[250:251], v8 offset:15456
    ds_read_b128 v[64:67], v4 offset:0
    ds_read_b128 v[68:71], v5 offset:0
    ds_read_b128 v[72:75], v6 offset:0
    ds_read_b128 v[76:79], v7 offset:0
    s_add_u32 m0, s39, 74752
    s_add_u32 s75, s38, 860160
    buffer_load_dwordx4 v253, s[28:31], s75 offen  lds
    s_cmp_lg_u32 s34, 0
    s_cbranch_scc1 L_85
    s_waitcnt lgkmcnt(10)
    v_mfma_f32_32x32x16_bf16 v[128:143], v[124:127], v[24:27], v[128:143]
    ds_read_b64_tr_b16 v[116:117], v8 offset:14592
    ds_read_b64_tr_b16 v[118:119], v8 offset:15488
    v_mfma_f32_16x16x32_bf16 v[96:99], v[112:115], v[124:127], v[96:99]
    s_waitcnt lgkmcnt(10)
    v_mfma_f32_32x32x16_bf16 v[144:159], v[240:243], v[24:27], v[144:159]
    ds_read_b64_tr_b16 v[120:121], v8 offset:14624
    ds_read_b64_tr_b16 v[122:123], v8 offset:15520
    v_mfma_f32_16x16x32_bf16 v[100:103], v[112:115], v[240:243], v[100:103]
    s_add_u32 m0, s39, 75776
    s_add_u32 s75, s38, 860160
    buffer_load_dwordx4 v254, s[28:31], s75 offen  lds
    s_waitcnt lgkmcnt(10)
    v_mfma_f32_32x32x16_bf16 v[160:175], v[244:247], v[24:27], v[160:175]
    ds_read_b64_tr_b16 v[124:125], v8 offset:14656
    ds_read_b64_tr_b16 v[126:127], v8 offset:15552
    v_mfma_f32_16x16x32_bf16 v[104:107], v[112:115], v[244:247], v[104:107]
    s_waitcnt lgkmcnt(10)
    v_mfma_f32_32x32x16_bf16 v[176:191], v[248:251], v[24:27], v[176:191]
    ds_read_b64_tr_b16 v[240:241], v9 offset:14464
    ds_read_b64_tr_b16 v[242:243], v9 offset:15360
    v_mfma_f32_16x16x32_bf16 v[108:111], v[112:115], v[248:251], v[108:111]
    s_add_u32 m0, s37, 129408
    s_add_u32 s75, s36, 344064
    s_mov_b32 exec_hi, 0xffffff
    buffer_load_dwordx4 v1, s[56:59], s75 offen  lds
    s_mov_b32 exec_hi, -1
    s_waitcnt lgkmcnt(6)
    v_mfma_f32_32x32x16_bf16 v[192:207], v[116:119], v[24:27], v[192:207]
    ds_read_b64_tr_b16 v[244:245], v9 offset:14496
    ds_read_b64_tr_b16 v[246:247], v9 offset:15392
    s_waitcnt lgkmcnt(6)
    v_mfma_f32_32x32x16_bf16 v[208:223], v[120:123], v[24:27], v[208:223]
    ds_read_b64_tr_b16 v[248:249], v9 offset:14528
    ds_read_b64_tr_b16 v[250:251], v9 offset:15424
    s_add_u32 m0, s37, 130304
    s_add_u32 s75, s36, 358400
    s_mov_b32 exec_hi, 0xffffff
    buffer_load_dwordx4 v1, s[56:59], s75 offen  lds
    s_mov_b32 exec_hi, -1
    s_waitcnt lgkmcnt(6)
    v_mfma_f32_32x32x16_bf16 v[224:239], v[124:127], v[24:27], v[224:239]
    ds_read_b64_tr_b16 v[116:117], v9 offset:14560
    ds_read_b64_tr_b16 v[118:119], v9 offset:15456
    s_branch L_86
L_85:
    s_waitcnt lgkmcnt(10)
    v_mfma_f32_32x32x16_bf16 v[128:143], v[124:127], v[24:27], v[128:143]
    ds_read_b64_tr_b16 v[116:117], v8 offset:14592
    ds_read_b64_tr_b16 v[118:119], v8 offset:15488
    s_waitcnt lgkmcnt(10)
    v_mfma_f32_32x32x16_bf16 v[144:159], v[240:243], v[24:27], v[144:159]
    ds_read_b64_tr_b16 v[120:121], v8 offset:14624
    ds_read_b64_tr_b16 v[122:123], v8 offset:15520
    s_add_u32 m0, s39, 75776
    s_add_u32 s75, s38, 860160
    buffer_load_dwordx4 v254, s[28:31], s75 offen  lds
    s_waitcnt lgkmcnt(10)
    v_mfma_f32_32x32x16_bf16 v[160:175], v[244:247], v[24:27], v[160:175]
    ds_read_b64_tr_b16 v[124:125], v8 offset:14656
    ds_read_b64_tr_b16 v[126:127], v8 offset:15552
    s_waitcnt lgkmcnt(10)
    v_mfma_f32_32x32x16_bf16 v[176:191], v[248:251], v[24:27], v[176:191]
    ds_read_b64_tr_b16 v[240:241], v9 offset:14464
    ds_read_b64_tr_b16 v[242:243], v9 offset:15360
    s_add_u32 m0, s37, 129408
    s_add_u32 s75, s36, 344064
    s_mov_b32 exec_hi, 0xffffff
    buffer_load_dwordx4 v1, s[56:59], s75 offen  lds
    s_mov_b32 exec_hi, -1
    s_waitcnt lgkmcnt(6)
    v_mfma_f32_32x32x16_bf16 v[192:207], v[116:119], v[24:27], v[192:207]
    ds_read_b64_tr_b16 v[244:245], v9 offset:14496
    ds_read_b64_tr_b16 v[246:247], v9 offset:15392
    v_mfma_f32_16x16x32_bf16 v[96:99], v[112:115], v[116:119], v[96:99]
    s_waitcnt lgkmcnt(6)
    v_mfma_f32_32x32x16_bf16 v[208:223], v[120:123], v[24:27], v[208:223]
    ds_read_b64_tr_b16 v[248:249], v9 offset:14528
    ds_read_b64_tr_b16 v[250:251], v9 offset:15424
    v_mfma_f32_16x16x32_bf16 v[100:103], v[112:115], v[120:123], v[100:103]
    s_add_u32 m0, s37, 130304
    s_add_u32 s75, s36, 358400
    s_mov_b32 exec_hi, 0xffffff
    buffer_load_dwordx4 v1, s[56:59], s75 offen  lds
    s_mov_b32 exec_hi, -1
    s_waitcnt lgkmcnt(6)
    v_mfma_f32_32x32x16_bf16 v[224:239], v[124:127], v[24:27], v[224:239]
    ds_read_b64_tr_b16 v[116:117], v9 offset:14560
    ds_read_b64_tr_b16 v[118:119], v9 offset:15456
    v_mfma_f32_16x16x32_bf16 v[104:107], v[112:115], v[124:127], v[104:107]
L_86:
    s_waitcnt lgkmcnt(6)
    v_mfma_f32_32x32x16_bf16 v[128:143], v[240:243], v[28:31], v[128:143]
    ds_read_b64_tr_b16 v[120:121], v9 offset:14592
    ds_read_b64_tr_b16 v[122:123], v9 offset:15488
    s_add_u32 m0, s37, 131200
    s_add_u32 s75, s36, 372736
    s_mov_b32 exec_hi, 0xffffff
    buffer_load_dwordx4 v1, s[56:59], s75 offen  lds
    s_mov_b32 exec_hi, -1
    s_waitcnt lgkmcnt(6)
    v_mfma_f32_32x32x16_bf16 v[144:159], v[244:247], v[28:31], v[144:159]
    ds_read_b64_tr_b16 v[124:125], v9 offset:14624
    ds_read_b64_tr_b16 v[126:127], v9 offset:15520
    s_waitcnt lgkmcnt(6)
    v_mfma_f32_32x32x16_bf16 v[160:175], v[248:251], v[28:31], v[160:175]
    ds_read_b64_tr_b16 v[240:241], v9 offset:14656
    ds_read_b64_tr_b16 v[242:243], v9 offset:15552
    s_add_u32 m0, s37, 132096
    s_add_u32 s75, s36, 387072
    s_mov_b32 exec_hi, 0xffffff
    buffer_load_dwordx4 v1, s[56:59], s75 offen  lds
    s_mov_b32 exec_hi, -1
    s_waitcnt lgkmcnt(6)
    v_mfma_f32_32x32x16_bf16 v[176:191], v[116:119], v[28:31], v[176:191]
    s_waitcnt vmcnt(7)
    s_barrier
    ds_read_b64_tr_b16 v[244:245], v8 offset:28928
    ds_read_b64_tr_b16 v[246:247], v8 offset:29824
    s_add_u32 m0, s39, 49152
    s_add_u32 s75, s38, 1032192
    buffer_load_dwordx4 v252, s[28:31], s75 offen  lds
    s_waitcnt lgkmcnt(6)
    v_mfma_f32_32x32x16_bf16 v[192:207], v[120:123], v[28:31], v[192:207]
    ds_read_b64_tr_b16 v[248:249], v8 offset:28960
    ds_read_b64_tr_b16 v[250:251], v8 offset:29856
    s_add_u32 m0, s39, 50176
    s_add_u32 s75, s38, 1032192
    buffer_load_dwordx4 v253, s[28:31], s75 offen  lds
    s_waitcnt lgkmcnt(6)
    v_mfma_f32_32x32x16_bf16 v[208:223], v[124:127], v[28:31], v[208:223]
    ds_read_b64_tr_b16 v[116:117], v8 offset:28992
    ds_read_b64_tr_b16 v[118:119], v8 offset:29888
    s_add_u32 m0, s39, 51200
    s_add_u32 s75, s38, 1032192
    buffer_load_dwordx4 v254, s[28:31], s75 offen  lds
    s_waitcnt lgkmcnt(6)
    v_mfma_f32_32x32x16_bf16 v[224:239], v[240:243], v[28:31], v[224:239]
    ds_read_b64_tr_b16 v[120:121], v8 offset:29024
    ds_read_b64_tr_b16 v[122:123], v8 offset:29920
    ds_read_b128 v[80:83], v4 offset:16384
    ds_read_b128 v[84:87], v5 offset:16384
    ds_read_b128 v[88:91], v6 offset:16384
    ds_read_b128 v[92:95], v7 offset:16384
    s_add_u32 m0, s37, 143872
    s_add_u32 s75, s36, 458752
    s_mov_b32 exec_hi, 0xffffff
    buffer_load_dwordx4 v1, s[56:59], s75 offen  lds
    s_mov_b32 exec_hi, -1
    s_cmp_lg_u32 s34, 0
    s_cbranch_scc1 L_87
    s_waitcnt lgkmcnt(10)
    v_mfma_f32_32x32x16_bf16 v[128:143], v[244:247], v[32:35], v[128:143]
    ds_read_b64_tr_b16 v[124:125], v8 offset:29056
    ds_read_b64_tr_b16 v[126:127], v8 offset:29952
    v_mfma_f32_16x16x32_bf16 v[96:99], v[112:115], v[244:247], v[96:99]
    s_add_u32 m0, s37, 144768
    s_add_u32 s75, s36, 473088
    s_mov_b32 exec_hi, 0xffffff
    buffer_load_dwordx4 v1, s[56:59], s75 offen  lds
    s_mov_b32 exec_hi, -1
    s_waitcnt lgkmcnt(10)
    v_mfma_f32_32x32x16_bf16 v[144:159], v[248:251], v[32:35], v[144:159]
    ds_read_b64_tr_b16 v[240:241], v8 offset:29088
    ds_read_b64_tr_b16 v[242:243], v8 offset:29984
    v_mfma_f32_16x16x32_bf16 v[100:103], v[112:115], v[248:251], v[100:103]
    s_add_u32 m0, s37, 145664
    s_add_u32 s75, s36, 487424
    s_mov_b32 exec_hi, 0xffffff
    buffer_load_dwordx4 v1, s[56:59], s75 offen  lds
    s_mov_b32 exec_hi, -1
    s_waitcnt lgkmcnt(10)
    v_mfma_f32_32x32x16_bf16 v[160:175], v[116:119], v[32:35], v[160:175]
    ds_read_b64_tr_b16 v[244:245], v8 offset:29120
    ds_read_b64_tr_b16 v[246:247], v8 offset:30016
    v_mfma_f32_16x16x32_bf16 v[104:107], v[112:115], v[116:119], v[104:107]
    s_waitcnt lgkmcnt(10)
    v_mfma_f32_32x32x16_bf16 v[176:191], v[120:123], v[32:35], v[176:191]
    ds_read_b64_tr_b16 v[248:249], v9 offset:28928
    ds_read_b64_tr_b16 v[250:251], v9 offset:29824
    v_mfma_f32_16x16x32_bf16 v[108:111], v[112:115], v[120:123], v[108:111]
    s_add_u32 m0, s37, 146560
    s_add_u32 s75, s36, 501760
    s_mov_b32 exec_hi, 0xffffff
    buffer_load_dwordx4 v1, s[56:59], s75 offen  lds
    s_mov_b32 exec_hi, -1
    s_waitcnt lgkmcnt(6)
    v_mfma_f32_32x32x16_bf16 v[192:207], v[124:127], v[32:35], v[192:207]
    ds_read_b64_tr_b16 v[116:117], v9 offset:28960
    ds_read_b64_tr_b16 v[118:119], v9 offset:29856
    s_waitcnt lgkmcnt(6)
    v_mfma_f32_32x32x16_bf16 v[208:223], v[240:243], v[32:35], v[208:223]
    ds_read_b64_tr_b16 v[120:121], v9 offset:28992
    ds_read_b64_tr_b16 v[122:123], v9 offset:29888
    s_add_u32 m0, s37, 86016
    s_add_u32 s75, s36, 573440
    s_mov_b32 exec_hi, 0xffffff
    buffer_load_dwordx4 v1, s[56:59], s75 offen  lds
    s_mov_b32 exec_hi, -1
    s_waitcnt lgkmcnt(6)
    v_mfma_f32_32x32x16_bf16 v[224:239], v[244:247], v[32:35], v[224:239]
    ds_read_b64_tr_b16 v[124:125], v9 offset:29024
    ds_read_b64_tr_b16 v[126:127], v9 offset:29920
    s_branch L_88
L_87:
    s_waitcnt lgkmcnt(10)
    v_mfma_f32_32x32x16_bf16 v[128:143], v[244:247], v[32:35], v[128:143]
    ds_read_b64_tr_b16 v[124:125], v8 offset:29056
    ds_read_b64_tr_b16 v[126:127], v8 offset:29952
    s_add_u32 m0, s37, 144768
    s_add_u32 s75, s36, 473088
    s_mov_b32 exec_hi, 0xffffff
    buffer_load_dwordx4 v1, s[56:59], s75 offen  lds
    s_mov_b32 exec_hi, -1
    s_waitcnt lgkmcnt(10)
    v_mfma_f32_32x32x16_bf16 v[144:159], v[248:251], v[32:35], v[144:159]
    ds_read_b64_tr_b16 v[240:241], v8 offset:29088
    ds_read_b64_tr_b16 v[242:243], v8 offset:29984
    s_add_u32 m0, s37, 145664
    s_add_u32 s75, s36, 487424
    s_mov_b32 exec_hi, 0xffffff
    buffer_load_dwordx4 v1, s[56:59], s75 offen  lds
    s_mov_b32 exec_hi, -1
    s_waitcnt lgkmcnt(10)
    v_mfma_f32_32x32x16_bf16 v[160:175], v[116:119], v[32:35], v[160:175]
    ds_read_b64_tr_b16 v[244:245], v8 offset:29120
    ds_read_b64_tr_b16 v[246:247], v8 offset:30016
    s_waitcnt lgkmcnt(10)
    v_mfma_f32_32x32x16_bf16 v[176:191], v[120:123], v[32:35], v[176:191]
    ds_read_b64_tr_b16 v[248:249], v9 offset:28928
    ds_read_b64_tr_b16 v[250:251], v9 offset:29824
    s_add_u32 m0, s37, 146560
    s_add_u32 s75, s36, 501760
    s_mov_b32 exec_hi, 0xffffff
    buffer_load_dwordx4 v1, s[56:59], s75 offen  lds
    s_mov_b32 exec_hi, -1
    s_waitcnt lgkmcnt(6)
    v_mfma_f32_32x32x16_bf16 v[192:207], v[124:127], v[32:35], v[192:207]
    ds_read_b64_tr_b16 v[116:117], v9 offset:28960
    ds_read_b64_tr_b16 v[118:119], v9 offset:29856
    v_mfma_f32_16x16x32_bf16 v[96:99], v[112:115], v[124:127], v[96:99]
    s_waitcnt lgkmcnt(6)
    v_mfma_f32_32x32x16_bf16 v[208:223], v[240:243], v[32:35], v[208:223]
    ds_read_b64_tr_b16 v[120:121], v9 offset:28992
    ds_read_b64_tr_b16 v[122:123], v9 offset:29888
    v_mfma_f32_16x16x32_bf16 v[100:103], v[112:115], v[240:243], v[100:103]
    s_add_u32 m0, s37, 86016
    s_add_u32 s75, s36, 573440
    s_mov_b32 exec_hi, 0xffffff
    buffer_load_dwordx4 v1, s[56:59], s75 offen  lds
    s_mov_b32 exec_hi, -1
    s_waitcnt lgkmcnt(6)
    v_mfma_f32_32x32x16_bf16 v[224:239], v[244:247], v[32:35], v[224:239]
    ds_read_b64_tr_b16 v[124:125], v9 offset:29024
    ds_read_b64_tr_b16 v[126:127], v9 offset:29920
    v_mfma_f32_16x16x32_bf16 v[104:107], v[112:115], v[244:247], v[104:107]
L_88:
    s_waitcnt lgkmcnt(6)
    v_mfma_f32_32x32x16_bf16 v[128:143], v[248:251], v[36:39], v[128:143]
    ds_read_b64_tr_b16 v[240:241], v9 offset:29056
    ds_read_b64_tr_b16 v[242:243], v9 offset:29952
    s_add_u32 m0, s37, 86912
    s_add_u32 s75, s36, 587776
    s_mov_b32 exec_hi, 0xffffff
    buffer_load_dwordx4 v1, s[56:59], s75 offen  lds
    s_mov_b32 exec_hi, -1
    s_waitcnt lgkmcnt(6)
    v_mfma_f32_32x32x16_bf16 v[144:159], v[116:119], v[36:39], v[144:159]
    ds_read_b64_tr_b16 v[244:245], v9 offset:29088
    ds_read_b64_tr_b16 v[246:247], v9 offset:29984
    s_waitcnt lgkmcnt(6)
    v_mfma_f32_32x32x16_bf16 v[160:175], v[120:123], v[36:39], v[160:175]
    ds_read_b64_tr_b16 v[248:249], v9 offset:29120
    ds_read_b64_tr_b16 v[250:251], v9 offset:30016
    s_add_u32 m0, s37, 87808
    s_add_u32 s75, s36, 602112
    s_mov_b32 exec_hi, 0xffffff
    buffer_load_dwordx4 v1, s[56:59], s75 offen  lds
    s_mov_b32 exec_hi, -1
    s_waitcnt lgkmcnt(6)
    v_mfma_f32_32x32x16_bf16 v[176:191], v[124:127], v[36:39], v[176:191]
    s_waitcnt vmcnt(10)
    s_barrier
    ds_read_b64_tr_b16 v[116:117], v8 offset:43392
    ds_read_b64_tr_b16 v[118:119], v8 offset:44288
    s_add_u32 m0, s37, 88704
    s_add_u32 s75, s36, 616448
    s_mov_b32 exec_hi, 0xffffff
    buffer_load_dwordx4 v1, s[56:59], s75 offen  lds
    s_mov_b32 exec_hi, -1
    s_waitcnt lgkmcnt(6)
    v_mfma_f32_32x32x16_bf16 v[192:207], v[240:243], v[36:39], v[192:207]
    ds_read_b64_tr_b16 v[120:121], v8 offset:43424
    ds_read_b64_tr_b16 v[122:123], v8 offset:44320
    s_add_u32 m0, s37, 100480
    s_add_u32 s75, s36, 688128
    s_mov_b32 exec_hi, 0xffffff
    buffer_load_dwordx4 v1, s[56:59], s75 offen  lds
    s_mov_b32 exec_hi, -1
    s_waitcnt lgkmcnt(6)
    v_mfma_f32_32x32x16_bf16 v[208:223], v[244:247], v[36:39], v[208:223]
    ds_read_b64_tr_b16 v[124:125], v8 offset:43456
    ds_read_b64_tr_b16 v[126:127], v8 offset:44352
    s_add_u32 m0, s37, 101376
    s_add_u32 s75, s36, 702464
    s_mov_b32 exec_hi, 0xffffff
    buffer_load_dwordx4 v1, s[56:59], s75 offen  lds
    s_mov_b32 exec_hi, -1
    s_waitcnt lgkmcnt(6)
    v_mfma_f32_32x32x16_bf16 v[224:239], v[248:251], v[36:39], v[224:239]
    ds_read_b64_tr_b16 v[240:241], v8 offset:43488
    ds_read_b64_tr_b16 v[242:243], v8 offset:44384
    ds_read_b128 v[16:19], v4 offset:32768
    ds_read_b128 v[20:23], v5 offset:32768
    ds_read_b128 v[24:27], v6 offset:32768
    ds_read_b128 v[28:31], v7 offset:32768
    s_add_u32 m0, s37, 102272
    s_add_u32 s75, s36, 716800
    s_mov_b32 exec_hi, 0xffffff
    buffer_load_dwordx4 v1, s[56:59], s75 offen  lds
    s_mov_b32 exec_hi, -1
    s_cmp_lg_u32 s34, 0
    s_cbranch_scc1 L_89
    s_waitcnt lgkmcnt(10)
    v_mfma_f32_32x32x16_bf16 v[128:143], v[116:119], v[40:43], v[128:143]
    ds_read_b64_tr_b16 v[244:245], v8 offset:43520
    ds_read_b64_tr_b16 v[246:247], v8 offset:44416
    v_mfma_f32_16x16x32_bf16 v[96:99], v[112:115], v[116:119], v[96:99]
    s_waitcnt lgkmcnt(10)
    v_mfma_f32_32x32x16_bf16 v[144:159], v[120:123], v[40:43], v[144:159]
    ds_read_b64_tr_b16 v[248:249], v8 offset:43552
    ds_read_b64_tr_b16 v[250:251], v8 offset:44448
    v_mfma_f32_16x16x32_bf16 v[100:103], v[112:115], v[120:123], v[100:103]
    s_add_u32 m0, s37, 103168
    s_add_u32 s75, s36, 731136
    s_mov_b32 exec_hi, 0xffffff
    buffer_load_dwordx4 v1, s[56:59], s75 offen  lds
    s_mov_b32 exec_hi, -1
    s_waitcnt lgkmcnt(10)
    v_mfma_f32_32x32x16_bf16 v[160:175], v[124:127], v[40:43], v[160:175]
    ds_read_b64_tr_b16 v[116:117], v8 offset:43584
    ds_read_b64_tr_b16 v[118:119], v8 offset:44480
    v_mfma_f32_16x16x32_bf16 v[104:107], v[112:115], v[124:127], v[104:107]
    s_waitcnt lgkmcnt(10)
    v_mfma_f32_32x32x16_bf16 v[176:191], v[240:243], v[40:43], v[176:191]
    ds_read_b64_tr_b16 v[120:121], v9 offset:43392
    ds_read_b64_tr_b16 v[122:123], v9 offset:44288
    v_mfma_f32_16x16x32_bf16 v[108:111], v[112:115], v[240:243], v[108:111]
    s_add_u32 m0, s37, 16384
    s_add_u32 s75, s36, 917504
    s_mov_b32 exec_hi, 0xffffff
    buffer_load_dwordx4 v1, s[56:59], s75 offen  lds
    s_mov_b32 exec_hi, -1
    s_waitcnt lgkmcnt(6)
    v_mfma_f32_32x32x16_bf16 v[192:207], v[244:247], v[40:43], v[192:207]
    ds_read_b64_tr_b16 v[124:125], v9 offset:43424
    ds_read_b64_tr_b16 v[126:127], v9 offset:44320
    s_waitcnt lgkmcnt(6)
    v_mfma_f32_32x32x16_bf16 v[208:223], v[248:251], v[40:43], v[208:223]
    ds_read_b64_tr_b16 v[240:241], v9 offset:43456
    ds_read_b64_tr_b16 v[242:243], v9 offset:44352
    s_add_u32 m0, s37, 17280
    s_add_u32 s75, s36, 931840
    s_mov_b32 exec_hi, 0xffffff
    buffer_load_dwordx4 v1, s[56:59], s75 offen  lds
    s_mov_b32 exec_hi, -1
    s_waitcnt lgkmcnt(6)
    v_mfma_f32_32x32x16_bf16 v[224:239], v[116:119], v[40:43], v[224:239]
    ds_read_b64_tr_b16 v[244:245], v9 offset:43488
    ds_read_b64_tr_b16 v[246:247], v9 offset:44384
    s_branch L_90
L_89:
    s_waitcnt lgkmcnt(10)
    v_mfma_f32_32x32x16_bf16 v[128:143], v[116:119], v[40:43], v[128:143]
    ds_read_b64_tr_b16 v[244:245], v8 offset:43520
    ds_read_b64_tr_b16 v[246:247], v8 offset:44416
    s_waitcnt lgkmcnt(10)
    v_mfma_f32_32x32x16_bf16 v[144:159], v[120:123], v[40:43], v[144:159]
    ds_read_b64_tr_b16 v[248:249], v8 offset:43552
    ds_read_b64_tr_b16 v[250:251], v8 offset:44448
    s_add_u32 m0, s37, 103168
    s_add_u32 s75, s36, 731136
    s_mov_b32 exec_hi, 0xffffff
    buffer_load_dwordx4 v1, s[56:59], s75 offen  lds
    s_mov_b32 exec_hi, -1
    s_waitcnt lgkmcnt(10)
    v_mfma_f32_32x32x16_bf16 v[160:175], v[124:127], v[40:43], v[160:175]
    ds_read_b64_tr_b16 v[116:117], v8 offset:43584
    ds_read_b64_tr_b16 v[118:119], v8 offset:44480
    s_waitcnt lgkmcnt(10)
    v_mfma_f32_32x32x16_bf16 v[176:191], v[240:243], v[40:43], v[176:191]
    ds_read_b64_tr_b16 v[120:121], v9 offset:43392
    ds_read_b64_tr_b16 v[122:123], v9 offset:44288
    s_add_u32 m0, s37, 16384
    s_add_u32 s75, s36, 917504
    s_mov_b32 exec_hi, 0xffffff
    buffer_load_dwordx4 v1, s[56:59], s75 offen  lds
    s_mov_b32 exec_hi, -1
    s_waitcnt lgkmcnt(6)
    v_mfma_f32_32x32x16_bf16 v[192:207], v[244:247], v[40:43], v[192:207]
    ds_read_b64_tr_b16 v[124:125], v9 offset:43424
    ds_read_b64_tr_b16 v[126:127], v9 offset:44320
    v_mfma_f32_16x16x32_bf16 v[96:99], v[112:115], v[244:247], v[96:99]
    s_waitcnt lgkmcnt(6)
    v_mfma_f32_32x32x16_bf16 v[208:223], v[248:251], v[40:43], v[208:223]
    ds_read_b64_tr_b16 v[240:241], v9 offset:43456
    ds_read_b64_tr_b16 v[242:243], v9 offset:44352
    v_mfma_f32_16x16x32_bf16 v[100:103], v[112:115], v[248:251], v[100:103]
    s_add_u32 m0, s37, 17280
    s_add_u32 s75, s36, 931840
    s_mov_b32 exec_hi, 0xffffff
    buffer_load_dwordx4 v1, s[56:59], s75 offen  lds
    s_mov_b32 exec_hi, -1
    s_waitcnt lgkmcnt(6)
    v_mfma_f32_32x32x16_bf16 v[224:239], v[116:119], v[40:43], v[224:239]
    ds_read_b64_tr_b16 v[244:245], v9 offset:43488
    ds_read_b64_tr_b16 v[246:247], v9 offset:44384
    v_mfma_f32_16x16x32_bf16 v[104:107], v[112:115], v[116:119], v[104:107]
L_90:
    s_waitcnt lgkmcnt(6)
    v_mfma_f32_32x32x16_bf16 v[128:143], v[120:123], v[44:47], v[128:143]
    ds_read_b64_tr_b16 v[248:249], v9 offset:43520
    ds_read_b64_tr_b16 v[250:251], v9 offset:44416
    s_add_u32 m0, s37, 18176
    s_add_u32 s75, s36, 946176
    s_mov_b32 exec_hi, 0xffffff
    buffer_load_dwordx4 v1, s[56:59], s75 offen  lds
    s_mov_b32 exec_hi, -1
    s_waitcnt lgkmcnt(6)
    v_mfma_f32_32x32x16_bf16 v[144:159], v[124:127], v[44:47], v[144:159]
    ds_read_b64_tr_b16 v[116:117], v9 offset:43552
    ds_read_b64_tr_b16 v[118:119], v9 offset:44448
    s_waitcnt lgkmcnt(6)
    v_mfma_f32_32x32x16_bf16 v[160:175], v[240:243], v[44:47], v[160:175]
    ds_read_b64_tr_b16 v[120:121], v9 offset:43584
    ds_read_b64_tr_b16 v[122:123], v9 offset:44480
    s_add_u32 m0, s37, 19072
    s_add_u32 s75, s36, 960512
    s_mov_b32 exec_hi, 0xffffff
    buffer_load_dwordx4 v1, s[56:59], s75 offen  lds
    s_mov_b32 exec_hi, -1
    s_waitcnt lgkmcnt(6)
    v_mfma_f32_32x32x16_bf16 v[176:191], v[244:247], v[44:47], v[176:191]
    s_waitcnt vmcnt(12)
    s_barrier
    ds_read_b64_tr_b16 v[124:125], v8 offset:57856
    ds_read_b64_tr_b16 v[126:127], v8 offset:58752
    s_add_u32 m0, s37, 114944
    s_add_u32 s75, s36, 802816
    s_mov_b32 exec_hi, 0xffffff
    buffer_load_dwordx4 v1, s[56:59], s75 offen  lds
    s_mov_b32 exec_hi, -1
    s_waitcnt lgkmcnt(6)
    v_mfma_f32_32x32x16_bf16 v[192:207], v[248:251], v[44:47], v[192:207]
    ds_read_b64_tr_b16 v[240:241], v8 offset:57888
    ds_read_b64_tr_b16 v[242:243], v8 offset:58784
    s_add_u32 m0, s37, 115840
    s_add_u32 s75, s36, 817152
    s_mov_b32 exec_hi, 0xffffff
    buffer_load_dwordx4 v1, s[56:59], s75 offen  lds
    s_mov_b32 exec_hi, -1
    s_waitcnt lgkmcnt(6)
    v_mfma_f32_32x32x16_bf16 v[208:223], v[116:119], v[44:47], v[208:223]
    ds_read_b64_tr_b16 v[244:245], v8 offset:57920
    ds_read_b64_tr_b16 v[246:247], v8 offset:58816
    s_add_u32 m0, s37, 116736
    s_add_u32 s75, s36, 831488
    s_mov_b32 exec_hi, 0xffffff
    buffer_load_dwordx4 v1, s[56:59], s75 offen  lds
    s_mov_b32 exec_hi, -1
    s_waitcnt lgkmcnt(6)
    v_mfma_f32_32x32x16_bf16 v[224:239], v[120:123], v[44:47], v[224:239]
    ds_read_b64_tr_b16 v[248:249], v8 offset:57952
    ds_read_b64_tr_b16 v[250:251], v8 offset:58848
    ds_read_b128 v[32:35], v4 offset:0
    ds_read_b128 v[36:39], v5 offset:0
    ds_read_b128 v[40:43], v6 offset:0
    ds_read_b128 v[44:47], v7 offset:0
    s_add_u32 m0, s37, 117632
    s_add_u32 s75, s36, 845824
    s_mov_b32 exec_hi, 0xffffff
    buffer_load_dwordx4 v1, s[56:59], s75 offen  lds
    s_mov_b32 exec_hi, -1
    s_cmp_lg_u32 s34, 0
    s_cbranch_scc1 L_91
    s_waitcnt lgkmcnt(10)
    v_mfma_f32_32x32x16_bf16 v[128:143], v[124:127], v[48:51], v[128:143]
    ds_read_b64_tr_b16 v[116:117], v8 offset:57984
    ds_read_b64_tr_b16 v[118:119], v8 offset:58880
    v_mfma_f32_16x16x32_bf16 v[96:99], v[112:115], v[124:127], v[96:99]
    s_add_u32 m0, s37, 32768
    s_add_u32 s75, s36, 1032192
    s_mov_b32 exec_hi, 0xffffff
    buffer_load_dwordx4 v1, s[56:59], s75 offen  lds
    s_mov_b32 exec_hi, -1
    s_waitcnt lgkmcnt(10)
    v_mfma_f32_32x32x16_bf16 v[144:159], v[240:243], v[48:51], v[144:159]
    ds_read_b64_tr_b16 v[120:121], v8 offset:58016
    ds_read_b64_tr_b16 v[122:123], v8 offset:58912
    v_mfma_f32_16x16x32_bf16 v[100:103], v[112:115], v[240:243], v[100:103]
    s_add_u32 m0, s37, 33664
    s_add_u32 s75, s36, 1046528
    s_mov_b32 exec_hi, 0xffffff
    buffer_load_dwordx4 v1, s[56:59], s75 offen  lds
    s_mov_b32 exec_hi, -1
    s_waitcnt lgkmcnt(10)
    v_mfma_f32_32x32x16_bf16 v[160:175], v[244:247], v[48:51], v[160:175]
    ds_read_b64_tr_b16 v[124:125], v8 offset:58048
    ds_read_b64_tr_b16 v[126:127], v8 offset:58944
    v_mfma_f32_16x16x32_bf16 v[104:107], v[112:115], v[244:247], v[104:107]
    s_waitcnt lgkmcnt(10)
    v_mfma_f32_32x32x16_bf16 v[176:191], v[248:251], v[48:51], v[176:191]
    ds_read_b64_tr_b16 v[240:241], v9 offset:57856
    ds_read_b64_tr_b16 v[242:243], v9 offset:58752
    v_mfma_f32_16x16x32_bf16 v[108:111], v[112:115], v[248:251], v[108:111]
    s_add_u32 m0, s37, 34560
    s_add_u32 s75, s36, 1060864
    s_mov_b32 exec_hi, 0xffffff
    buffer_load_dwordx4 v1, s[56:59], s75 offen  lds
    s_mov_b32 exec_hi, -1
    s_waitcnt lgkmcnt(6)
    v_mfma_f32_32x32x16_bf16 v[192:207], v[116:119], v[48:51], v[192:207]
    ds_read_b64_tr_b16 v[244:245], v9 offset:57888
    ds_read_b64_tr_b16 v[246:247], v9 offset:58784
    s_waitcnt lgkmcnt(6)
    v_mfma_f32_32x32x16_bf16 v[208:223], v[120:123], v[48:51], v[208:223]
    ds_read_b64_tr_b16 v[248:249], v9 offset:57920
    ds_read_b64_tr_b16 v[250:251], v9 offset:58816
    s_add_u32 m0, s37, 35456
    s_add_u32 s75, s36, 1075200
    s_mov_b32 exec_hi, 0xffffff
    buffer_load_dwordx4 v1, s[56:59], s75 offen  lds
    s_mov_b32 exec_hi, -1
    s_waitcnt lgkmcnt(6)
    v_mfma_f32_32x32x16_bf16 v[224:239], v[124:127], v[48:51], v[224:239]
    ds_read_b64_tr_b16 v[116:117], v9 offset:57952
    ds_read_b64_tr_b16 v[118:119], v9 offset:58848
    s_branch L_92
L_91:
    s_waitcnt lgkmcnt(10)
    v_mfma_f32_32x32x16_bf16 v[128:143], v[124:127], v[48:51], v[128:143]
    ds_read_b64_tr_b16 v[116:117], v8 offset:57984
    ds_read_b64_tr_b16 v[118:119], v8 offset:58880
    s_add_u32 m0, s37, 32768
    s_add_u32 s75, s36, 1032192
    s_mov_b32 exec_hi, 0xffffff
    buffer_load_dwordx4 v1, s[56:59], s75 offen  lds
    s_mov_b32 exec_hi, -1
    s_waitcnt lgkmcnt(10)
    v_mfma_f32_32x32x16_bf16 v[144:159], v[240:243], v[48:51], v[144:159]
    ds_read_b64_tr_b16 v[120:121], v8 offset:58016
    ds_read_b64_tr_b16 v[122:123], v8 offset:58912
    s_add_u32 m0, s37, 33664
    s_add_u32 s75, s36, 1046528
    s_mov_b32 exec_hi, 0xffffff
    buffer_load_dwordx4 v1, s[56:59], s75 offen  lds
    s_mov_b32 exec_hi, -1
    s_waitcnt lgkmcnt(10)
    v_mfma_f32_32x32x16_bf16 v[160:175], v[244:247], v[48:51], v[160:175]
    ds_read_b64_tr_b16 v[124:125], v8 offset:58048
    ds_read_b64_tr_b16 v[126:127], v8 offset:58944
    s_waitcnt lgkmcnt(10)
    v_mfma_f32_32x32x16_bf16 v[176:191], v[248:251], v[48:51], v[176:191]
    ds_read_b64_tr_b16 v[240:241], v9 offset:57856
    ds_read_b64_tr_b16 v[242:243], v9 offset:58752
    s_add_u32 m0, s37, 34560
    s_add_u32 s75, s36, 1060864
    s_mov_b32 exec_hi, 0xffffff
    buffer_load_dwordx4 v1, s[56:59], s75 offen  lds
    s_mov_b32 exec_hi, -1
    s_waitcnt lgkmcnt(6)
    v_mfma_f32_32x32x16_bf16 v[192:207], v[116:119], v[48:51], v[192:207]
    ds_read_b64_tr_b16 v[244:245], v9 offset:57888
    ds_read_b64_tr_b16 v[246:247], v9 offset:58784
    v_mfma_f32_16x16x32_bf16 v[96:99], v[112:115], v[116:119], v[96:99]
    s_waitcnt lgkmcnt(6)
    v_mfma_f32_32x32x16_bf16 v[208:223], v[120:123], v[48:51], v[208:223]
    ds_read_b64_tr_b16 v[248:249], v9 offset:57920
    ds_read_b64_tr_b16 v[250:251], v9 offset:58816
    v_mfma_f32_16x16x32_bf16 v[100:103], v[112:115], v[120:123], v[100:103]
    s_add_u32 m0, s37, 35456
    s_add_u32 s75, s36, 1075200
    s_mov_b32 exec_hi, 0xffffff
    buffer_load_dwordx4 v1, s[56:59], s75 offen  lds
    s_mov_b32 exec_hi, -1
    s_waitcnt lgkmcnt(6)
    v_mfma_f32_32x32x16_bf16 v[224:239], v[124:127], v[48:51], v[224:239]
    ds_read_b64_tr_b16 v[116:117], v9 offset:57952
    ds_read_b64_tr_b16 v[118:119], v9 offset:58848
    v_mfma_f32_16x16x32_bf16 v[104:107], v[112:115], v[124:127], v[104:107]
L_92:
    s_waitcnt lgkmcnt(6)
    v_mfma_f32_32x32x16_bf16 v[128:143], v[240:243], v[52:55], v[128:143]
    ds_read_b64_tr_b16 v[120:121], v9 offset:57984
    ds_read_b64_tr_b16 v[122:123], v9 offset:58880
    s_add_u32 m0, s37, 61440
    s_add_u32 s75, s36, 1146880
    s_mov_b32 exec_hi, 0xffffff
    buffer_load_dwordx4 v1, s[56:59], s75 offen  lds
    s_mov_b32 exec_hi, -1
    s_waitcnt lgkmcnt(6)
    v_mfma_f32_32x32x16_bf16 v[144:159], v[244:247], v[52:55], v[144:159]
    ds_read_b64_tr_b16 v[124:125], v9 offset:58016
    ds_read_b64_tr_b16 v[126:127], v9 offset:58912
    s_waitcnt lgkmcnt(6)
    v_mfma_f32_32x32x16_bf16 v[160:175], v[248:251], v[52:55], v[160:175]
    ds_read_b64_tr_b16 v[240:241], v9 offset:58048
    ds_read_b64_tr_b16 v[242:243], v9 offset:58944
    s_add_u32 m0, s37, 62336
    s_add_u32 s75, s36, 1161216
    s_mov_b32 exec_hi, 0xffffff
    buffer_load_dwordx4 v1, s[56:59], s75 offen  lds
    s_mov_b32 exec_hi, -1
    s_waitcnt lgkmcnt(6)
    v_mfma_f32_32x32x16_bf16 v[176:191], v[116:119], v[52:55], v[176:191]
    s_waitcnt vmcnt(18)
    s_barrier
    ds_read_b64_tr_b16 v[244:245], v8 offset:0
    ds_read_b64_tr_b16 v[246:247], v8 offset:896
    s_waitcnt lgkmcnt(6)
    v_mfma_f32_32x32x16_bf16 v[192:207], v[120:123], v[52:55], v[192:207]
    ds_read_b64_tr_b16 v[248:249], v8 offset:32
    ds_read_b64_tr_b16 v[250:251], v8 offset:928
    s_add_u32 m0, s37, 63232
    s_add_u32 s75, s36, 1175552
    s_mov_b32 exec_hi, 0xffffff
    buffer_load_dwordx4 v1, s[56:59], s75 offen  lds
    s_mov_b32 exec_hi, -1
    s_waitcnt lgkmcnt(6)
    v_mfma_f32_32x32x16_bf16 v[208:223], v[124:127], v[52:55], v[208:223]
    ds_read_b64_tr_b16 v[116:117], v8 offset:64
    ds_read_b64_tr_b16 v[118:119], v8 offset:960
    s_waitcnt lgkmcnt(6)
    v_mfma_f32_32x32x16_bf16 v[224:239], v[240:243], v[52:55], v[224:239]
    ds_read_b64_tr_b16 v[120:121], v8 offset:96
    ds_read_b64_tr_b16 v[122:123], v8 offset:992
    s_add_u32 m0, s37, 64128
    s_add_u32 s75, s36, 1189888
    s_mov_b32 exec_hi, 0xffffff
    buffer_load_dwordx4 v1, s[56:59], s75 offen  lds
    s_mov_b32 exec_hi, -1
    s_cmp_lg_u32 s34, 0
    s_cbranch_scc1 L_93
    s_waitcnt lgkmcnt(6)
    v_mfma_f32_32x32x16_bf16 v[128:143], v[244:247], v[56:59], v[128:143]
    ds_read_b64_tr_b16 v[124:125], v8 offset:128
    ds_read_b64_tr_b16 v[126:127], v8 offset:1024
    v_mfma_f32_16x16x32_bf16 v[96:99], v[112:115], v[244:247], v[96:99]
    s_waitcnt lgkmcnt(6)
    v_mfma_f32_32x32x16_bf16 v[144:159], v[248:251], v[56:59], v[144:159]
    ds_read_b64_tr_b16 v[240:241], v8 offset:160
    ds_read_b64_tr_b16 v[242:243], v8 offset:1056
    v_mfma_f32_16x16x32_bf16 v[100:103], v[112:115], v[248:251], v[100:103]
    s_waitcnt vmcnt(16)
    s_mov_b64 exec, 1
    ds_add_u32 v2, v3 offset:32
    s_mov_b64 exec, -1
    s_add_u32 m0, s37, 129408
    s_add_u32 s75, s36, 1261568
    s_mov_b32 exec_hi, 0xffffff
    buffer_load_dwordx4 v1, s[56:59], s75 offen  lds
    s_mov_b32 exec_hi, -1
    s_waitcnt lgkmcnt(7)
    v_mfma_f32_32x32x16_bf16 v[160:175], v[116:119], v[56:59], v[160:175]
    ds_read_b64_tr_b16 v[244:245], v8 offset:192
    ds_read_b64_tr_b16 v[246:247], v8 offset:1088
    v_mfma_f32_16x16x32_bf16 v[104:107], v[112:115], v[116:119], v[104:107]
    s_waitcnt lgkmcnt(7)
    v_mfma_f32_32x32x16_bf16 v[176:191], v[120:123], v[56:59], v[176:191]
    ds_read_b64_tr_b16 v[248:249], v9 offset:0
    ds_read_b64_tr_b16 v[250:251], v9 offset:896
    v_mfma_f32_16x16x32_bf16 v[108:111], v[112:115], v[120:123], v[108:111]
    s_waitcnt lgkmcnt(7)
    v_mfma_f32_32x32x16_bf16 v[192:207], v[124:127], v[56:59], v[192:207]
    ds_read_b64_tr_b16 v[116:117], v9 offset:32
    ds_read_b64_tr_b16 v[118:119], v9 offset:928
    ds_read_b32 v15, v2 offset:32
    s_add_u32 m0, s37, 130304
    s_add_u32 s75, s36, 1275904
    s_mov_b32 exec_hi, 0xffffff
    buffer_load_dwordx4 v1, s[56:59], s75 offen  lds
    s_mov_b32 exec_hi, -1
    s_waitcnt lgkmcnt(8)
    v_mfma_f32_32x32x16_bf16 v[208:223], v[240:243], v[56:59], v[208:223]
    ds_read_b64_tr_b16 v[120:121], v9 offset:64
    ds_read_b64_tr_b16 v[122:123], v9 offset:960
    s_waitcnt lgkmcnt(7)
    v_mfma_f32_32x32x16_bf16 v[224:239], v[244:247], v[56:59], v[224:239]
    ds_read_b64_tr_b16 v[124:125], v9 offset:96
    ds_read_b64_tr_b16 v[126:127], v9 offset:992
    s_branch L_94
L_93:
    s_waitcnt lgkmcnt(6)
    v_mfma_f32_32x32x16_bf16 v[128:143], v[244:247], v[56:59], v[128:143]
    ds_read_b64_tr_b16 v[124:125], v8 offset:128
    ds_read_b64_tr_b16 v[126:127], v8 offset:1024
    s_waitcnt lgkmcnt(6)
    v_mfma_f32_32x32x16_bf16 v[144:159], v[248:251], v[56:59], v[144:159]
    ds_read_b64_tr_b16 v[240:241], v8 offset:160
    ds_read_b64_tr_b16 v[242:243], v8 offset:1056
    s_waitcnt vmcnt(16)
    s_mov_b64 exec, 1
    ds_add_u32 v2, v3 offset:32
    s_mov_b64 exec, -1
    s_add_u32 m0, s37, 129408
    s_add_u32 s75, s36, 1261568
    s_mov_b32 exec_hi, 0xffffff
    buffer_load_dwordx4 v1, s[56:59], s75 offen  lds
    s_mov_b32 exec_hi, -1
    s_waitcnt lgkmcnt(7)
    v_mfma_f32_32x32x16_bf16 v[160:175], v[116:119], v[56:59], v[160:175]
    ds_read_b64_tr_b16 v[244:245], v8 offset:192
    ds_read_b64_tr_b16 v[246:247], v8 offset:1088
    s_waitcnt lgkmcnt(7)
    v_mfma_f32_32x32x16_bf16 v[176:191], v[120:123], v[56:59], v[176:191]
    ds_read_b64_tr_b16 v[248:249], v9 offset:0
    ds_read_b64_tr_b16 v[250:251], v9 offset:896
    s_waitcnt lgkmcnt(7)
    v_mfma_f32_32x32x16_bf16 v[192:207], v[124:127], v[56:59], v[192:207]
    ds_read_b64_tr_b16 v[116:117], v9 offset:32
    ds_read_b64_tr_b16 v[118:119], v9 offset:928
    v_mfma_f32_16x16x32_bf16 v[96:99], v[112:115], v[124:127], v[96:99]
    ds_read_b32 v15, v2 offset:32
    s_add_u32 m0, s37, 130304
    s_add_u32 s75, s36, 1275904
    s_mov_b32 exec_hi, 0xffffff
    buffer_load_dwordx4 v1, s[56:59], s75 offen  lds
    s_mov_b32 exec_hi, -1
    s_waitcnt lgkmcnt(8)
    v_mfma_f32_32x32x16_bf16 v[208:223], v[240:243], v[56:59], v[208:223]
    ds_read_b64_tr_b16 v[120:121], v9 offset:64
    ds_read_b64_tr_b16 v[122:123], v9 offset:960
    v_mfma_f32_16x16x32_bf16 v[100:103], v[112:115], v[240:243], v[100:103]
    s_waitcnt lgkmcnt(7)
    v_mfma_f32_32x32x16_bf16 v[224:239], v[244:247], v[56:59], v[224:239]
    ds_read_b64_tr_b16 v[124:125], v9 offset:96
    ds_read_b64_tr_b16 v[126:127], v9 offset:992
    v_mfma_f32_16x16x32_bf16 v[104:107], v[112:115], v[244:247], v[104:107]
L_94:
    s_waitcnt lgkmcnt(7)
    v_mfma_f32_32x32x16_bf16 v[128:143], v[248:251], v[60:63], v[128:143]
    ds_read_b64_tr_b16 v[240:241], v9 offset:128
    ds_read_b64_tr_b16 v[242:243], v9 offset:1024
    s_add_u32 m0, s37, 131200
    s_add_u32 s75, s36, 1290240
    s_mov_b32 exec_hi, 0xffffff
    buffer_load_dwordx4 v1, s[56:59], s75 offen  lds
    s_mov_b32 exec_hi, -1
    s_waitcnt lgkmcnt(7)
    v_mfma_f32_32x32x16_bf16 v[144:159], v[116:119], v[60:63], v[144:159]
    ds_read_b64_tr_b16 v[244:245], v9 offset:160
    ds_read_b64_tr_b16 v[246:247], v9 offset:1056
    s_waitcnt lgkmcnt(6)
    v_mfma_f32_32x32x16_bf16 v[160:175], v[120:123], v[60:63], v[160:175]
    ds_read_b64_tr_b16 v[248:249], v9 offset:192
    ds_read_b64_tr_b16 v[250:251], v9 offset:1088
    s_waitcnt lgkmcnt(6)
    v_mfma_f32_32x32x16_bf16 v[176:191], v[124:127], v[60:63], v[176:191]
    v_readfirstlane_b32 s71, v15
    s_cmp_ge_u32 s71, 4
    s_cbranch_scc1 LD_95
    s_mov_b32 s3, 0x40000
LW_96:
    ds_read_b32 v15, v2 offset:32
    s_waitcnt lgkmcnt(0)
    v_readfirstlane_b32 s71, v15
    s_cmp_ge_u32 s71, 4
    s_cbranch_scc1 LD_97
    s_sub_u32 s3, s3, 1
    s_cmp_lg_u32 s3, 0
    s_cbranch_scc1 LW_96
LD_97:
LD_95:
    ds_read_b64_tr_b16 v[116:117], v8 offset:14464
    ds_read_b64_tr_b16 v[118:119], v8 offset:15360
    s_add_u32 m0, s37, 132096
    s_add_u32 s75, s36, 1304576
    s_mov_b32 exec_hi, 0xffffff
    buffer_load_dwordx4 v1, s[56:59], s75 offen  lds
    s_mov_b32 exec_hi, -1
    s_waitcnt lgkmcnt(6)
    v_mfma_f32_32x32x16_bf16 v[192:207], v[240:243], v[60:63], v[192:207]
    ds_read_b64_tr_b16 v[120:121], v8 offset:14496
    ds_read_b64_tr_b16 v[122:123], v8 offset:15392
    s_waitcnt lgkmcnt(6)
    v_mfma_f32_32x32x16_bf16 v[208:223], v[244:247], v[60:63], v[208:223]
    ds_read_b64_tr_b16 v[124:125], v8 offset:14528
    ds_read_b64_tr_b16 v[126:127], v8 offset:15424
    s_waitcnt lgkmcnt(6)
    v_mfma_f32_32x32x16_bf16 v[224:239], v[248:251], v[60:63], v[224:239]
    ds_read_b64_tr_b16 v[240:241], v8 offset:14560
    ds_read_b64_tr_b16 v[242:243], v8 offset:15456
    s_add_u32 m0, s37, 143872
    s_add_u32 s75, s36, 1376256
    s_mov_b32 exec_hi, 0xffffff
    buffer_load_dwordx4 v1, s[56:59], s75 offen  lds
    s_mov_b32 exec_hi, -1
    s_cmp_lg_u32 s34, 0
    s_cbranch_scc1 L_98
    s_waitcnt lgkmcnt(4)
    v_mfma_f32_32x32x16_bf16 v[128:143], v[116:119], v[64:67], v[128:143]
    ds_read_b64_tr_b16 v[244:245], v8 offset:14592
    ds_read_b64_tr_b16 v[246:247], v8 offset:15488
    ds_read_b64_tr_b16 v[248:249], v8 offset:14624
    ds_read_b64_tr_b16 v[250:251], v8 offset:15520
    v_mfma_f32_16x16x32_bf16 v[96:99], v[112:115], v[116:119], v[96:99]
    v_mfma_f32_32x32x16_bf16 v[144:159], v[120:123], v[64:67], v[144:159]
    ds_read_b64_tr_b16 v[48:49], v8 offset:14656
    ds_read_b64_tr_b16 v[50:51], v8 offset:15552
    ds_read_b64_tr_b16 v[52:53], v9 offset:14464
    ds_read_b64_tr_b16 v[54:55], v9 offset:15360
    v_mfma_f32_16x16x32_bf16 v[100:103], v[112:115], v[120:123], v[100:103]
    s_waitcnt vmcnt(13)
    s_mov_b64 exec, 1
    ds_add_u32 v2, v3 offset:32
    s_mov_b64 exec, -1
    s_add_u32 m0, s37, 144768
    s_add_u32 s75, s36, 1390592
    s_mov_b32 exec_hi, 0xffffff
    buffer_load_dwordx4 v1, s[56:59], s75 offen  lds
    s_mov_b32 exec_hi, -1
    s_waitcnt lgkmcnt(9)
    v_mfma_f32_32x32x16_bf16 v[160:175], v[124:127], v[64:67], v[160:175]
    ds_read_b64_tr_b16 v[116:117], v9 offset:14496
    ds_read_b64_tr_b16 v[118:119], v9 offset:15392
    v_mfma_f32_16x16x32_bf16 v[104:107], v[112:115], v[124:127], v[104:107]
    v_mfma_f32_32x32x16_bf16 v[176:191], v[240:243], v[64:67], v[176:191]
    ds_read_b64_tr_b16 v[120:121], v9 offset:14528
    ds_read_b64_tr_b16 v[122:123], v9 offset:15424
    v_mfma_f32_16x16x32_bf16 v[108:111], v[112:115], v[240:243], v[108:111]
    s_waitcnt lgkmcnt(9)
    v_mfma_f32_32x32x16_bf16 v[192:207], v[244:247], v[64:67], v[192:207]
    ds_read_b64_tr_b16 v[124:125], v9 offset:14560
    ds_read_b64_tr_b16 v[126:127], v9 offset:15456
    ds_read_b32 v15, v2 offset:32
    s_add_u32 m0, s37, 145664
    s_add_u32 s75, s36, 1404928
    s_mov_b32 exec_hi, 0xffffff
    buffer_load_dwordx4 v1, s[56:59], s75 offen  lds
    s_mov_b32 exec_hi, -1
    v_mfma_f32_32x32x16_bf16 v[208:223], v[248:251], v[64:67], v[208:223]
    ds_read_b64_tr_b16 v[240:241], v9 offset:14592
    ds_read_b64_tr_b16 v[242:243], v9 offset:15488
    s_waitcnt lgkmcnt(10)
    v_mfma_f32_32x32x16_bf16 v[224:239], v[48:51], v[64:67], v[224:239]
    ds_read_b64_tr_b16 v[244:245], v9 offset:14624
    ds_read_b64_tr_b16 v[246:247], v9 offset:15520
    s_branch L_99
L_98:
    s_waitcnt lgkmcnt(4)
    v_mfma_f32_32x32x16_bf16 v[128:143], v[116:119], v[64:67], v[128:143]
    ds_read_b64_tr_b16 v[244:245], v8 offset:14592
    ds_read_b64_tr_b16 v[246:247], v8 offset:15488
    ds_read_b64_tr_b16 v[248:249], v8 offset:14624
    ds_read_b64_tr_b16 v[250:251], v8 offset:15520
    v_mfma_f32_32x32x16_bf16 v[144:159], v[120:123], v[64:67], v[144:159]
    ds_read_b64_tr_b16 v[48:49], v8 offset:14656
    ds_read_b64_tr_b16 v[50:51], v8 offset:15552
    ds_read_b64_tr_b16 v[52:53], v9 offset:14464
    ds_read_b64_tr_b16 v[54:55], v9 offset:15360
    s_waitcnt vmcnt(13)
    s_mov_b64 exec, 1
    ds_add_u32 v2, v3 offset:32
    s_mov_b64 exec, -1
    s_add_u32 m0, s37, 144768
    s_add_u32 s75, s36, 1390592
    s_mov_b32 exec_hi, 0xffffff
    buffer_load_dwordx4 v1, s[56:59], s75 offen  lds
    s_mov_b32 exec_hi, -1
    s_waitcnt lgkmcnt(9)
    v_mfma_f32_32x32x16_bf16 v[160:175], v[124:127], v[64:67], v[160:175]
    ds_read_b64_tr_b16 v[116:117], v9 offset:14496
    ds_read_b64_tr_b16 v[118:119], v9 offset:15392
    v_mfma_f32_32x32x16_bf16 v[176:191], v[240:243], v[64:67], v[176:191]
    ds_read_b64_tr_b16 v[120:121], v9 offset:14528
    ds_read_b64_tr_b16 v[122:123], v9 offset:15424
    s_waitcnt lgkmcnt(9)
    v_mfma_f32_32x32x16_bf16 v[192:207], v[244:247], v[64:67], v[192:207]
    ds_read_b64_tr_b16 v[124:125], v9 offset:14560
    ds_read_b64_tr_b16 v[126:127], v9 offset:15456
    v_mfma_f32_16x16x32_bf16 v[96:99], v[112:115], v[244:247], v[96:99]
    ds_read_b32 v15, v2 offset:32
    s_add_u32 m0, s37, 145664
    s_add_u32 s75, s36, 1404928
    s_mov_b32 exec_hi, 0xffffff
    buffer_load_dwordx4 v1, s[56:59], s75 offen  lds
    s_mov_b32 exec_hi, -1
    v_mfma_f32_32x32x16_bf16 v[208:223], v[248:251], v[64:67], v[208:223]
    ds_read_b64_tr_b16 v[240:241], v9 offset:14592
    ds_read_b64_tr_b16 v[242:243], v9 offset:15488
    v_mfma_f32_16x16x32_bf16 v[100:103], v[112:115], v[248:251], v[100:103]
    s_waitcnt lgkmcnt(10)
    v_mfma_f32_32x32x16_bf16 v[224:239], v[48:51], v[64:67], v[224:239]
    ds_read_b64_tr_b16 v[244:245], v9 offset:14624
    ds_read_b64_tr_b16 v[246:247], v9 offset:15520
    v_mfma_f32_16x16x32_bf16 v[104:107], v[112:115], v[48:51], v[104:107]
L_99:
    v_mfma_f32_32x32x16_bf16 v[128:143], v[52:55], v[68:71], v[128:143]
    ds_read_b64_tr_b16 v[248:249], v9 offset:14656
    ds_read_b64_tr_b16 v[250:251], v9 offset:15552
    s_add_u32 m0, s37, 146560
    s_add_u32 s75, s36, 1419264
    s_mov_b32 exec_hi, 0xffffff
    buffer_load_dwordx4 v1, s[56:59], s75 offen  lds
    s_mov_b32 exec_hi, -1
    s_waitcnt lgkmcnt(9)
    v_mfma_f32_32x32x16_bf16 v[144:159], v[116:119], v[68:71], v[144:159]
    s_waitcnt lgkmcnt(6)
    v_readfirstlane_b32 s71, v15
    s_cmp_ge_u32 s71, 8
    s_cbranch_scc1 LD_100
    s_mov_b32 s3, 0x40000
LW_101:
    ds_read_b32 v15, v2 offset:32
    s_waitcnt lgkmcnt(0)
    v_readfirstlane_b32 s71, v15
    s_cmp_ge_u32 s71, 8
    s_cbranch_scc1 LD_102
    s_sub_u32 s3, s3, 1
    s_cmp_lg_u32 s3, 0
    s_cbranch_scc1 LW_101
LD_102:
LD_100:
    ds_read_b64_tr_b16 v[48:49], v8 offset:28928
    ds_read_b64_tr_b16 v[50:51], v8 offset:29824
    v_mfma_f32_32x32x16_bf16 v[160:175], v[120:123], v[68:71], v[160:175]
    ds_read_b64_tr_b16 v[52:53], v8 offset:28960
    ds_read_b64_tr_b16 v[54:55], v8 offset:29856
    s_waitcnt lgkmcnt(8)
    v_mfma_f32_32x32x16_bf16 v[176:191], v[124:127], v[68:71], v[176:191]
    ds_read_b64_tr_b16 v[116:117], v8 offset:28992
    ds_read_b64_tr_b16 v[118:119], v8 offset:29888
    s_add_u32 m0, s37, 86016
    s_add_u32 s75, s36, 1490944
    s_mov_b32 exec_hi, 0xffffff
    buffer_load_dwordx4 v1, s[56:59], s75 offen  lds
    s_mov_b32 exec_hi, -1
    v_mfma_f32_32x32x16_bf16 v[192:207], v[240:243], v[68:71], v[192:207]
    ds_read_b64_tr_b16 v[120:121], v8 offset:29024
    ds_read_b64_tr_b16 v[122:123], v8 offset:29920
    s_waitcnt lgkmcnt(8)
    v_mfma_f32_32x32x16_bf16 v[208:223], v[244:247], v[68:71], v[208:223]
    ds_read_b64_tr_b16 v[124:125], v8 offset:29056
    ds_read_b64_tr_b16 v[126:127], v8 offset:29952
    v_mfma_f32_32x32x16_bf16 v[224:239], v[248:251], v[68:71], v[224:239]
    ds_read_b64_tr_b16 v[240:241], v8 offset:29088
    ds_read_b64_tr_b16 v[242:243], v8 offset:29984
    s_add_u32 m0, s37, 86912
    s_add_u32 s75, s36, 1505280
    s_mov_b32 exec_hi, 0xffffff
    buffer_load_dwordx4 v1, s[56:59], s75 offen  lds
    s_mov_b32 exec_hi, -1
    s_cmp_lg_u32 s34, 0
    s_cbranch_scc1 L_103
    s_waitcnt lgkmcnt(8)
    v_mfma_f32_32x32x16_bf16 v[128:143], v[48:51], v[72:75], v[128:143]
    ds_read_b64_tr_b16 v[244:245], v8 offset:29120
    ds_read_b64_tr_b16 v[246:247], v8 offset:30016
    v_mfma_f32_16x16x32_bf16 v[96:99], v[112:115], v[48:51], v[96:99]
    v_mfma_f32_32x32x16_bf16 v[144:159], v[52:55], v[72:75], v[144:159]
    ds_read_b64_tr_b16 v[248:249], v9 offset:28928
    ds_read_b64_tr_b16 v[250:251], v9 offset:29824
    v_mfma_f32_16x16x32_bf16 v[100:103], v[112:115], v[52:55], v[100:103]
    s_mov_b64 exec, 1
    ds_add_u32 v2, v3 offset:32
    s_mov_b64 exec, -1
    s_add_u32 m0, s37, 87808
    s_add_u32 s75, s36, 1519616
    s_mov_b32 exec_hi, 0xffffff
    buffer_load_dwordx4 v1, s[56:59], s75 offen  lds
    s_mov_b32 exec_hi, -1
    s_waitcnt lgkmcnt(9)
    v_mfma_f32_32x32x16_bf16 v[160:175], v[116:119], v[72:75], v[160:175]
    ds_read_b64_tr_b16 v[48:49], v9 offset:28960
    ds_read_b64_tr_b16 v[50:51], v9 offset:29856
    v_mfma_f32_16x16x32_bf16 v[104:107], v[112:115], v[116:119], v[104:107]
    v_mfma_f32_32x32x16_bf16 v[176:191], v[120:123], v[72:75], v[176:191]
    ds_read_b64_tr_b16 v[52:53], v9 offset:28992
    ds_read_b64_tr_b16 v[54:55], v9 offset:29888
    v_mfma_f32_16x16x32_bf16 v[108:111], v[112:115], v[120:123], v[108:111]
    s_waitcnt lgkmcnt(9)
    v_mfma_f32_32x32x16_bf16 v[192:207], v[124:127], v[72:75], v[192:207]
    ds_read_b64_tr_b16 v[116:117], v9 offset:29024
    ds_read_b64_tr_b16 v[118:119], v9 offset:29920
    ds_read_b32 v15, v2 offset:32
    s_add_u32 m0, s37, 88704
    s_add_u32 s75, s36, 1533952
    s_mov_b32 exec_hi, 0xffffff
    buffer_load_dwordx4 v1, s[56:59], s75 offen  lds
    s_mov_b32 exec_hi, -1
    v_mfma_f32_32x32x16_bf16 v[208:223], v[240:243], v[72:75], v[208:223]
    ds_read_b64_tr_b16 v[120:121], v9 offset:29056
    ds_read_b64_tr_b16 v[122:123], v9 offset:29952
    s_waitcnt lgkmcnt(10)
    v_mfma_f32_32x32x16_bf16 v[224:239], v[244:247], v[72:75], v[224:239]
    ds_read_b64_tr_b16 v[124:125], v9 offset:29088
    ds_read_b64_tr_b16 v[126:127], v9 offset:29984
    s_branch L_104
L_103:
    s_waitcnt lgkmcnt(8)
    v_mfma_f32_32x32x16_bf16 v[128:143], v[48:51], v[72:75], v[128:143]
    ds_read_b64_tr_b16 v[244:245], v8 offset:29120
    ds_read_b64_tr_b16 v[246:247], v8 offset:30016
    v_mfma_f32_32x32x16_bf16 v[144:159], v[52:55], v[72:75], v[144:159]
    ds_read_b64_tr_b16 v[248:249], v9 offset:28928
    ds_read_b64_tr_b16 v[250:251], v9 offset:29824
    s_mov_b64 exec, 1
    ds_add_u32 v2, v3 offset:32
    s_mov_b64 exec, -1
    s_add_u32 m0, s37, 87808
    s_add_u32 s75, s36, 1519616
    s_mov_b32 exec_hi, 0xffffff
    buffer_load_dwordx4 v1, s[56:59], s75 offen  lds
    s_mov_b32 exec_hi, -1
    s_waitcnt lgkmcnt(9)
    v_mfma_f32_32x32x16_bf16 v[160:175], v[116:119], v[72:75], v[160:175]
    ds_read_b64_tr_b16 v[48:49], v9 offset:28960
    ds_read_b64_tr_b16 v[50:51], v9 offset:29856
    v_mfma_f32_32x32x16_bf16 v[176:191], v[120:123], v[72:75], v[176:191]
    ds_read_b64_tr_b16 v[52:53], v9 offset:28992
    ds_read_b64_tr_b16 v[54:55], v9 offset:29888
    s_waitcnt lgkmcnt(9)
    v_mfma_f32_32x32x16_bf16 v[192:207], v[124:127], v[72:75], v[192:207]
    ds_read_b64_tr_b16 v[116:117], v9 offset:29024
    ds_read_b64_tr_b16 v[118:119], v9 offset:29920
    v_mfma_f32_16x16x32_bf16 v[96:99], v[112:115], v[124:127], v[96:99]
    ds_read_b32 v15, v2 offset:32
    s_add_u32 m0, s37, 88704
    s_add_u32 s75, s36, 1533952
    s_mov_b32 exec_hi, 0xffffff
    buffer_load_dwordx4 v1, s[56:59], s75 offen  lds
    s_mov_b32 exec_hi, -1
    v_mfma_f32_32x32x16_bf16 v[208:223], v[240:243], v[72:75], v[208:223]
    ds_read_b64_tr_b16 v[120:121], v9 offset:29056
    ds_read_b64_tr_b16 v[122:123], v9 offset:29952
    v_mfma_f32_16x16x32_bf16 v[100:103], v[112:115], v[240:243], v[100:103]
    s_waitcnt lgkmcnt(10)
    v_mfma_f32_32x32x16_bf16 v[224:239], v[244:247], v[72:75], v[224:239]
    ds_read_b64_tr_b16 v[124:125], v9 offset:29088
    ds_read_b64_tr_b16 v[126:127], v9 offset:29984
    v_mfma_f32_16x16x32_bf16 v[104:107], v[112:115], v[244:247], v[104:107]
L_104:
    v_mfma_f32_32x32x16_bf16 v[128:143], v[248:251], v[76:79], v[128:143]
    ds_read_b64_tr_b16 v[240:241], v9 offset:29120
    ds_read_b64_tr_b16 v[242:243], v9 offset:30016
    s_waitcnt lgkmcnt(9)
    v_mfma_f32_32x32x16_bf16 v[144:159], v[48:51], v[76:79], v[144:159]
    s_waitcnt lgkmcnt(6)
    v_readfirstlane_b32 s71, v15
    s_cmp_ge_u32 s71, 12
    s_cbranch_scc1 LD_105
    s_mov_b32 s3, 0x40000
LW_106:
    ds_read_b32 v15, v2 offset:32
    s_waitcnt lgkmcnt(0)
    v_readfirstlane_b32 s71, v15
    s_cmp_ge_u32 s71, 12
    s_cbranch_scc1 LD_107
    s_sub_u32 s3, s3, 1
    s_cmp_lg_u32 s3, 0
    s_cbranch_scc1 LW_106
LD_107:
LD_105:
    ds_read_b64_tr_b16 v[244:245], v12 offset:0
    ds_read_b64_tr_b16 v[246:247], v12 offset:896
    v_mfma_f32_32x32x16_bf16 v[160:175], v[52:55], v[76:79], v[160:175]
    ds_read_b64_tr_b16 v[248:249], v12 offset:32
    ds_read_b64_tr_b16 v[250:251], v12 offset:928
    s_waitcnt lgkmcnt(8)
    v_mfma_f32_32x32x16_bf16 v[176:191], v[116:119], v[76:79], v[176:191]
    ds_read_b64_tr_b16 v[48:49], v12 offset:64
    ds_read_b64_tr_b16 v[50:51], v12 offset:960
    v_mfma_f32_32x32x16_bf16 v[192:207], v[120:123], v[76:79], v[192:207]
    ds_read_b64_tr_b16 v[52:53], v12 offset:96
    ds_read_b64_tr_b16 v[54:55], v12 offset:992
    s_waitcnt lgkmcnt(8)
    v_mfma_f32_32x32x16_bf16 v[208:223], v[124:127], v[76:79], v[208:223]
    ds_read_b64_tr_b16 v[116:117], v12 offset:128
    ds_read_b64_tr_b16 v[118:119], v12 offset:1024
    v_mfma_f32_32x32x16_bf16 v[224:239], v[240:243], v[76:79], v[224:239]
    ds_read_b64_tr_b16 v[120:121], v12 offset:160
    ds_read_b64_tr_b16 v[122:123], v12 offset:1056
    s_cmp_lg_u32 s34, 0
    s_cbranch_scc1 L_108
    s_waitcnt lgkmcnt(8)
    v_mfma_f32_32x32x16_bf16 v[128:143], v[244:247], v[80:83], v[128:143]
    ds_read_b64_tr_b16 v[124:125], v12 offset:192
    ds_read_b64_tr_b16 v[126:127], v12 offset:1088
    v_mfma_f32_16x16x32_bf16 v[96:99], v[112:115], v[244:247], v[96:99]
    v_mfma_f32_32x32x16_bf16 v[144:159], v[248:251], v[80:83], v[144:159]
    ds_read_b64_tr_b16 v[240:241], v13 offset:0
    ds_read_b64_tr_b16 v[242:243], v13 offset:896
    v_mfma_f32_16x16x32_bf16 v[100:103], v[112:115], v[248:251], v[100:103]
    s_waitcnt vmcnt(16)
    s_mov_b64 exec, 1
    ds_add_u32 v2, v3 offset:32
    s_mov_b64 exec, -1
    s_waitcnt lgkmcnt(9)
    v_mfma_f32_32x32x16_bf16 v[160:175], v[48:51], v[80:83], v[160:175]
    ds_read_b64_tr_b16 v[244:245], v13 offset:32
    ds_read_b64_tr_b16 v[246:247], v13 offset:928
    v_mfma_f32_16x16x32_bf16 v[104:107], v[112:115], v[48:51], v[104:107]
    v_mfma_f32_32x32x16_bf16 v[176:191], v[52:55], v[80:83], v[176:191]
    ds_read_b64_tr_b16 v[248:249], v13 offset:64
    ds_read_b64_tr_b16 v[250:251], v13 offset:960
    v_mfma_f32_16x16x32_bf16 v[108:111], v[112:115], v[52:55], v[108:111]
    s_waitcnt lgkmcnt(9)
    v_mfma_f32_32x32x16_bf16 v[192:207], v[116:119], v[80:83], v[192:207]
    ds_read_b64_tr_b16 v[48:49], v13 offset:96
    ds_read_b64_tr_b16 v[50:51], v13 offset:992
    ds_read_b32 v15, v2 offset:32
    v_mfma_f32_32x32x16_bf16 v[208:223], v[120:123], v[80:83], v[208:223]
    ds_read_b64_tr_b16 v[52:53], v13 offset:128
    ds_read_b64_tr_b16 v[54:55], v13 offset:1024
    s_waitcnt lgkmcnt(10)
    v_mfma_f32_32x32x16_bf16 v[224:239], v[124:127], v[80:83], v[224:239]
    ds_read_b64_tr_b16 v[116:117], v13 offset:160
    ds_read_b64_tr_b16 v[118:119], v13 offset:1056
    s_branch L_109
L_108:
    s_waitcnt lgkmcnt(8)
    v_mfma_f32_32x32x16_bf16 v[128:143], v[244:247], v[80:83], v[128:143]
    ds_read_b64_tr_b16 v[124:125], v12 offset:192
    ds_read_b64_tr_b16 v[126:127], v12 offset:1088
    v_mfma_f32_32x32x16_bf16 v[144:159], v[248:251], v[80:83], v[144:159]
    ds_read_b64_tr_b16 v[240:241], v13 offset:0
    ds_read_b64_tr_b16 v[242:243], v13 offset:896
    s_waitcnt vmcnt(16)
    s_mov_b64 exec, 1
    ds_add_u32 v2, v3 offset:32
    s_mov_b64 exec, -1
    s_waitcnt lgkmcnt(9)
    v_mfma_f32_32x32x16_bf16 v[160:175], v[48:51], v[80:83], v[160:175]
    ds_read_b64_tr_b16 v[244:245], v13 offset:32
    ds_read_b64_tr_b16 v[246:247], v13 offset:928
    v_mfma_f32_32x32x16_bf16 v[176:191], v[52:55], v[80:83], v[176:191]
    ds_read_b64_tr_b16 v[248:249], v13 offset:64
    ds_read_b64_tr_b16 v[250:251], v13 offset:960
    s_waitcnt lgkmcnt(9)
    v_mfma_f32_32x32x16_bf16 v[192:207], v[116:119], v[80:83], v[192:207]
    ds_read_b64_tr_b16 v[48:49], v13 offset:96
    ds_read_b64_tr_b16 v[50:51], v13 offset:992
    v_mfma_f32_16x16x32_bf16 v[96:99], v[112:115], v[116:119], v[96:99]
    ds_read_b32 v15, v2 offset:32
    v_mfma_f32_32x32x16_bf16 v[208:223], v[120:123], v[80:83], v[208:223]
    ds_read_b64_tr_b16 v[52:53], v13 offset:128
    ds_read_b64_tr_b16 v[54:55], v13 offset:1024
    v_mfma_f32_16x16x32_bf16 v[100:103], v[112:115], v[120:123], v[100:103]
    s_waitcnt lgkmcnt(10)
    v_mfma_f32_32x32x16_bf16 v[224:239], v[124:127], v[80:83], v[224:239]
    ds_read_b64_tr_b16 v[116:117], v13 offset:160
    ds_read_b64_tr_b16 v[118:119], v13 offset:1056
    v_mfma_f32_16x16x32_bf16 v[104:107], v[112:115], v[124:127], v[104:107]
L_109:
    v_mfma_f32_32x32x16_bf16 v[128:143], v[240:243], v[84:87], v[128:143]
    ds_read_b64_tr_b16 v[120:121], v13 offset:192
    ds_read_b64_tr_b16 v[122:123], v13 offset:1088
    s_waitcnt lgkmcnt(9)
    v_mfma_f32_32x32x16_bf16 v[144:159], v[244:247], v[84:87], v[144:159]
    s_waitcnt lgkmcnt(6)
    v_readfirstlane_b32 s71, v15
    s_cmp_ge_u32 s71, 16
    s_cbranch_scc1 LD_110
    s_mov_b32 s3, 0x40000
LW_111:
    ds_read_b32 v15, v2 offset:32
    s_waitcnt lgkmcnt(0)
    v_readfirstlane_b32 s71, v15
    s_cmp_ge_u32 s71, 16
    s_cbranch_scc1 LD_112
    s_sub_u32 s3, s3, 1
    s_cmp_lg_u32 s3, 0
    s_cbranch_scc1 LW_111
LD_112:
LD_110:
    ds_read_b64_tr_b16 v[124:125], v12 offset:16384
    ds_read_b64_tr_b16 v[126:127], v12 offset:17280
    v_mfma_f32_32x32x16_bf16 v[160:175], v[248:251], v[84:87], v[160:175]
    ds_read_b64_tr_b16 v[240:241], v12 offset:16416
    ds_read_b64_tr_b16 v[242:243], v12 offset:17312
    s_waitcnt lgkmcnt(8)
    v_mfma_f32_32x32x16_bf16 v[176:191], v[48:51], v[84:87], v[176:191]
    ds_read_b64_tr_b16 v[244:245], v12 offset:16448
    ds_read_b64_tr_b16 v[246:247], v12 offset:17344
    v_mfma_f32_32x32x16_bf16 v[192:207], v[52:55], v[84:87], v[192:207]
    ds_read_b64_tr_b16 v[248:249], v12 offset:16480
    ds_read_b64_tr_b16 v[250:251], v12 offset:17376
    s_waitcnt lgkmcnt(8)
    v_mfma_f32_32x32x16_bf16 v[208:223], v[116:119], v[84:87], v[208:223]
    ds_read_b64_tr_b16 v[48:49], v12 offset:16512
    ds_read_b64_tr_b16 v[50:51], v12 offset:17408
    v_mfma_f32_32x32x16_bf16 v[224:239], v[120:123], v[84:87], v[224:239]
    ds_read_b64_tr_b16 v[52:53], v12 offset:16544
    ds_read_b64_tr_b16 v[54:55], v12 offset:17440
    s_cmp_lg_u32 s34, 0
    s_cbranch_scc1 L_113
    s_waitcnt lgkmcnt(8)
    v_mfma_f32_32x32x16_bf16 v[128:143], v[124:127], v[88:91], v[128:143]
    ds_read_b64_tr_b16 v[116:117], v12 offset:16576
    ds_read_b64_tr_b16 v[118:119], v12 offset:17472
    v_mfma_f32_16x16x32_bf16 v[96:99], v[112:115], v[124:127], v[96:99]
    v_mfma_f32_32x32x16_bf16 v[144:159], v[240:243], v[88:91], v[144:159]
    ds_read_b64_tr_b16 v[120:121], v13 offset:16384
    ds_read_b64_tr_b16 v[122:123], v13 offset:17280
    v_mfma_f32_16x16x32_bf16 v[100:103], v[112:115], v[240:243], v[100:103]
    s_waitcnt vmcnt(12)
    s_mov_b64 exec, 1
    ds_add_u32 v2, v3 offset:32
    s_mov_b64 exec, -1
    s_waitcnt lgkmcnt(9)
    v_mfma_f32_32x32x16_bf16 v[160:175], v[244:247], v[88:91], v[160:175]
    ds_read_b64_tr_b16 v[124:125], v13 offset:16416
    ds_read_b64_tr_b16 v[126:127], v13 offset:17312
    v_mfma_f32_16x16x32_bf16 v[104:107], v[112:115], v[244:247], v[104:107]
    v_mfma_f32_32x32x16_bf16 v[176:191], v[248:251], v[88:91], v[176:191]
    ds_read_b64_tr_b16 v[240:241], v13 offset:16448
    ds_read_b64_tr_b16 v[242:243], v13 offset:17344
    v_mfma_f32_16x16x32_bf16 v[108:111], v[112:115], v[248:251], v[108:111]
    s_waitcnt lgkmcnt(9)
    v_mfma_f32_32x32x16_bf16 v[192:207], v[48:51], v[88:91], v[192:207]
    ds_read_b64_tr_b16 v[244:245], v13 offset:16480
    ds_read_b64_tr_b16 v[246:247], v13 offset:17376
    ds_read_b32 v15, v2 offset:32
    v_mfma_f32_32x32x16_bf16 v[208:223], v[52:55], v[88:91], v[208:223]
    ds_read_b64_tr_b16 v[248:249], v13 offset:16512
    ds_read_b64_tr_b16 v[250:251], v13 offset:17408
    s_waitcnt lgkmcnt(10)
    v_mfma_f32_32x32x16_bf16 v[224:239], v[116:119], v[88:91], v[224:239]
    ds_read_b64_tr_b16 v[48:49], v13 offset:16544
    ds_read_b64_tr_b16 v[50:51], v13 offset:17440
    s_branch L_114
L_113:
    s_waitcnt lgkmcnt(8)
    v_mfma_f32_32x32x16_bf16 v[128:143], v[124:127], v[88:91], v[128:143]
    ds_read_b64_tr_b16 v[116:117], v12 offset:16576
    ds_read_b64_tr_b16 v[118:119], v12 offset:17472
    v_mfma_f32_32x32x16_bf16 v[144:159], v[240:243], v[88:91], v[144:159]
    ds_read_b64_tr_b16 v[120:121], v13 offset:16384
    ds_read_b64_tr_b16 v[122:123], v13 offset:17280
    s_waitcnt vmcnt(12)
    s_mov_b64 exec, 1
    ds_add_u32 v2, v3 offset:32
    s_mov_b64 exec, -1
    s_waitcnt lgkmcnt(9)
    v_mfma_f32_32x32x16_bf16 v[160:175], v[244:247], v[88:91], v[160:175]
    ds_read_b64_tr_b16 v[124:125], v13 offset:16416
    ds_read_b64_tr_b16 v[126:127], v13 offset:17312
    v_mfma_f32_32x32x16_bf16 v[176:191], v[248:251], v[88:91], v[176:191]
    ds_read_b64_tr_b16 v[240:241], v13 offset:16448
    ds_read_b64_tr_b16 v[242:243], v13 offset:17344
    s_waitcnt lgkmcnt(9)
    v_mfma_f32_32x32x16_bf16 v[192:207], v[48:51], v[88:91], v[192:207]
    ds_read_b64_tr_b16 v[244:245], v13 offset:16480
    ds_read_b64_tr_b16 v[246:247], v13 offset:17376
    v_mfma_f32_16x16x32_bf16 v[96:99], v[112:115], v[48:51], v[96:99]
    ds_read_b32 v15, v2 offset:32
    v_mfma_f32_32x32x16_bf16 v[208:223], v[52:55], v[88:91], v[208:223]
    ds_read_b64_tr_b16 v[248:249], v13 offset:16512
    ds_read_b64_tr_b16 v[250:251], v13 offset:17408
    v_mfma_f32_16x16x32_bf16 v[100:103], v[112:115], v[52:55], v[100:103]
    s_waitcnt lgkmcnt(10)
    v_mfma_f32_32x32x16_bf16 v[224:239], v[116:119], v[88:91], v[224:239]
    ds_read_b64_tr_b16 v[48:49], v13 offset:16544
    ds_read_b64_tr_b16 v[50:51], v13 offset:17440
    v_mfma_f32_16x16x32_bf16 v[104:107], v[112:115], v[116:119], v[104:107]
L_114:
    v_mfma_f32_32x32x16_bf16 v[128:143], v[120:123], v[92:95], v[128:143]
    ds_read_b64_tr_b16 v[52:53], v13 offset:16576
    ds_read_b64_tr_b16 v[54:55], v13 offset:17472
    s_waitcnt lgkmcnt(9)
    v_mfma_f32_32x32x16_bf16 v[144:159], v[124:127], v[92:95], v[144:159]
    s_waitcnt lgkmcnt(6)
    v_readfirstlane_b32 s71, v15
    s_cmp_ge_u32 s71, 20
    s_cbranch_scc1 LD_115
    s_mov_b32 s3, 0x40000
LW_116:
    ds_read_b32 v15, v2 offset:32
    s_waitcnt lgkmcnt(0)
    v_readfirstlane_b32 s71, v15
    s_cmp_ge_u32 s71, 20
    s_cbranch_scc1 LD_117
    s_sub_u32 s3, s3, 1
    s_cmp_lg_u32 s3, 0
    s_cbranch_scc1 LW_116
LD_117:
LD_115:
    ds_read_b64_tr_b16 v[116:117], v12 offset:45056
    ds_read_b64_tr_b16 v[118:119], v12 offset:45952
    v_mfma_f32_32x32x16_bf16 v[160:175], v[240:243], v[92:95], v[160:175]
    ds_read_b64_tr_b16 v[120:121], v12 offset:45088
    ds_read_b64_tr_b16 v[122:123], v12 offset:45984
    s_waitcnt lgkmcnt(8)
    v_mfma_f32_32x32x16_bf16 v[176:191], v[244:247], v[92:95], v[176:191]
    ds_read_b64_tr_b16 v[124:125], v12 offset:45120
    ds_read_b64_tr_b16 v[126:127], v12 offset:46016
    v_mfma_f32_32x32x16_bf16 v[192:207], v[248:251], v[92:95], v[192:207]
    ds_read_b64_tr_b16 v[240:241], v12 offset:45152
    ds_read_b64_tr_b16 v[242:243], v12 offset:46048
    s_waitcnt lgkmcnt(8)
    v_mfma_f32_32x32x16_bf16 v[208:223], v[48:51], v[92:95], v[208:223]
    ds_read_b64_tr_b16 v[244:245], v12 offset:45184
    ds_read_b64_tr_b16 v[246:247], v12 offset:46080
    v_mfma_f32_32x32x16_bf16 v[224:239], v[52:55], v[92:95], v[224:239]
    ds_read_b64_tr_b16 v[248:249], v12 offset:45216
    ds_read_b64_tr_b16 v[250:251], v12 offset:46112
    s_cmp_lg_u32 s34, 0
    s_cbranch_scc1 L_118
    s_waitcnt lgkmcnt(8)
    v_mfma_f32_32x32x16_bf16 v[128:143], v[116:119], v[16:19], v[128:143]
    ds_read_b64_tr_b16 v[48:49], v12 offset:45248
    ds_read_b64_tr_b16 v[50:51], v12 offset:46144
    v_mfma_f32_16x16x32_bf16 v[96:99], v[112:115], v[116:119], v[96:99]
    v_mfma_f32_32x32x16_bf16 v[144:159], v[120:123], v[16:19], v[144:159]
    ds_read_b64_tr_b16 v[52:53], v13 offset:45056
    ds_read_b64_tr_b16 v[54:55], v13 offset:45952
    v_mfma_f32_16x16x32_bf16 v[100:103], v[112:115], v[120:123], v[100:103]
    s_waitcnt vmcnt(8)
    s_mov_b64 exec, 1
    ds_add_u32 v2, v3 offset:32
    s_mov_b64 exec, -1
    s_waitcnt lgkmcnt(9)
    v_mfma_f32_32x32x16_bf16 v[160:175], v[124:127], v[16:19], v[160:175]
    ds_read_b64_tr_b16 v[116:117], v13 offset:45088
    ds_read_b64_tr_b16 v[118:119], v13 offset:45984
    v_mfma_f32_16x16x32_bf16 v[104:107], v[112:115], v[124:127], v[104:107]
    v_mfma_f32_32x32x16_bf16 v[176:191], v[240:243], v[16:19], v[176:191]
    ds_read_b64_tr_b16 v[120:121], v13 offset:45120
    ds_read_b64_tr_b16 v[122:123], v13 offset:46016
    v_mfma_f32_16x16x32_bf16 v[108:111], v[112:115], v[240:243], v[108:111]
    s_waitcnt lgkmcnt(9)
    v_mfma_f32_32x32x16_bf16 v[192:207], v[244:247], v[16:19], v[192:207]
    ds_read_b64_tr_b16 v[124:125], v13 offset:45152
    ds_read_b64_tr_b16 v[126:127], v13 offset:46048
    ds_read_b32 v15, v2 offset:32
    v_mfma_f32_32x32x16_bf16 v[208:223], v[248:251], v[16:19], v[208:223]
    ds_read_b64_tr_b16 v[240:241], v13 offset:45184
    ds_read_b64_tr_b16 v[242:243], v13 offset:46080
    s_waitcnt lgkmcnt(10)
    v_mfma_f32_32x32x16_bf16 v[224:239], v[48:51], v[16:19], v[224:239]
    ds_read_b64_tr_b16 v[244:245], v13 offset:45216
    ds_read_b64_tr_b16 v[246:247], v13 offset:46112
    s_branch L_119
L_118:
    s_waitcnt lgkmcnt(8)
    v_mfma_f32_32x32x16_bf16 v[128:143], v[116:119], v[16:19], v[128:143]
    ds_read_b64_tr_b16 v[48:49], v12 offset:45248
    ds_read_b64_tr_b16 v[50:51], v12 offset:46144
    v_mfma_f32_32x32x16_bf16 v[144:159], v[120:123], v[16:19], v[144:159]
    ds_read_b64_tr_b16 v[52:53], v13 offset:45056
    ds_read_b64_tr_b16 v[54:55], v13 offset:45952
    s_waitcnt vmcnt(8)
    s_mov_b64 exec, 1
    ds_add_u32 v2, v3 offset:32
    s_mov_b64 exec, -1
    s_waitcnt lgkmcnt(9)
    v_mfma_f32_32x32x16_bf16 v[160:175], v[124:127], v[16:19], v[160:175]
    ds_read_b64_tr_b16 v[116:117], v13 offset:45088
    ds_read_b64_tr_b16 v[118:119], v13 offset:45984
    v_mfma_f32_32x32x16_bf16 v[176:191], v[240:243], v[16:19], v[176:191]
    ds_read_b64_tr_b16 v[120:121], v13 offset:45120
    ds_read_b64_tr_b16 v[122:123], v13 offset:46016
    s_waitcnt lgkmcnt(9)
    v_mfma_f32_32x32x16_bf16 v[192:207], v[244:247], v[16:19], v[192:207]
    ds_read_b64_tr_b16 v[124:125], v13 offset:45152
    ds_read_b64_tr_b16 v[126:127], v13 offset:46048
    v_mfma_f32_16x16x32_bf16 v[96:99], v[112:115], v[244:247], v[96:99]
    ds_read_b32 v15, v2 offset:32
    v_mfma_f32_32x32x16_bf16 v[208:223], v[248:251], v[16:19], v[208:223]
    ds_read_b64_tr_b16 v[240:241], v13 offset:45184
    ds_read_b64_tr_b16 v[242:243], v13 offset:46080
    v_mfma_f32_16x16x32_bf16 v[100:103], v[112:115], v[248:251], v[100:103]
    s_waitcnt lgkmcnt(10)
    v_mfma_f32_32x32x16_bf16 v[224:239], v[48:51], v[16:19], v[224:239]
    ds_read_b64_tr_b16 v[244:245], v13 offset:45216
    ds_read_b64_tr_b16 v[246:247], v13 offset:46112
    v_mfma_f32_16x16x32_bf16 v[104:107], v[112:115], v[48:51], v[104:107]
L_119:
    v_mfma_f32_32x32x16_bf16 v[128:143], v[52:55], v[20:23], v[128:143]
    ds_read_b64_tr_b16 v[248:249], v13 offset:45248
    ds_read_b64_tr_b16 v[250:251], v13 offset:46144
    s_waitcnt lgkmcnt(9)
    v_mfma_f32_32x32x16_bf16 v[144:159], v[116:119], v[20:23], v[144:159]
    s_waitcnt lgkmcnt(6)
    v_readfirstlane_b32 s71, v15
    s_cmp_ge_u32 s71, 24
    s_cbranch_scc1 LD_120
    s_mov_b32 s3, 0x40000
LW_121:
    ds_read_b32 v15, v2 offset:32
    s_waitcnt lgkmcnt(0)
    v_readfirstlane_b32 s71, v15
    s_cmp_ge_u32 s71, 24
    s_cbranch_scc1 LD_122
    s_sub_u32 s3, s3, 1
    s_cmp_lg_u32 s3, 0
    s_cbranch_scc1 LW_121
LD_122:
LD_120:
    ds_read_b64_tr_b16 v[48:49], v8 offset:43392
    ds_read_b64_tr_b16 v[50:51], v8 offset:44288
    v_mfma_f32_32x32x16_bf16 v[160:175], v[120:123], v[20:23], v[160:175]
    ds_read_b64_tr_b16 v[52:53], v8 offset:43424
    ds_read_b64_tr_b16 v[54:55], v8 offset:44320
    s_waitcnt lgkmcnt(8)
    v_mfma_f32_32x32x16_bf16 v[176:191], v[124:127], v[20:23], v[176:191]
    ds_read_b64_tr_b16 v[116:117], v8 offset:43456
    ds_read_b64_tr_b16 v[118:119], v8 offset:44352
    v_mfma_f32_32x32x16_bf16 v[192:207], v[240:243], v[20:23], v[192:207]
    ds_read_b64_tr_b16 v[120:121], v8 offset:43488
    ds_read_b64_tr_b16 v[122:123], v8 offset:44384
    s_waitcnt lgkmcnt(8)
    v_mfma_f32_32x32x16_bf16 v[208:223], v[244:247], v[20:23], v[208:223]
    ds_read_b64_tr_b16 v[124:125], v8 offset:43520
    ds_read_b64_tr_b16 v[126:127], v8 offset:44416
    v_mfma_f32_32x32x16_bf16 v[224:239], v[248:251], v[20:23], v[224:239]
    ds_read_b64_tr_b16 v[240:241], v8 offset:43552
    ds_read_b64_tr_b16 v[242:243], v8 offset:44448
    s_cmp_lg_u32 s34, 0
    s_cbranch_scc1 L_123
    s_waitcnt lgkmcnt(8)
    v_mfma_f32_32x32x16_bf16 v[128:143], v[48:51], v[24:27], v[128:143]
    ds_read_b64_tr_b16 v[244:245], v8 offset:43584
    ds_read_b64_tr_b16 v[246:247], v8 offset:44480
    v_mfma_f32_16x16x32_bf16 v[96:99], v[112:115], v[48:51], v[96:99]
    v_mfma_f32_32x32x16_bf16 v[144:159], v[52:55], v[24:27], v[144:159]
    ds_read_b64_tr_b16 v[248:249], v9 offset:43392
    ds_read_b64_tr_b16 v[250:251], v9 offset:44288
    v_mfma_f32_16x16x32_bf16 v[100:103], v[112:115], v[52:55], v[100:103]
    s_waitcnt vmcnt(4)
    s_mov_b64 exec, 1
    ds_add_u32 v2, v3 offset:32
    s_mov_b64 exec, -1
    s_waitcnt lgkmcnt(9)
    v_mfma_f32_32x32x16_bf16 v[160:175], v[116:119], v[24:27], v[160:175]
    ds_read_b64_tr_b16 v[48:49], v9 offset:43424
    ds_read_b64_tr_b16 v[50:51], v9 offset:44320
    v_mfma_f32_16x16x32_bf16 v[104:107], v[112:115], v[116:119], v[104:107]
    v_mfma_f32_32x32x16_bf16 v[176:191], v[120:123], v[24:27], v[176:191]
    ds_read_b64_tr_b16 v[52:53], v9 offset:43456
    ds_read_b64_tr_b16 v[54:55], v9 offset:44352
    v_mfma_f32_16x16x32_bf16 v[108:111], v[112:115], v[120:123], v[108:111]
    s_waitcnt lgkmcnt(9)
    v_mfma_f32_32x32x16_bf16 v[192:207], v[124:127], v[24:27], v[192:207]
    ds_read_b64_tr_b16 v[116:117], v9 offset:43488
    ds_read_b64_tr_b16 v[118:119], v9 offset:44384
    ds_read_b32 v15, v2 offset:32
    v_mfma_f32_32x32x16_bf16 v[208:223], v[240:243], v[24:27], v[208:223]
    ds_read_b64_tr_b16 v[120:121], v9 offset:43520
    ds_read_b64_tr_b16 v[122:123], v9 offset:44416
    s_waitcnt lgkmcnt(10)
    v_mfma_f32_32x32x16_bf16 v[224:239], v[244:247], v[24:27], v[224:239]
    ds_read_b64_tr_b16 v[124:125], v9 offset:43552
    ds_read_b64_tr_b16 v[126:127], v9 offset:44448
    s_branch L_124
L_123:
    s_waitcnt lgkmcnt(8)
    v_mfma_f32_32x32x16_bf16 v[128:143], v[48:51], v[24:27], v[128:143]
    ds_read_b64_tr_b16 v[244:245], v8 offset:43584
    ds_read_b64_tr_b16 v[246:247], v8 offset:44480
    v_mfma_f32_32x32x16_bf16 v[144:159], v[52:55], v[24:27], v[144:159]
    ds_read_b64_tr_b16 v[248:249], v9 offset:43392
    ds_read_b64_tr_b16 v[250:251], v9 offset:44288
    s_waitcnt vmcnt(4)
    s_mov_b64 exec, 1
    ds_add_u32 v2, v3 offset:32
    s_mov_b64 exec, -1
    s_waitcnt lgkmcnt(9)
    v_mfma_f32_32x32x16_bf16 v[160:175], v[116:119], v[24:27], v[160:175]
    ds_read_b64_tr_b16 v[48:49], v9 offset:43424
    ds_read_b64_tr_b16 v[50:51], v9 offset:44320
    v_mfma_f32_32x32x16_bf16 v[176:191], v[120:123], v[24:27], v[176:191]
    ds_read_b64_tr_b16 v[52:53], v9 offset:43456
    ds_read_b64_tr_b16 v[54:55], v9 offset:44352
    s_waitcnt lgkmcnt(9)
    v_mfma_f32_32x32x16_bf16 v[192:207], v[124:127], v[24:27], v[192:207]
    ds_read_b64_tr_b16 v[116:117], v9 offset:43488
    ds_read_b64_tr_b16 v[118:119], v9 offset:44384
    v_mfma_f32_16x16x32_bf16 v[96:99], v[112:115], v[124:127], v[96:99]
    ds_read_b32 v15, v2 offset:32
    v_mfma_f32_32x32x16_bf16 v[208:223], v[240:243], v[24:27], v[208:223]
    ds_read_b64_tr_b16 v[120:121], v9 offset:43520
    ds_read_b64_tr_b16 v[122:123], v9 offset:44416
    v_mfma_f32_16x16x32_bf16 v[100:103], v[112:115], v[240:243], v[100:103]
    s_waitcnt lgkmcnt(10)
    v_mfma_f32_32x32x16_bf16 v[224:239], v[244:247], v[24:27], v[224:239]
    ds_read_b64_tr_b16 v[124:125], v9 offset:43552
    ds_read_b64_tr_b16 v[126:127], v9 offset:44448
    v_mfma_f32_16x16x32_bf16 v[104:107], v[112:115], v[244:247], v[104:107]
L_124:
    v_mfma_f32_32x32x16_bf16 v[128:143], v[248:251], v[28:31], v[128:143]
    ds_read_b64_tr_b16 v[240:241], v9 offset:43584
    ds_read_b64_tr_b16 v[242:243], v9 offset:44480
    s_waitcnt lgkmcnt(9)
    v_mfma_f32_32x32x16_bf16 v[144:159], v[48:51], v[28:31], v[144:159]
    s_waitcnt lgkmcnt(6)
    v_readfirstlane_b32 s71, v15
    s_cmp_ge_u32 s71, 28
    s_cbranch_scc1 LD_125
    s_mov_b32 s3, 0x40000
LW_126:
    ds_read_b32 v15, v2 offset:32
    s_waitcnt lgkmcnt(0)
    v_readfirstlane_b32 s71, v15
    s_cmp_ge_u32 s71, 28
    s_cbranch_scc1 LD_127
    s_sub_u32 s3, s3, 1
    s_cmp_lg_u32 s3, 0
    s_cbranch_scc1 LW_126
LD_127:
LD_125:
    ds_read_b64_tr_b16 v[244:245], v8 offset:57856
    ds_read_b64_tr_b16 v[246:247], v8 offset:58752
    v_mfma_f32_32x32x16_bf16 v[160:175], v[52:55], v[28:31], v[160:175]
    ds_read_b64_tr_b16 v[248:249], v8 offset:57888
    ds_read_b64_tr_b16 v[250:251], v8 offset:58784
    s_waitcnt lgkmcnt(8)
    v_mfma_f32_32x32x16_bf16 v[176:191], v[116:119], v[28:31], v[176:191]
    ds_read_b64_tr_b16 v[48:49], v8 offset:57920
    ds_read_b64_tr_b16 v[50:51], v8 offset:58816
    v_mfma_f32_32x32x16_bf16 v[192:207], v[120:123], v[28:31], v[192:207]
    ds_read_b64_tr_b16 v[52:53], v8 offset:57952
    ds_read_b64_tr_b16 v[54:55], v8 offset:58848
    s_waitcnt lgkmcnt(8)
    v_mfma_f32_32x32x16_bf16 v[208:223], v[124:127], v[28:31], v[208:223]
    ds_read_b64_tr_b16 v[116:117], v8 offset:57984
    ds_read_b64_tr_b16 v[118:119], v8 offset:58880
    v_mfma_f32_32x32x16_bf16 v[224:239], v[240:243], v[28:31], v[224:239]
    ds_read_b64_tr_b16 v[120:121], v8 offset:58016
    ds_read_b64_tr_b16 v[122:123], v8 offset:58912
    s_cmp_lg_u32 s34, 0
    s_cbranch_scc1 L_128
    s_waitcnt lgkmcnt(8)
    v_mfma_f32_32x32x16_bf16 v[128:143], v[244:247], v[32:35], v[128:143]
    ds_read_b64_tr_b16 v[124:125], v8 offset:58048
    ds_read_b64_tr_b16 v[126:127], v8 offset:58944
    v_mfma_f32_16x16x32_bf16 v[96:99], v[112:115], v[244:247], v[96:99]
    v_mfma_f32_32x32x16_bf16 v[144:159], v[248:251], v[32:35], v[144:159]
    ds_read_b64_tr_b16 v[240:241], v9 offset:57856
    ds_read_b64_tr_b16 v[242:243], v9 offset:58752
    v_mfma_f32_16x16x32_bf16 v[100:103], v[112:115], v[248:251], v[100:103]
    s_waitcnt vmcnt(0)
    s_mov_b64 exec, 1
    ds_add_u32 v2, v3 offset:32
    s_mov_b64 exec, -1
    s_waitcnt lgkmcnt(9)
    v_mfma_f32_32x32x16_bf16 v[160:175], v[48:51], v[32:35], v[160:175]
    ds_read_b64_tr_b16 v[244:245], v9 offset:57888
    ds_read_b64_tr_b16 v[246:247], v9 offset:58784
    v_mfma_f32_16x16x32_bf16 v[104:107], v[112:115], v[48:51], v[104:107]
    v_mfma_f32_32x32x16_bf16 v[176:191], v[52:55], v[32:35], v[176:191]
    ds_read_b64_tr_b16 v[248:249], v9 offset:57920
    ds_read_b64_tr_b16 v[250:251], v9 offset:58816
    v_mfma_f32_16x16x32_bf16 v[108:111], v[112:115], v[52:55], v[108:111]
    s_waitcnt lgkmcnt(9)
    v_mfma_f32_32x32x16_bf16 v[192:207], v[116:119], v[32:35], v[192:207]
    ds_read_b64_tr_b16 v[48:49], v9 offset:57952
    ds_read_b64_tr_b16 v[50:51], v9 offset:58848
    ds_read_b32 v15, v2 offset:32
    v_mfma_f32_32x32x16_bf16 v[208:223], v[120:123], v[32:35], v[208:223]
    ds_read_b64_tr_b16 v[52:53], v9 offset:57984
    ds_read_b64_tr_b16 v[54:55], v9 offset:58880
    s_waitcnt lgkmcnt(10)
    v_mfma_f32_32x32x16_bf16 v[224:239], v[124:127], v[32:35], v[224:239]
    ds_read_b64_tr_b16 v[116:117], v9 offset:58016
    ds_read_b64_tr_b16 v[118:119], v9 offset:58912
    s_branch L_129
L_128:
    s_waitcnt lgkmcnt(8)
    v_mfma_f32_32x32x16_bf16 v[128:143], v[244:247], v[32:35], v[128:143]
    ds_read_b64_tr_b16 v[124:125], v8 offset:58048
    ds_read_b64_tr_b16 v[126:127], v8 offset:58944
    v_mfma_f32_32x32x16_bf16 v[144:159], v[248:251], v[32:35], v[144:159]
    ds_read_b64_tr_b16 v[240:241], v9 offset:57856
    ds_read_b64_tr_b16 v[242:243], v9 offset:58752
    s_waitcnt vmcnt(0)
    s_mov_b64 exec, 1
    ds_add_u32 v2, v3 offset:32
    s_mov_b64 exec, -1
    s_waitcnt lgkmcnt(9)
    v_mfma_f32_32x32x16_bf16 v[160:175], v[48:51], v[32:35], v[160:175]
    ds_read_b64_tr_b16 v[244:245], v9 offset:57888
    ds_read_b64_tr_b16 v[246:247], v9 offset:58784
    v_mfma_f32_32x32x16_bf16 v[176:191], v[52:55], v[32:35], v[176:191]
    ds_read_b64_tr_b16 v[248:249], v9 offset:57920
    ds_read_b64_tr_b16 v[250:251], v9 offset:58816
    s_waitcnt lgkmcnt(9)
    v_mfma_f32_32x32x16_bf16 v[192:207], v[116:119], v[32:35], v[192:207]
    ds_read_b64_tr_b16 v[48:49], v9 offset:57952
    ds_read_b64_tr_b16 v[50:51], v9 offset:58848
    v_mfma_f32_16x16x32_bf16 v[96:99], v[112:115], v[116:119], v[96:99]
    ds_read_b32 v15, v2 offset:32
    v_mfma_f32_32x32x16_bf16 v[208:223], v[120:123], v[32:35], v[208:223]
    ds_read_b64_tr_b16 v[52:53], v9 offset:57984
    ds_read_b64_tr_b16 v[54:55], v9 offset:58880
    v_mfma_f32_16x16x32_bf16 v[100:103], v[112:115], v[120:123], v[100:103]
    s_waitcnt lgkmcnt(10)
    v_mfma_f32_32x32x16_bf16 v[224:239], v[124:127], v[32:35], v[224:239]
    ds_read_b64_tr_b16 v[116:117], v9 offset:58016
    ds_read_b64_tr_b16 v[118:119], v9 offset:58912
    v_mfma_f32_16x16x32_bf16 v[104:107], v[112:115], v[124:127], v[104:107]
L_129:
    v_mfma_f32_32x32x16_bf16 v[128:143], v[240:243], v[36:39], v[128:143]
    ds_read_b64_tr_b16 v[120:121], v9 offset:58048
    ds_read_b64_tr_b16 v[122:123], v9 offset:58944
    s_waitcnt lgkmcnt(9)
    v_mfma_f32_32x32x16_bf16 v[144:159], v[244:247], v[36:39], v[144:159]
    s_waitcnt lgkmcnt(6)
    v_readfirstlane_b32 s71, v15
    s_cmp_ge_u32 s71, 32
    s_cbranch_scc1 LD_130
    s_mov_b32 s3, 0x40000
LW_131:
    ds_read_b32 v15, v2 offset:32
    s_waitcnt lgkmcnt(0)
    v_readfirstlane_b32 s71, v15
    s_cmp_ge_u32 s71, 32
    s_cbranch_scc1 LD_132
    s_sub_u32 s3, s3, 1
    s_cmp_lg_u32 s3, 0
    s_cbranch_scc1 LW_131
LD_132:
LD_130:
    ds_read_b64_tr_b16 v[124:125], v8 offset:0
    ds_read_b64_tr_b16 v[126:127], v8 offset:896
    v_mfma_f32_32x32x16_bf16 v[160:175], v[248:251], v[36:39], v[160:175]
    ds_read_b64_tr_b16 v[240:241], v8 offset:32
    ds_read_b64_tr_b16 v[242:243], v8 offset:928
    s_waitcnt lgkmcnt(8)
    v_mfma_f32_32x32x16_bf16 v[176:191], v[48:51], v[36:39], v[176:191]
    ds_read_b64_tr_b16 v[244:245], v8 offset:64
    ds_read_b64_tr_b16 v[246:247], v8 offset:960
    v_mfma_f32_32x32x16_bf16 v[192:207], v[52:55], v[36:39], v[192:207]
    ds_read_b64_tr_b16 v[248:249], v8 offset:96
    ds_read_b64_tr_b16 v[250:251], v8 offset:992
    s_waitcnt lgkmcnt(8)
    v_mfma_f32_32x32x16_bf16 v[208:223], v[116:119], v[36:39], v[208:223]
    ds_read_b64_tr_b16 v[48:49], v8 offset:128
    ds_read_b64_tr_b16 v[50:51], v8 offset:1024
    v_mfma_f32_32x32x16_bf16 v[224:239], v[120:123], v[36:39], v[224:239]
    ds_read_b64_tr_b16 v[52:53], v8 offset:160
    ds_read_b64_tr_b16 v[54:55], v8 offset:1056
    s_cmp_lg_u32 s34, 0
    s_cbranch_scc1 L_133
    s_waitcnt lgkmcnt(8)
    v_mfma_f32_32x32x16_bf16 v[128:143], v[124:127], v[40:43], v[128:143]
    ds_read_b64_tr_b16 v[116:117], v8 offset:192
    ds_read_b64_tr_b16 v[118:119], v8 offset:1088
    v_mfma_f32_16x16x32_bf16 v[96:99], v[112:115], v[124:127], v[96:99]
    v_mfma_f32_32x32x16_bf16 v[144:159], v[240:243], v[40:43], v[144:159]
    ds_read_b64_tr_b16 v[120:121], v9 offset:0
    ds_read_b64_tr_b16 v[122:123], v9 offset:896
    v_mfma_f32_16x16x32_bf16 v[100:103], v[112:115], v[240:243], v[100:103]
    s_waitcnt lgkmcnt(8)
    v_mfma_f32_32x32x16_bf16 v[160:175], v[244:247], v[40:43], v[160:175]
    ds_read_b64_tr_b16 v[124:125], v9 offset:32
    ds_read_b64_tr_b16 v[126:127], v9 offset:928
    v_mfma_f32_16x16x32_bf16 v[104:107], v[112:115], v[244:247], v[104:107]
    v_mfma_f32_32x32x16_bf16 v[176:191], v[248:251], v[40:43], v[176:191]
    ds_read_b64_tr_b16 v[240:241], v9 offset:64
    ds_read_b64_tr_b16 v[242:243], v9 offset:960
    v_mfma_f32_16x16x32_bf16 v[108:111], v[112:115], v[248:251], v[108:111]
    s_waitcnt lgkmcnt(8)
    v_mfma_f32_32x32x16_bf16 v[192:207], v[48:51], v[40:43], v[192:207]
    ds_read_b64_tr_b16 v[244:245], v9 offset:96
    ds_read_b64_tr_b16 v[246:247], v9 offset:992
    v_mfma_f32_32x32x16_bf16 v[208:223], v[52:55], v[40:43], v[208:223]
    ds_read_b64_tr_b16 v[248:249], v9 offset:128
    ds_read_b64_tr_b16 v[250:251], v9 offset:1024
    s_waitcnt lgkmcnt(8)
    v_mfma_f32_32x32x16_bf16 v[224:239], v[116:119], v[40:43], v[224:239]
    ds_read_b64_tr_b16 v[48:49], v9 offset:160
    ds_read_b64_tr_b16 v[50:51], v9 offset:1056
    s_branch L_134
L_133:
    s_waitcnt lgkmcnt(8)
    v_mfma_f32_32x32x16_bf16 v[128:143], v[124:127], v[40:43], v[128:143]
    ds_read_b64_tr_b16 v[116:117], v8 offset:192
    ds_read_b64_tr_b16 v[118:119], v8 offset:1088
    v_mfma_f32_32x32x16_bf16 v[144:159], v[240:243], v[40:43], v[144:159]
    ds_read_b64_tr_b16 v[120:121], v9 offset:0
    ds_read_b64_tr_b16 v[122:123], v9 offset:896
    s_waitcnt lgkmcnt(8)
    v_mfma_f32_32x32x16_bf16 v[160:175], v[244:247], v[40:43], v[160:175]
    ds_read_b64_tr_b16 v[124:125], v9 offset:32
    ds_read_b64_tr_b16 v[126:127], v9 offset:928
    v_mfma_f32_32x32x16_bf16 v[176:191], v[248:251], v[40:43], v[176:191]
    ds_read_b64_tr_b16 v[240:241], v9 offset:64
    ds_read_b64_tr_b16 v[242:243], v9 offset:960
    s_waitcnt lgkmcnt(8)
    v_mfma_f32_32x32x16_bf16 v[192:207], v[48:51], v[40:43], v[192:207]
    ds_read_b64_tr_b16 v[244:245], v9 offset:96
    ds_read_b64_tr_b16 v[246:247], v9 offset:992
    v_mfma_f32_16x16x32_bf16 v[96:99], v[112:115], v[48:51], v[96:99]
    v_mfma_f32_32x32x16_bf16 v[208:223], v[52:55], v[40:43], v[208:223]
    ds_read_b64_tr_b16 v[248:249], v9 offset:128
    ds_read_b64_tr_b16 v[250:251], v9 offset:1024
    v_mfma_f32_16x16x32_bf16 v[100:103], v[112:115], v[52:55], v[100:103]
    s_waitcnt lgkmcnt(8)
    v_mfma_f32_32x32x16_bf16 v[224:239], v[116:119], v[40:43], v[224:239]
    ds_read_b64_tr_b16 v[48:49], v9 offset:160
    ds_read_b64_tr_b16 v[50:51], v9 offset:1056
    v_mfma_f32_16x16x32_bf16 v[104:107], v[112:115], v[116:119], v[104:107]
L_134:
    v_mfma_f32_32x32x16_bf16 v[128:143], v[120:123], v[44:47], v[128:143]
    ds_read_b64_tr_b16 v[52:53], v9 offset:192
    ds_read_b64_tr_b16 v[54:55], v9 offset:1088
    s_waitcnt lgkmcnt(8)
    v_mfma_f32_32x32x16_bf16 v[144:159], v[124:127], v[44:47], v[144:159]
    v_mfma_f32_32x32x16_bf16 v[160:175], v[240:243], v[44:47], v[160:175]
    s_waitcnt lgkmcnt(4)
    v_mfma_f32_32x32x16_bf16 v[176:191], v[244:247], v[44:47], v[176:191]
    v_mfma_f32_32x32x16_bf16 v[192:207], v[248:251], v[44:47], v[192:207]
    s_waitcnt lgkmcnt(0)
    v_mfma_f32_32x32x16_bf16 v[208:223], v[48:51], v[44:47], v[208:223]
    v_mfma_f32_32x32x16_bf16 v[224:239], v[52:55], v[44:47], v[224:239]
    v_readfirstlane_b32 s69, v255
    s_mul_i32 s69, s69, 0x9e3779b1
    s_add_u32 s69, s69, 0x7f4a7c15
    s_mul_i32 s72, s34, 1024
    s_lshl_b32 s75, s83, 2
    s_add_u32 s72, s72, s75
    s_add_u32 s72, s72, 158336
    v_lshl_add_u32 v12, v0, 3, s72
    v_lshlrev_b32 v13, 3, v10
    v_add_u32 v13, 158336, v13
    s_lshl_b32 s72, s61, 7
    s_add_u32 s72, s72, 161280
    v_lshl_add_u32 v14, v10, 2, s72
    s_mov_b64 exec, 0xffff
    ds_write_b32 v12, v96 offset:0
    ds_write_b32 v12, v97 offset:128
    ds_write_b32 v12, v100 offset:256
    ds_write_b32 v12, v101 offset:384
    ds_write_b32 v12, v104 offset:512
    ds_write_b32 v12, v105 offset:640
    ds_write_b32 v12, v108 offset:768
    ds_write_b32 v12, v109 offset:896
    s_mov_b64 exec, 1
    ds_add_u32 v2, v3 offset:32
    s_mov_b64 exec, -1
    v_mov_b32 v6, 161152
    v_mov_b32 v7, 1
    ds_read_b32 v3, v14
    ds_read_b32 v4, v14 offset:2048
    v_mov_b32 v97, 0
    v_mov_b32 v98, 0
    v_mov_b32 v99, 0
    v_mov_b32 v101, 0
    v_mov_b32 v102, 0
    v_mov_b32 v103, 0
    v_mov_b32 v105, 0
    v_mov_b32 v106, 0
    v_mov_b32 v107, 0
    v_mov_b32 v109, 0
    v_mov_b32 v110, 0
    v_mov_b32 v111, 0
    v_mov_b32 v113, 0
    v_mov_b32 v114, 0
    v_mov_b32 v115, 0
    v_mov_b32 v117, 0
    v_mov_b32 v118, 0
    v_mov_b32 v119, 0
    v_mov_b32 v121, 0
    v_mov_b32 v122, 0
    v_mov_b32 v123, 0
    v_mov_b32 v125, 0
    v_mov_b32 v126, 0
    v_mov_b32 v127, 0
    v_cmp_ne_u32 vcc, 0, v11
    s_mov_b32 s3, 0x40000
LW_135:
    ds_read_b32 v15, v6 offset:32
    s_waitcnt lgkmcnt(0)
    v_readfirstlane_b32 s71, v15
    s_cmp_ge_u32 s71, 36
    s_cbranch_scc1 LD_136
    s_sub_u32 s3, s3, 1
    s_cmp_lg_u32 s3, 0
    s_cbranch_scc1 LW_135
LD_136:
    ds_read_b64 v[16:17], v13 offset:0
    ds_read_b64 v[20:21], v13 offset:256
    ds_read_b64 v[24:25], v13 offset:512
    ds_read_b64 v[28:29], v13 offset:768
    ds_read_b64 v[32:33], v13 offset:1024
    ds_read_b64 v[36:37], v13 offset:1280
    ds_read_b64 v[40:41], v13 offset:1536
    s_lshl_b32 s72, s62, 2
    s_add_u32 s72, s72, s61
    s_mul_i32 s72, s72, 112
    s_mul_i32 s73, s64, 7
    s_add_u32 s72, s72, s73
    s_lshl_b32 s72, s72, 10
    s_add_u32 s82, s72, 8388608
    v_lshlrev_b32 v1, 4, v0
    v_lshrrev_b32 v8, 3, v0
    v_mul_u32_u24 v8, 896, v8
    v_and_b32 v9, 7, v0
    v_bfe_u32 v12, v0, 4, 1
    v_lshlrev_b32 v12, 2, v12
    v_xor_b32 v9, v9, v12
    v_lshl_add_u32 v2, v9, 4, v8
    s_mul_i32 s78, s61, 401408
    s_lshl_b32 s72, s68, 7
    s_add_u32 s78, s78, s72
    s_mul_i32 s79, s61, 20480
    s_add_u32 s79, s79, 69632
    s_cmp_ge_u32 s70, 28
    s_cselect_b32 s78, 0x7ff00000, s78
    v_cvt_pk_bf16_f32 v8, v3, v3
    v_lshlrev_b32 v8, 16, v8
    v_sub_f32 v9, v3, v8
    v_cndmask_b32 v8, v8, v9, vcc
    v_cvt_pk_bf16_f32 v96, -v8, -v8
    v_mul_f32 v3, 0xbfb8aa3b, v4
    v_mul_f32 v4, v4, v4
    v_rcp_f32 v4, v4
    s_waitcnt lgkmcnt(6)
    v_add_f32 v16, v16, v17
    v_cvt_pk_bf16_f32 v9, v16, v16
    v_lshlrev_b32 v9, 16, v9
    v_sub_f32 v9, v16, v9
    v_cvt_pk_bf16_f32 v100, v16, v9
    s_waitcnt lgkmcnt(5)
    v_add_f32 v20, v20, v21
    v_cvt_pk_bf16_f32 v9, v20, v20
    v_lshlrev_b32 v9, 16, v9
    v_sub_f32 v9, v20, v9
    v_cvt_pk_bf16_f32 v104, v20, v9
    v_mfma_f32_32x32x16_bf16 v[128:143], v[100:103], v[96:99], v[128:143]
    s_waitcnt lgkmcnt(4)
    v_add_f32 v24, v24, v25
    v_cvt_pk_bf16_f32 v9, v24, v24
    v_lshlrev_b32 v9, 16, v9
    v_sub_f32 v9, v24, v9
    v_cvt_pk_bf16_f32 v108, v24, v9
    v_mfma_f32_32x32x16_bf16 v[144:159], v[104:107], v[96:99], v[144:159]
    s_waitcnt lgkmcnt(3)
    v_add_f32 v28, v28, v29
    v_cvt_pk_bf16_f32 v9, v28, v28
    v_lshlrev_b32 v9, 16, v9
    v_sub_f32 v9, v28, v9
    v_cvt_pk_bf16_f32 v112, v28, v9
    v_mfma_f32_32x32x16_bf16 v[160:175], v[108:111], v[96:99], v[160:175]
    s_waitcnt lgkmcnt(2)
    v_add_f32 v32, v32, v33
    v_cvt_pk_bf16_f32 v9, v32, v32
    v_lshlrev_b32 v9, 16, v9
    v_sub_f32 v9, v32, v9
    v_cvt_pk_bf16_f32 v116, v32, v9
    v_mfma_f32_32x32x16_bf16 v[176:191], v[112:115], v[96:99], v[176:191]
    s_waitcnt lgkmcnt(1)
    v_add_f32 v36, v36, v37
    v_cvt_pk_bf16_f32 v9, v36, v36
    v_lshlrev_b32 v9, 16, v9
    v_sub_f32 v9, v36, v9
    v_cvt_pk_bf16_f32 v120, v36, v9
    v_mfma_f32_32x32x16_bf16 v[192:207], v[116:119], v[96:99], v[192:207]
    s_waitcnt lgkmcnt(0)
    v_add_f32 v40, v40, v41
    v_cvt_pk_bf16_f32 v9, v40, v40
    v_lshlrev_b32 v9, 16, v9
    v_sub_f32 v9, v40, v9
    v_cvt_pk_bf16_f32 v124, v40, v9
    v_mfma_f32_32x32x16_bf16 v[208:223], v[120:123], v[96:99], v[208:223]
    s_nop 0
    v_mfma_f32_32x32x16_bf16 v[224:239], v[124:127], v[96:99], v[224:239]
    v_mul_f32 v48, v3, v128
    v_mul_f32 v49, v3, v129
    v_mul_f32 v50, v3, v130
    v_mul_f32 v51, v3, v131
    v_mul_f32 v52, v3, v132
    v_mul_f32 v53, v3, v133
    v_mul_f32 v54, v3, v134
    v_mul_f32 v55, v3, v135
    v_exp_f32 v48, v48
    v_mul_f32 v128, v128, v136
    v_exp_f32 v49, v49
    v_mul_f32 v129, v129, v137
    v_exp_f32 v50, v50
    v_mul_f32 v130, v130, v138
    s_add_u32 m0, s79, 0
    s_add_u32 s75, s78, 0
    buffer_load_dwordx4 v2, s[40:43], s75 offen lds
    v_exp_f32 v51, v51
    v_mul_f32 v131, v131, v139
    v_exp_f32 v52, v52
    v_mul_f32 v132, v132, v140
    v_exp_f32 v53, v53
    v_mul_f32 v133, v133, v141
    v_exp_f32 v54, v54
    v_mul_f32 v134, v134, v142
    v_exp_f32 v55, v55
    v_mul_f32 v135, v135, v143
    v_fma_f32 v48, v48, v4, v4
    v_fma_f32 v49, v49, v4, v4
    v_fma_f32 v50, v50, v4, v4
    s_add_u32 m0, s79, 1024
    s_add_u32 s75, s78, 7168
    buffer_load_dwordx4 v2, s[40:43], s75 offen lds
    v_fma_f32 v51, v51, v4, v4
    v_fma_f32 v52, v52, v4, v4
    v_fma_f32 v53, v53, v4, v4
    v_fma_f32 v54, v54, v4, v4
    v_fma_f32 v55, v55, v4, v4
    v_rcp_f32 v48, v48
    v_rcp_f32 v49, v49
    v_mul_f32 v128, v128, v48
    v_rcp_f32 v50, v50
    v_mul_f32 v129, v129, v49
    v_rcp_f32 v51, v51
    v_mul_f32 v130, v130, v50
    v_rcp_f32 v52, v52
    s_add_u32 m0, s79, 2048
    s_add_u32 s75, s78, 14336
    buffer_load_dwordx4 v2, s[40:43], s75 offen lds
    v_mul_f32 v131, v131, v51
    v_rcp_f32 v53, v53
    v_mul_f32 v132, v132, v52
    v_rcp_f32 v54, v54
    v_mul_f32 v133, v133, v53
    v_rcp_f32 v55, v55
    v_mul_f32 v134, v134, v54
    v_cvt_pk_bf16_f32 v64, v128, v129
    v_mul_f32 v135, v135, v55
    v_cvt_pk_bf16_f32 v65, v130, v131
    v_cvt_pk_bf16_f32 v66, v132, v133
    v_cvt_pk_bf16_f32 v67, v134, v135
    s_add_u32 m0, s79, 3072
    s_add_u32 s75, s78, 21504
    buffer_load_dwordx4 v2, s[40:43], s75 offen lds
    buffer_store_dwordx4 v[64:67], v1, s[52:55], s82 offen offset:0 sc1
    v_mul_f32 v56, v3, v144
    v_mul_f32 v57, v3, v145
    v_mul_f32 v58, v3, v146
    v_mul_f32 v59, v3, v147
    v_mul_f32 v60, v3, v148
    v_mul_f32 v61, v3, v149
    v_mul_f32 v62, v3, v150
    v_mul_f32 v63, v3, v151
    v_exp_f32 v56, v56
    v_mul_f32 v144, v144, v152
    v_exp_f32 v57, v57
    v_mul_f32 v145, v145, v153
    v_exp_f32 v58, v58
    v_mul_f32 v146, v146, v154
    s_add_u32 m0, s79, 4096
    s_add_u32 s75, s78, 28672
    buffer_load_dwordx4 v2, s[40:43], s75 offen lds
    v_exp_f32 v59, v59
    v_mul_f32 v147, v147, v155
    v_exp_f32 v60, v60
    v_mul_f32 v148, v148, v156
    v_exp_f32 v61, v61
    v_mul_f32 v149, v149, v157
    v_exp_f32 v62, v62
    v_mul_f32 v150, v150, v158
    v_exp_f32 v63, v63
    v_mul_f32 v151, v151, v159
    v_fma_f32 v56, v56, v4, v4
    v_fma_f32 v57, v57, v4, v4
    v_fma_f32 v58, v58, v4, v4
    s_add_u32 m0, s79, 5120
    s_add_u32 s75, s78, 35840
    buffer_load_dwordx4 v2, s[40:43], s75 offen lds
    v_fma_f32 v59, v59, v4, v4
    v_fma_f32 v60, v60, v4, v4
    v_fma_f32 v61, v61, v4, v4
    v_fma_f32 v62, v62, v4, v4
    v_fma_f32 v63, v63, v4, v4
    v_rcp_f32 v56, v56
    v_rcp_f32 v57, v57
    v_mul_f32 v144, v144, v56
    v_rcp_f32 v58, v58
    v_mul_f32 v145, v145, v57
    v_rcp_f32 v59, v59
    v_mul_f32 v146, v146, v58
    v_rcp_f32 v60, v60
    s_add_u32 m0, s79, 6144
    s_add_u32 s75, s78, 43008
    buffer_load_dwordx4 v2, s[40:43], s75 offen lds
    v_mul_f32 v147, v147, v59
    v_rcp_f32 v61, v61
    v_mul_f32 v148, v148, v60
    v_rcp_f32 v62, v62
    v_mul_f32 v149, v149, v61
    v_rcp_f32 v63, v63
    v_mul_f32 v150, v150, v62
    v_cvt_pk_bf16_f32 v68, v144, v145
    v_mul_f32 v151, v151, v63
    v_cvt_pk_bf16_f32 v69, v146, v147
    v_cvt_pk_bf16_f32 v70, v148, v149
    v_cvt_pk_bf16_f32 v71, v150, v151
    s_add_u32 m0, s79, 7168
    s_add_u32 s75, s78, 50176
    buffer_load_dwordx4 v2, s[40:43], s75 offen lds
    buffer_store_dwordx4 v[68:71], v1, s[52:55], s82 offen offset:1024 sc1
    v_mul_f32 v48, v3, v160
    v_mul_f32 v49, v3, v161
    v_mul_f32 v50, v3, v162
    v_mul_f32 v51, v3, v163
    v_mul_f32 v52, v3, v164
    v_mul_f32 v53, v3, v165
    v_mul_f32 v54, v3, v166
    v_mul_f32 v55, v3, v167
    v_exp_f32 v48, v48
    v_mul_f32 v160, v160, v168
    v_exp_f32 v49, v49
    v_mul_f32 v161, v161, v169
    v_exp_f32 v50, v50
    v_mul_f32 v162, v162, v170
    s_add_u32 m0, s79, 8192
    s_add_u32 s75, s78, 57344
    buffer_load_dwordx4 v2, s[40:43], s75 offen lds
    v_exp_f32 v51, v51
    v_mul_f32 v163, v163, v171
    v_exp_f32 v52, v52
    v_mul_f32 v164, v164, v172
    v_exp_f32 v53, v53
    v_mul_f32 v165, v165, v173
    v_exp_f32 v54, v54
    v_mul_f32 v166, v166, v174
    v_exp_f32 v55, v55
    v_mul_f32 v167, v167, v175
    v_fma_f32 v48, v48, v4, v4
    v_fma_f32 v49, v49, v4, v4
    v_fma_f32 v50, v50, v4, v4
    s_add_u32 m0, s79, 9216
    s_add_u32 s75, s78, 64512
    buffer_load_dwordx4 v2, s[40:43], s75 offen lds
    v_fma_f32 v51, v51, v4, v4
    v_fma_f32 v52, v52, v4, v4
    v_fma_f32 v53, v53, v4, v4
    v_fma_f32 v54, v54, v4, v4
    v_fma_f32 v55, v55, v4, v4
    v_rcp_f32 v48, v48
    v_rcp_f32 v49, v49
    v_mul_f32 v160, v160, v48
    v_rcp_f32 v50, v50
    v_mul_f32 v161, v161, v49
    v_rcp_f32 v51, v51
    v_mul_f32 v162, v162, v50
    v_rcp_f32 v52, v52
    s_add_u32 m0, s79, 10240
    s_add_u32 s75, s78, 71680
    buffer_load_dwordx4 v2, s[40:43], s75 offen lds
    v_mul_f32 v163, v163, v51
    v_rcp_f32 v53, v53
    v_mul_f32 v164, v164, v52
    v_rcp_f32 v54, v54
    v_mul_f32 v165, v165, v53
    v_rcp_f32 v55, v55
    v_mul_f32 v166, v166, v54
    v_cvt_pk_bf16_f32 v72, v160, v161
    v_mul_f32 v167, v167, v55
    v_cvt_pk_bf16_f32 v73, v162, v163
    v_cvt_pk_bf16_f32 v74, v164, v165
    v_cvt_pk_bf16_f32 v75, v166, v167
    s_add_u32 m0, s79, 11264
    s_add_u32 s75, s78, 78848
    buffer_load_dwordx4 v2, s[40:43], s75 offen lds
    buffer_store_dwordx4 v[72:75], v1, s[52:55], s82 offen offset:2048 sc1
    v_mul_f32 v56, v3, v176
    v_mul_f32 v57, v3, v177
    v_mul_f32 v58, v3, v178
    v_mul_f32 v59, v3, v179
    v_mul_f32 v60, v3, v180
    v_mul_f32 v61, v3, v181
    v_mul_f32 v62, v3, v182
    v_mul_f32 v63, v3, v183
    v_exp_f32 v56, v56
    v_mul_f32 v176, v176, v184
    v_exp_f32 v57, v57
    v_mul_f32 v177, v177, v185
    v_exp_f32 v58, v58
    v_mul_f32 v178, v178, v186
    s_add_u32 m0, s79, 12288
    s_add_u32 s75, s78, 86016
    buffer_load_dwordx4 v2, s[40:43], s75 offen lds
    v_exp_f32 v59, v59
    v_mul_f32 v179, v179, v187
    v_exp_f32 v60, v60
    v_mul_f32 v180, v180, v188
    v_exp_f32 v61, v61
    v_mul_f32 v181, v181, v189
    v_exp_f32 v62, v62
    v_mul_f32 v182, v182, v190
    v_exp_f32 v63, v63
    v_mul_f32 v183, v183, v191
    v_fma_f32 v56, v56, v4, v4
    v_fma_f32 v57, v57, v4, v4
    v_fma_f32 v58, v58, v4, v4
    s_add_u32 m0, s79, 13312
    s_add_u32 s75, s78, 93184
    buffer_load_dwordx4 v2, s[40:43], s75 offen lds
    v_fma_f32 v59, v59, v4, v4
    v_fma_f32 v60, v60, v4, v4
    v_fma_f32 v61, v61, v4, v4
    v_fma_f32 v62, v62, v4, v4
    v_fma_f32 v63, v63, v4, v4
    v_rcp_f32 v56, v56
    v_rcp_f32 v57, v57
    v_mul_f32 v176, v176, v56
    v_rcp_f32 v58, v58
    v_mul_f32 v177, v177, v57
    v_rcp_f32 v59, v59
    v_mul_f32 v178, v178, v58
    v_rcp_f32 v60, v60
    s_add_u32 m0, s79, 14336
    s_add_u32 s75, s78, 100352
    buffer_load_dwordx4 v2, s[40:43], s75 offen lds
    v_mul_f32 v179, v179, v59
    v_rcp_f32 v61, v61
    v_mul_f32 v180, v180, v60
    v_rcp_f32 v62, v62
    v_mul_f32 v181, v181, v61
    v_rcp_f32 v63, v63
    v_mul_f32 v182, v182, v62
    v_cvt_pk_bf16_f32 v76, v176, v177
    v_mul_f32 v183, v183, v63
    v_cvt_pk_bf16_f32 v77, v178, v179
    v_cvt_pk_bf16_f32 v78, v180, v181
    v_cvt_pk_bf16_f32 v79, v182, v183
    s_add_u32 m0, s79, 15360
    s_add_u32 s75, s78, 107520
    buffer_load_dwordx4 v2, s[40:43], s75 offen lds
    buffer_store_dwordx4 v[76:79], v1, s[52:55], s82 offen offset:3072 sc1
    v_mul_f32 v48, v3, v192
    v_mul_f32 v49, v3, v193
    v_mul_f32 v50, v3, v194
    v_mul_f32 v51, v3, v195
    v_mul_f32 v52, v3, v196
    v_mul_f32 v53, v3, v197
    v_mul_f32 v54, v3, v198
    v_mul_f32 v55, v3, v199
    v_exp_f32 v48, v48
    v_mul_f32 v192, v192, v200
    v_exp_f32 v49, v49
    v_mul_f32 v193, v193, v201
    v_exp_f32 v50, v50
    v_mul_f32 v194, v194, v202
    s_add_u32 m0, s79, 16384
    s_add_u32 s75, s78, 114688
    buffer_load_dwordx4 v2, s[40:43], s75 offen lds
    v_exp_f32 v51, v51
    v_mul_f32 v195, v195, v203
    v_exp_f32 v52, v52
    v_mul_f32 v196, v196, v204
    v_exp_f32 v53, v53
    v_mul_f32 v197, v197, v205
    v_exp_f32 v54, v54
    v_mul_f32 v198, v198, v206
    v_exp_f32 v55, v55
    v_mul_f32 v199, v199, v207
    v_fma_f32 v48, v48, v4, v4
    v_fma_f32 v49, v49, v4, v4
    v_fma_f32 v50, v50, v4, v4
    s_add_u32 m0, s79, 17408
    s_add_u32 s75, s78, 121856
    buffer_load_dwordx4 v2, s[40:43], s75 offen lds
    v_fma_f32 v51, v51, v4, v4
    v_fma_f32 v52, v52, v4, v4
    v_fma_f32 v53, v53, v4, v4
    v_fma_f32 v54, v54, v4, v4
    v_fma_f32 v55, v55, v4, v4
    v_rcp_f32 v48, v48
    v_rcp_f32 v49, v49
    v_mul_f32 v192, v192, v48
    v_rcp_f32 v50, v50
    v_mul_f32 v193, v193, v49
    v_rcp_f32 v51, v51
    v_mul_f32 v194, v194, v50
    v_rcp_f32 v52, v52
    s_add_u32 m0, s79, 18432
    s_add_u32 s75, s78, 129024
    buffer_load_dwordx4 v2, s[40:43], s75 offen lds
    v_mul_f32 v195, v195, v51
    v_rcp_f32 v53, v53
    v_mul_f32 v196, v196, v52
    v_rcp_f32 v54, v54
    v_mul_f32 v197, v197, v53
    v_rcp_f32 v55, v55
    v_mul_f32 v198, v198, v54
    v_cvt_pk_bf16_f32 v80, v192, v193
    v_mul_f32 v199, v199, v55
    v_cvt_pk_bf16_f32 v81, v194, v195
    v_cvt_pk_bf16_f32 v82, v196, v197
    v_cvt_pk_bf16_f32 v83, v198, v199
    s_add_u32 m0, s79, 19456
    s_add_u32 s75, s78, 136192
    buffer_load_dwordx4 v2, s[40:43], s75 offen lds
    s_add_u32 s82, s82, 4096
    buffer_store_dwordx4 v[80:83], v1, s[52:55], s82 offen offset:0 sc1
    v_mul_f32 v56, v3, v208
    v_mul_f32 v57, v3, v209
    v_mul_f32 v58, v3, v210
    v_mul_f32 v59, v3, v211
    v_mul_f32 v60, v3, v212
    v_mul_f32 v61, v3, v213
    v_mul_f32 v62, v3, v214
    v_mul_f32 v63, v3, v215
    v_exp_f32 v56, v56
    v_mul_f32 v208, v208, v216
    v_exp_f32 v57, v57
    v_mul_f32 v209, v209, v217
    v_exp_f32 v58, v58
    v_mul_f32 v210, v210, v218
    v_exp_f32 v59, v59
    v_mul_f32 v211, v211, v219
    v_exp_f32 v60, v60
    v_mul_f32 v212, v212, v220
    v_exp_f32 v61, v61
    v_mul_f32 v213, v213, v221
    v_exp_f32 v62, v62
    v_mul_f32 v214, v214, v222
    v_exp_f32 v63, v63
    v_mul_f32 v215, v215, v223
    v_fma_f32 v56, v56, v4, v4
    v_fma_f32 v57, v57, v4, v4
    v_fma_f32 v58, v58, v4, v4
    v_fma_f32 v59, v59, v4, v4
    v_fma_f32 v60, v60, v4, v4
    v_fma_f32 v61, v61, v4, v4
    v_fma_f32 v62, v62, v4, v4
    v_fma_f32 v63, v63, v4, v4
    v_rcp_f32 v56, v56
    v_rcp_f32 v57, v57
    v_mul_f32 v208, v208, v56
    v_rcp_f32 v58, v58
    v_mul_f32 v209, v209, v57
    v_rcp_f32 v59, v59
    v_mul_f32 v210, v210, v58
    v_rcp_f32 v60, v60
    v_mul_f32 v211, v211, v59
    v_rcp_f32 v61, v61
    v_mul_f32 v212, v212, v60
    v_rcp_f32 v62, v62
    v_mul_f32 v213, v213, v61
    v_rcp_f32 v63, v63
    v_mul_f32 v214, v214, v62
    v_cvt_pk_bf16_f32 v84, v208, v209
    v_mul_f32 v215, v215, v63
    v_cvt_pk_bf16_f32 v85, v210, v211
    v_cvt_pk_bf16_f32 v86, v212, v213
    v_cvt_pk_bf16_f32 v87, v214, v215
    buffer_store_dwordx4 v[84:87], v1, s[52:55], s82 offen offset:1024 sc1
    v_mul_f32 v48, v3, v224
    v_mul_f32 v49, v3, v225
    v_mul_f32 v50, v3, v226
    v_mul_f32 v51, v3, v227
    v_mul_f32 v52, v3, v228
    v_mul_f32 v53, v3, v229
    v_mul_f32 v54, v3, v230
    v_mul_f32 v55, v3, v231
    v_exp_f32 v48, v48
    v_mul_f32 v224, v224, v232
    v_exp_f32 v49, v49
    v_mul_f32 v225, v225, v233
    v_exp_f32 v50, v50
    v_mul_f32 v226, v226, v234
    v_exp_f32 v51, v51
    v_mul_f32 v227, v227, v235
    v_exp_f32 v52, v52
    v_mul_f32 v228, v228, v236
    v_exp_f32 v53, v53
    v_mul_f32 v229, v229, v237
    v_exp_f32 v54, v54
    v_mul_f32 v230, v230, v238
    v_exp_f32 v55, v55
    v_mul_f32 v231, v231, v239
    v_fma_f32 v48, v48, v4, v4
    v_fma_f32 v49, v49, v4, v4
    v_fma_f32 v50, v50, v4, v4
    v_fma_f32 v51, v51, v4, v4
    v_fma_f32 v52, v52, v4, v4
    v_fma_f32 v53, v53, v4, v4
    v_fma_f32 v54, v54, v4, v4
    v_fma_f32 v55, v55, v4, v4
    v_rcp_f32 v48, v48
    v_rcp_f32 v49, v49
    v_mul_f32 v224, v224, v48
    v_rcp_f32 v50, v50
    v_mul_f32 v225, v225, v49
    v_rcp_f32 v51, v51
    v_mul_f32 v226, v226, v50
    v_rcp_f32 v52, v52
    v_mul_f32 v227, v227, v51
    v_rcp_f32 v53, v53
    v_mul_f32 v228, v228, v52
    v_rcp_f32 v54, v54
    v_mul_f32 v229, v229, v53
    v_rcp_f32 v55, v55
    v_mul_f32 v230, v230, v54
    v_cvt_pk_bf16_f32 v88, v224, v225
    v_mul_f32 v231, v231, v55
    v_cvt_pk_bf16_f32 v89, v226, v227
    v_cvt_pk_bf16_f32 v90, v228, v229
    v_cvt_pk_bf16_f32 v91, v230, v231
    buffer_store_dwordx4 v[88:91], v1, s[52:55], s82 offen offset:2048 sc1
    v_mov_b32 v19, 128
    buffer_load_dword v19, v19, s[52:55], 0 offen sc1
    s_lshl_b32 s72, s62, 7
    s_add_u32 s72, s72, 2304
    v_mov_b32 v8, s72
    v_mov_b32 v9, s69
    s_lshr_b32 s72, s67, 1
    s_lshl_b32 s72, s72, 7
    s_add_u32 s72, s72, 8448
    v_mov_b32 v10, s72
    v_lshrrev_b32 v11, 5, v0
    v_bfe_u32 v12, v0, 2, 2
    v_lshl_add_u32 v13, v11, 2, v12
    v_lshlrev_b32 v13, 7, v13
    v_bfe_u32 v14, v0, 4, 1
    v_and_b32 v12, 2, v12
    v_xor_b32 v12, v12, v14
    v_lshl_add_u32 v13, v12, 5, v13
    v_and_b32 v12, 3, v0
    v_lshl_add_u32 v13, v12, 3, v13
    v_xor_b32 v14, 64, v13
    v_add_u32 v3, s79, v13
    v_add_u32 v4, s79, v14
    s_lshl_b32 s72, s67, 2
    s_add_u32 s72, s72, s61
    s_mul_i32 s72, s72, 14336
    s_lshl_b32 s73, s68, 7
    s_add_u32 s82, s72, s73
    v_lshrrev_b32 v11, 3, v0
    v_and_b32 v12, 7, v0
    v_mul_u32_u24 v5, 896, v11
    v_lshl_add_u32 v5, v12, 4, v5
    s_lshr_b32 s72, s61, 1
    s_mul_i32 s72, s72, 8704
    s_and_b32 s73, s61, 1
    s_lshl_b32 s73, s73, 8
    s_add_u32 s72, s72, s73
    v_mul_u32_u24 v12, 1088, v12
    v_lshl_add_u32 v12, v11, 4, v12
    v_add_u32 v11, s72, v12
    v_add_u32 v12, 69632, v11
    v_add_u32 v13, 40960, v12
    s_mul_i32 s72, s61, 28
    s_mul_i32 s76, s67, 224
    s_add_u32 s76, s76, s72
    s_lshl_b32 s76, s76, 10
    s_add_u32 s76, s76, 8388608
    s_add_u32 s77, s76, 114688
    s_waitcnt vmcnt(0)
    s_mov_b64 exec, 1
    ds_add_rtn_u32 v15, v6, v7 offset:40
    s_waitcnt lgkmcnt(0)
    v_readfirstlane_b32 s83, v15
    s_cmp_lg_u32 s83, 3
    s_cbranch_scc1 L_137
    v_readfirstlane_b32 s71, v19
    s_cmp_eq_u32 s71, s69
    s_cbranch_scc1 LI_138
    v_mov_b32 v19, 128
    s_mov_b32 s3, 32768
GP_139:
    buffer_load_dword v15, v19, s[52:55], 0 offen sc1
    s_waitcnt vmcnt(0)
    v_cmp_ne_u32 vcc, s69, v15
    s_cbranch_vccz GD_140
    s_sleep 2
    s_sub_u32 s3, s3, 1
    s_cmp_lg_u32 s3, 0
    s_cbranch_scc1 GP_139
GD_140:
LI_138:
    s_mov_b64 exec, 1
    v_mov_b32 v15, 1
    buffer_atomic_add v15, v8, s[52:55], 0 offen sc0 sc1
    s_waitcnt vmcnt(0)
    v_cmp_eq_u32 vcc, 15, v15
    v_add_u32 v8, 6144, v8
    s_and_b64 exec, exec, vcc
    s_cbranch_execz LI_141
    buffer_store_dword v9, v8, s[52:55], 0 offen sc1
LI_141:
    s_mov_b64 exec, 1
L_137:
    s_mov_b64 exec, -1
    s_setprio 0
    s_cmp_lt_u32 s70, 28
    s_cbranch_scc1 L_142
    s_mov_b64 exec, 1
    ds_add_u32 v6, v7 offset:32
    s_mov_b64 exec, -1
    s_branch L_ffn_end
L_142:
    s_mul_i32 s80, s61, 14336
    s_add_u32 s80, s80, 9216
    s_sub_u32 s72, s80, s79
    v_add_u32 v168, s72, v3
    v_add_u32 v169, s72, v4
    ds_read_b64_tr_b16 v[176:177], v3 offset:0
    ds_read_b64_tr_b16 v[178:179], v3 offset:1024
    ds_read_b64_tr_b16 v[180:181], v4 offset:0
    ds_read_b64_tr_b16 v[182:183], v4 offset:1024
    ds_read_b64_tr_b16 v[184:185], v3 offset:2048
    ds_read_b64_tr_b16 v[186:187], v3 offset:3072
    ds_read_b64_tr_b16 v[188:189], v4 offset:2048
    ds_read_b64_tr_b16 v[190:191], v4 offset:3072
    ds_read_b64_tr_b16 v[192:193], v3 offset:4096
    ds_read_b64_tr_b16 v[194:195], v3 offset:5120
    ds_read_b64_tr_b16 v[196:197], v4 offset:4096
    ds_read_b64_tr_b16 v[198:199], v4 offset:5120
    s_waitcnt lgkmcnt(8)
    s_add_u32 m0, s79, 0
    s_add_u32 s75, s78, 143360
    buffer_load_dwordx4 v2, s[40:43], s75 offen lds
    s_add_u32 m0, s79, 1024
    s_add_u32 s75, s78, 150528
    buffer_load_dwordx4 v2, s[40:43], s75 offen lds
    ds_read_b64_tr_b16 v[200:201], v3 offset:6144
    ds_read_b64_tr_b16 v[202:203], v3 offset:7168
    ds_read_b64_tr_b16 v[204:205], v4 offset:6144
    ds_read_b64_tr_b16 v[206:207], v4 offset:7168
    s_waitcnt lgkmcnt(8)
    s_add_u32 m0, s79, 2048
    s_add_u32 s75, s78, 157696
    buffer_load_dwordx4 v2, s[40:43], s75 offen lds
    s_add_u32 m0, s79, 3072
    s_add_u32 s75, s78, 164864
    buffer_load_dwordx4 v2, s[40:43], s75 offen lds
    ds_read_b64_tr_b16 v[208:209], v3 offset:8192
    ds_read_b64_tr_b16 v[210:211], v3 offset:9216
    ds_read_b64_tr_b16 v[212:213], v4 offset:8192
    ds_read_b64_tr_b16 v[214:215], v4 offset:9216
    s_waitcnt lgkmcnt(8)
    s_add_u32 m0, s79, 4096
    s_add_u32 s75, s78, 172032
    buffer_load_dwordx4 v2, s[40:43], s75 offen lds
    s_add_u32 m0, s79, 5120
    s_add_u32 s75, s78, 179200
    buffer_load_dwordx4 v2, s[40:43], s75 offen lds
    ds_read_b64_tr_b16 v[216:217], v3 offset:10240
    ds_read_b64_tr_b16 v[218:219], v3 offset:11264
    ds_read_b64_tr_b16 v[220:221], v4 offset:10240
    ds_read_b64_tr_b16 v[222:223], v4 offset:11264
    s_waitcnt lgkmcnt(8)
    s_add_u32 m0, s79, 6144
    s_add_u32 s75, s78, 186368
    buffer_load_dwordx4 v2, s[40:43], s75 offen lds
    s_add_u32 m0, s79, 7168
    s_add_u32 s75, s78, 193536
    buffer_load_dwordx4 v2, s[40:43], s75 offen lds
    ds_read_b64_tr_b16 v[224:225], v3 offset:12288
    ds_read_b64_tr_b16 v[226:227], v3 offset:13312
    ds_read_b64_tr_b16 v[228:229], v4 offset:12288
    ds_read_b64_tr_b16 v[230:231], v4 offset:13312
    s_waitcnt lgkmcnt(8)
    s_add_u32 m0, s79, 8192
    s_add_u32 s75, s78, 200704
    buffer_load_dwordx4 v2, s[40:43], s75 offen lds
    s_add_u32 m0, s79, 9216
    s_add_u32 s75, s78, 207872
    buffer_load_dwordx4 v2, s[40:43], s75 offen lds
    ds_read_b64_tr_b16 v[232:233], v3 offset:14336
    ds_read_b64_tr_b16 v[234:235], v3 offset:15360
    ds_read_b64_tr_b16 v[236:237], v4 offset:14336
    ds_read_b64_tr_b16 v[238:239], v4 offset:15360
    s_waitcnt lgkmcnt(8)
    s_add_u32 m0, s79, 10240
    s_add_u32 s75, s78, 215040
    buffer_load_dwordx4 v2, s[40:43], s75 offen lds
    s_add_u32 m0, s79, 11264
    s_add_u32 s75, s78, 222208
    buffer_load_dwordx4 v2, s[40:43], s75 offen lds
    ds_read_b64_tr_b16 v[240:241], v3 offset:16384
    ds_read_b64_tr_b16 v[242:243], v3 offset:17408
    ds_read_b64_tr_b16 v[244:245], v4 offset:16384
    ds_read_b64_tr_b16 v[246:247], v4 offset:17408
    s_waitcnt lgkmcnt(8)
    s_add_u32 m0, s79, 12288
    s_add_u32 s75, s78, 229376
    buffer_load_dwordx4 v2, s[40:43], s75 offen lds
    s_add_u32 m0, s79, 13312
    s_add_u32 s75, s78, 236544
    buffer_load_dwordx4 v2, s[40:43], s75 offen lds
    ds_read_b64_tr_b16 v[248:249], v3 offset:18432
    ds_read_b64_tr_b16 v[250:251], v3 offset:19456
    ds_read_b64_tr_b16 v[252:253], v4 offset:18432
    ds_read_b64_tr_b16 v[254:255], v4 offset:19456
    s_waitcnt lgkmcnt(8)
    s_add_u32 m0, s79, 14336
    s_add_u32 s75, s78, 243712
    buffer_load_dwordx4 v2, s[40:43], s75 offen lds
    s_add_u32 m0, s79, 15360
    s_add_u32 s75, s78, 250880
    buffer_load_dwordx4 v2, s[40:43], s75 offen lds
    s_waitcnt lgkmcnt(0)
    s_add_u32 m0, s79, 16384
    s_add_u32 s75, s78, 258048
    buffer_load_dwordx4 v2, s[40:43], s75 offen lds
    s_add_u32 m0, s79, 17408
    s_add_u32 s75, s78, 265216
    buffer_load_dwordx4 v2, s[40:43], s75 offen lds
    s_add_u32 m0, s79, 18432
    s_add_u32 s75, s78, 272384
    buffer_load_dwordx4 v2, s[40:43], s75 offen lds
    s_add_u32 m0, s79, 19456
    s_add_u32 s75, s78, 279552
    buffer_load_dwordx4 v2, s[40:43], s75 offen lds
    s_add_u32 m0, s80, 0
    s_add_u32 s75, s78, 286720
    buffer_load_dwordx4 v2, s[40:43], s75 offen lds
    s_add_u32 m0, s80, 1024
    s_add_u32 s75, s78, 293888
    buffer_load_dwordx4 v2, s[40:43], s75 offen lds
    s_add_u32 m0, s80, 2048
    s_add_u32 s75, s78, 301056
    buffer_load_dwordx4 v2, s[40:43], s75 offen lds
    s_add_u32 m0, s80, 3072
    s_add_u32 s75, s78, 308224
    buffer_load_dwordx4 v2, s[40:43], s75 offen lds
    s_add_u32 m0, s80, 4096
    s_add_u32 s75, s78, 315392
    buffer_load_dwordx4 v2, s[40:43], s75 offen lds
    s_add_u32 m0, s80, 5120
    s_add_u32 s75, s78, 322560
    buffer_load_dwordx4 v2, s[40:43], s75 offen lds
    s_add_u32 m0, s80, 6144
    s_add_u32 s75, s78, 329728
    buffer_load_dwordx4 v2, s[40:43], s75 offen lds
    s_add_u32 m0, s80, 7168
    s_add_u32 s75, s78, 336896
    buffer_load_dwordx4 v2, s[40:43], s75 offen lds
    s_add_u32 m0, s80, 8192
    s_add_u32 s75, s78, 344064
    buffer_load_dwordx4 v2, s[40:43], s75 offen lds
    s_add_u32 m0, s80, 9216
    s_add_u32 s75, s78, 351232
    buffer_load_dwordx4 v2, s[40:43], s75 offen lds
    s_add_u32 m0, s80, 10240
    s_add_u32 s75, s78, 358400
    buffer_load_dwordx4 v2, s[40:43], s75 offen lds
    s_add_u32 m0, s80, 11264
    s_add_u32 s75, s78, 365568
    buffer_load_dwordx4 v2, s[40:43], s75 offen lds
    s_add_u32 m0, s80, 12288
    s_add_u32 s75, s78, 372736
    buffer_load_dwordx4 v2, s[40:43], s75 offen lds
    s_add_u32 m0, s80, 13312
    s_add_u32 s75, s78, 379904
    buffer_load_dwordx4 v2, s[40:43], s75 offen lds
    buffer_load_dwordx4 v[96:99], v5, s[24:27], s82 offen
    s_add_u32 s36, s82, 7168
    buffer_load_dwordx4 v[100:103], v5, s[24:27], s36 offen
    s_mov_b64 exec, 1
    buffer_load_dword v152, v5, s[48:51], s82 offen
    s_mov_b64 exec, -1
    s_cmp_lg_u32 s83, 0
    s_cbranch_scc1 L_143
    s_mov_b32 s3, 32768
GP_145:
    buffer_load_dword v15, v10, s[52:55], 0 offen sc1
    s_waitcnt vmcnt(0)
    v_cmp_ne_u32 vcc, s69, v15
    s_cbranch_vccz GD_146
    s_sleep 2
    s_sub_u32 s3, s3, 1
    s_cmp_lg_u32 s3, 0
    s_cbranch_scc1 GP_145
GD_146:
    ds_write_b32 v6, v7 offset:44
    s_branch L_144
L_143:
    s_mov_b32 s3, 0x40000
LW_147:
    ds_read_b32 v15, v6 offset:44
    s_waitcnt lgkmcnt(0)
    v_readfirstlane_b32 s71, v15
    s_cmp_ge_u32 s71, 1
    s_cbranch_scc1 LD_148
    s_sleep 1
    s_sub_u32 s3, s3, 1
    s_cmp_lg_u32 s3, 0
    s_cbranch_scc1 LW_147
LD_148:
L_144:
    s_add_u32 s72, s76, 20480
    s_add_u32 s73, s77, 20480
    buffer_load_dwordx4 v[16:19], v1, s[52:55], s72 offen sc1
    buffer_load_dwordx4 v[20:23], v1, s[52:55], s73 offen sc1
    s_add_u32 s72, s76, 21504
    s_add_u32 s73, s77, 21504
    buffer_load_dwordx4 v[24:27], v1, s[52:55], s72 offen sc1
    buffer_load_dwordx4 v[28:31], v1, s[52:55], s73 offen sc1
    s_add_u32 s72, s76, 22528
    s_add_u32 s73, s77, 22528
    buffer_load_dwordx4 v[32:35], v1, s[52:55], s72 offen sc1
    buffer_load_dwordx4 v[36:39], v1, s[52:55], s73 offen sc1
    s_add_u32 s72, s76, 23552
    s_add_u32 s73, s77, 23552
    buffer_load_dwordx4 v[40:43], v1, s[52:55], s72 offen sc1
    buffer_load_dwordx4 v[44:47], v1, s[52:55], s73 offen sc1
    s_add_u32 s72, s76, 24576
    s_add_u32 s73, s77, 24576
    buffer_load_dwordx4 v[48:51], v1, s[52:55], s72 offen sc1
    buffer_load_dwordx4 v[52:55], v1, s[52:55], s73 offen sc1
    s_add_u32 s72, s76, 25600
    s_add_u32 s73, s77, 25600
    buffer_load_dwordx4 v[56:59], v1, s[52:55], s72 offen sc1
    buffer_load_dwordx4 v[60:63], v1, s[52:55], s73 offen sc1
    s_add_u32 s72, s76, 26624
    s_add_u32 s73, s77, 26624
    buffer_load_dwordx4 v[64:67], v1, s[52:55], s72 offen sc1
    buffer_load_dwordx4 v[68:71], v1, s[52:55], s73 offen sc1
    s_add_u32 s72, s76, 10240
    s_add_u32 s73, s77, 10240
    buffer_load_dwordx4 v[72:75], v1, s[52:55], s72 offen sc1
    buffer_load_dwordx4 v[76:79], v1, s[52:55], s73 offen sc1
    s_mov_b32 s3, 0x40000
LW_149:
    ds_read_b32 v15, v6 offset:56
    s_waitcnt lgkmcnt(0)
    v_readfirstlane_b32 s71, v15
    s_cmp_ge_u32 s71, 4
    s_cbranch_scc1 LD_150
    s_sleep 2
    s_sub_u32 s3, s3, 1
    s_cmp_lg_u32 s3, 0
    s_cbranch_scc1 LW_149
LD_150:
    s_setprio 0
    s_waitcnt vmcnt(31)
    ds_read_b64_tr_b16 v[80:81], v168 offset:0
    ds_read_b64_tr_b16 v[82:83], v168 offset:1024
    ds_read_b64_tr_b16 v[84:85], v169 offset:0
    ds_read_b64_tr_b16 v[86:87], v169 offset:1024
    s_waitcnt vmcnt(14)
    ds_read_b64_tr_b16 v[88:89], v168 offset:2048
    ds_read_b64_tr_b16 v[90:91], v168 offset:3072
    ds_read_b64_tr_b16 v[92:93], v169 offset:2048
    ds_read_b64_tr_b16 v[94:95], v169 offset:3072
    s_waitcnt lgkmcnt(4)
    v_mfma_f32_32x32x16_bf16 v[104:119], v[80:83], v[16:19], 0
    v_mfma_f32_32x32x16_bf16 v[136:151], v[80:83], v[20:23], 0
    v_mfma_f32_32x32x16_bf16 v[120:135], v[84:87], v[16:19], 0
    v_mfma_f32_32x32x16_bf16 v[152:167], v[84:87], v[20:23], 0
    s_add_u32 s72, s76, 11264
    s_add_u32 s73, s77, 11264
    buffer_load_dwordx4 v[16:19], v1, s[52:55], s72 offen sc1
    buffer_load_dwordx4 v[20:23], v1, s[52:55], s73 offen sc1
    s_waitcnt vmcnt(14)
    ds_read_b64_tr_b16 v[80:81], v168 offset:4096
    ds_read_b64_tr_b16 v[82:83], v168 offset:5120
    ds_read_b64_tr_b16 v[84:85], v169 offset:4096
    ds_read_b64_tr_b16 v[86:87], v169 offset:5120
    s_waitcnt lgkmcnt(4)
    v_mfma_f32_32x32x16_bf16 v[104:119], v[88:91], v[24:27], v[104:119]
    v_mfma_f32_32x32x16_bf16 v[136:151], v[88:91], v[28:31], v[136:151]
    v_mfma_f32_32x32x16_bf16 v[120:135], v[92:95], v[24:27], v[120:135]
    v_mfma_f32_32x32x16_bf16 v[152:167], v[92:95], v[28:31], v[152:167]
    s_add_u32 s72, s76, 12288
    s_add_u32 s73, s77, 12288
    buffer_load_dwordx4 v[24:27], v1, s[52:55], s72 offen sc1
    buffer_load_dwordx4 v[28:31], v1, s[52:55], s73 offen sc1
    s_waitcnt vmcnt(14)
    ds_read_b64_tr_b16 v[88:89], v168 offset:6144
    ds_read_b64_tr_b16 v[90:91], v168 offset:7168
    ds_read_b64_tr_b16 v[92:93], v169 offset:6144
    ds_read_b64_tr_b16 v[94:95], v169 offset:7168
    s_waitcnt lgkmcnt(4)
    v_mfma_f32_32x32x16_bf16 v[104:119], v[80:83], v[32:35], v[104:119]
    v_mfma_f32_32x32x16_bf16 v[136:151], v[80:83], v[36:39], v[136:151]
    v_mfma_f32_32x32x16_bf16 v[120:135], v[84:87], v[32:35], v[120:135]
    v_mfma_f32_32x32x16_bf16 v[152:167], v[84:87], v[36:39], v[152:167]
    s_add_u32 s72, s76, 13312
    s_add_u32 s73, s77, 13312
    buffer_load_dwordx4 v[32:35], v1, s[52:55], s72 offen sc1
    buffer_load_dwordx4 v[36:39], v1, s[52:55], s73 offen sc1
    s_waitcnt vmcnt(14)
    ds_read_b64_tr_b16 v[80:81], v168 offset:8192
    ds_read_b64_tr_b16 v[82:83], v168 offset:9216
    ds_read_b64_tr_b16 v[84:85], v169 offset:8192
    ds_read_b64_tr_b16 v[86:87], v169 offset:9216
    s_waitcnt lgkmcnt(4)
    v_mfma_f32_32x32x16_bf16 v[104:119], v[88:91], v[40:43], v[104:119]
    v_mfma_f32_32x32x16_bf16 v[136:151], v[88:91], v[44:47], v[136:151]
    v_mfma_f32_32x32x16_bf16 v[120:135], v[92:95], v[40:43], v[120:135]
    v_mfma_f32_32x32x16_bf16 v[152:167], v[92:95], v[44:47], v[152:167]
    s_add_u32 s72, s76, 14336
    s_add_u32 s73, s77, 14336
    buffer_load_dwordx4 v[40:43], v1, s[52:55], s72 offen sc1
    buffer_load_dwordx4 v[44:47], v1, s[52:55], s73 offen sc1
    s_waitcnt vmcnt(14)
    ds_read_b64_tr_b16 v[88:89], v168 offset:10240
    ds_read_b64_tr_b16 v[90:91], v168 offset:11264
    ds_read_b64_tr_b16 v[92:93], v169 offset:10240
    ds_read_b64_tr_b16 v[94:95], v169 offset:11264
    s_waitcnt lgkmcnt(4)
    v_mfma_f32_32x32x16_bf16 v[104:119], v[80:83], v[48:51], v[104:119]
    v_mfma_f32_32x32x16_bf16 v[136:151], v[80:83], v[52:55], v[136:151]
    v_mfma_f32_32x32x16_bf16 v[120:135], v[84:87], v[48:51], v[120:135]
    v_mfma_f32_32x32x16_bf16 v[152:167], v[84:87], v[52:55], v[152:167]
    s_add_u32 s72, s76, 15360
    s_add_u32 s73, s77, 15360
    buffer_load_dwordx4 v[48:51], v1, s[52:55], s72 offen sc1
    buffer_load_dwordx4 v[52:55], v1, s[52:55], s73 offen sc1
    s_waitcnt vmcnt(14)
    ds_read_b64_tr_b16 v[80:81], v168 offset:12288
    ds_read_b64_tr_b16 v[82:83], v168 offset:13312
    ds_read_b64_tr_b16 v[84:85], v169 offset:12288
    ds_read_b64_tr_b16 v[86:87], v169 offset:13312
    s_waitcnt lgkmcnt(4)
    v_mfma_f32_32x32x16_bf16 v[104:119], v[88:91], v[56:59], v[104:119]
    v_mfma_f32_32x32x16_bf16 v[136:151], v[88:91], v[60:63], v[136:151]
    v_mfma_f32_32x32x16_bf16 v[120:135], v[92:95], v[56:59], v[120:135]
    v_mfma_f32_32x32x16_bf16 v[152:167], v[92:95], v[60:63], v[152:167]
    s_add_u32 s72, s76, 16384
    s_add_u32 s73, s77, 16384
    buffer_load_dwordx4 v[56:59], v1, s[52:55], s72 offen sc1
    buffer_load_dwordx4 v[60:63], v1, s[52:55], s73 offen sc1
    s_waitcnt vmcnt(14)
    ds_read_b64_tr_b16 v[88:89], v3 offset:0
    ds_read_b64_tr_b16 v[90:91], v3 offset:1024
    ds_read_b64_tr_b16 v[92:93], v4 offset:0
    ds_read_b64_tr_b16 v[94:95], v4 offset:1024
    s_waitcnt lgkmcnt(4)
    s_mov_b64 exec, 1
    ds_add_u32 v6, v7 offset:32
    s_mov_b64 exec, -1
    v_mfma_f32_32x32x16_bf16 v[104:119], v[80:83], v[64:67], v[104:119]
    v_mfma_f32_32x32x16_bf16 v[136:151], v[80:83], v[68:71], v[136:151]
    v_mfma_f32_32x32x16_bf16 v[120:135], v[84:87], v[64:67], v[120:135]
    v_mfma_f32_32x32x16_bf16 v[152:167], v[84:87], v[68:71], v[152:167]
    s_add_u32 s72, s76, 17408
    s_add_u32 s73, s77, 17408
    buffer_load_dwordx4 v[64:67], v1, s[52:55], s72 offen sc1
    buffer_load_dwordx4 v[68:71], v1, s[52:55], s73 offen sc1
    s_waitcnt vmcnt(14)
    ds_read_b64_tr_b16 v[80:81], v3 offset:2048
    ds_read_b64_tr_b16 v[82:83], v3 offset:3072
    ds_read_b64_tr_b16 v[84:85], v4 offset:2048
    ds_read_b64_tr_b16 v[86:87], v4 offset:3072
    s_waitcnt lgkmcnt(4)
    v_mfma_f32_32x32x16_bf16 v[104:119], v[88:91], v[72:75], v[104:119]
    s_add_u32 m0, s79, 0
    s_add_u32 s75, s78, 387072
    buffer_load_dwordx4 v2, s[40:43], s75 offen lds
    v_mfma_f32_32x32x16_bf16 v[136:151], v[88:91], v[76:79], v[136:151]
    s_add_u32 m0, s79, 1024
    s_add_u32 s75, s78, 394240
    buffer_load_dwordx4 v2, s[40:43], s75 offen lds
    v_mfma_f32_32x32x16_bf16 v[120:135], v[92:95], v[72:75], v[120:135]
    v_mfma_f32_32x32x16_bf16 v[152:167], v[92:95], v[76:79], v[152:167]
    s_add_u32 s72, s76, 18432
    s_add_u32 s73, s77, 18432
    buffer_load_dwordx4 v[72:75], v1, s[52:55], s72 offen sc1
    buffer_load_dwordx4 v[76:79], v1, s[52:55], s73 offen sc1
    s_waitcnt vmcnt(16)
    ds_read_b64_tr_b16 v[88:89], v3 offset:4096
    ds_read_b64_tr_b16 v[90:91], v3 offset:5120
    ds_read_b64_tr_b16 v[92:93], v4 offset:4096
    ds_read_b64_tr_b16 v[94:95], v4 offset:5120
    s_waitcnt lgkmcnt(4)
    v_mfma_f32_32x32x16_bf16 v[104:119], v[80:83], v[16:19], v[104:119]
    v_mfma_f32_32x32x16_bf16 v[136:151], v[80:83], v[20:23], v[136:151]
    v_mfma_f32_32x32x16_bf16 v[120:135], v[84:87], v[16:19], v[120:135]
    v_mfma_f32_32x32x16_bf16 v[152:167], v[84:87], v[20:23], v[152:167]
    s_add_u32 s72, s76, 19456
    s_add_u32 s73, s77, 19456
    buffer_load_dwordx4 v[16:19], v1, s[52:55], s72 offen sc1
    buffer_load_dwordx4 v[20:23], v1, s[52:55], s73 offen sc1
    s_waitcnt vmcnt(16)
    ds_read_b64_tr_b16 v[80:81], v3 offset:6144
    ds_read_b64_tr_b16 v[82:83], v3 offset:7168
    ds_read_b64_tr_b16 v[84:85], v4 offset:6144
    ds_read_b64_tr_b16 v[86:87], v4 offset:7168
    s_waitcnt lgkmcnt(4)
    v_mfma_f32_32x32x16_bf16 v[104:119], v[88:91], v[24:27], v[104:119]
    v_mfma_f32_32x32x16_bf16 v[136:151], v[88:91], v[28:31], v[136:151]
    v_mfma_f32_32x32x16_bf16 v[120:135], v[92:95], v[24:27], v[120:135]
    v_mfma_f32_32x32x16_bf16 v[152:167], v[92:95], v[28:31], v[152:167]
    s_add_u32 s72, s76, 0
    s_add_u32 s73, s77, 0
    buffer_load_dwordx4 v[24:27], v1, s[52:55], s72 offen sc1
    buffer_load_dwordx4 v[28:31], v1, s[52:55], s73 offen sc1
    s_waitcnt vmcnt(16)
    ds_read_b64_tr_b16 v[88:89], v3 offset:8192
    ds_read_b64_tr_b16 v[90:91], v3 offset:9216
    ds_read_b64_tr_b16 v[92:93], v4 offset:8192
    ds_read_b64_tr_b16 v[94:95], v4 offset:9216
    s_waitcnt lgkmcnt(4)
    v_mfma_f32_32x32x16_bf16 v[104:119], v[80:83], v[32:35], v[104:119]
    v_mfma_f32_32x32x16_bf16 v[136:151], v[80:83], v[36:39], v[136:151]
    v_mfma_f32_32x32x16_bf16 v[120:135], v[84:87], v[32:35], v[120:135]
    v_mfma_f32_32x32x16_bf16 v[152:167], v[84:87], v[36:39], v[152:167]
    s_add_u32 s72, s76, 1024
    s_add_u32 s73, s77, 1024
    buffer_load_dwordx4 v[32:35], v1, s[52:55], s72 offen sc1
    buffer_load_dwordx4 v[36:39], v1, s[52:55], s73 offen sc1
    s_waitcnt vmcnt(16)
    ds_read_b64_tr_b16 v[80:81], v3 offset:10240
    ds_read_b64_tr_b16 v[82:83], v3 offset:11264
    ds_read_b64_tr_b16 v[84:85], v4 offset:10240
    ds_read_b64_tr_b16 v[86:87], v4 offset:11264
    s_waitcnt lgkmcnt(4)
    v_mfma_f32_32x32x16_bf16 v[104:119], v[88:91], v[40:43], v[104:119]
    v_mfma_f32_32x32x16_bf16 v[136:151], v[88:91], v[44:47], v[136:151]
    v_mfma_f32_32x32x16_bf16 v[120:135], v[92:95], v[40:43], v[120:135]
    v_mfma_f32_32x32x16_bf16 v[152:167], v[92:95], v[44:47], v[152:167]
    s_add_u32 s72, s76, 2048
    s_add_u32 s73, s77, 2048
    buffer_load_dwordx4 v[40:43], v1, s[52:55], s72 offen sc1
    buffer_load_dwordx4 v[44:47], v1, s[52:55], s73 offen sc1
    s_waitcnt vmcnt(16)
    ds_read_b64_tr_b16 v[88:89], v3 offset:12288
    ds_read_b64_tr_b16 v[90:91], v3 offset:13312
    ds_read_b64_tr_b16 v[92:93], v4 offset:12288
    ds_read_b64_tr_b16 v[94:95], v4 offset:13312
    s_waitcnt lgkmcnt(4)
    v_mfma_f32_32x32x16_bf16 v[104:119], v[80:83], v[48:51], v[104:119]
    v_mfma_f32_32x32x16_bf16 v[136:151], v[80:83], v[52:55], v[136:151]
    v_mfma_f32_32x32x16_bf16 v[120:135], v[84:87], v[48:51], v[120:135]
    v_mfma_f32_32x32x16_bf16 v[152:167], v[84:87], v[52:55], v[152:167]
    s_add_u32 s72, s76, 3072
    s_add_u32 s73, s77, 3072
    buffer_load_dwordx4 v[48:51], v1, s[52:55], s72 offen sc1
    buffer_load_dwordx4 v[52:55], v1, s[52:55], s73 offen sc1
    s_waitcnt vmcnt(16)
    ds_read_b64_tr_b16 v[80:81], v3 offset:14336
    ds_read_b64_tr_b16 v[82:83], v3 offset:15360
    ds_read_b64_tr_b16 v[84:85], v4 offset:14336
    ds_read_b64_tr_b16 v[86:87], v4 offset:15360
    s_waitcnt lgkmcnt(4)
    v_mfma_f32_32x32x16_bf16 v[104:119], v[88:91], v[56:59], v[104:119]
    v_mfma_f32_32x32x16_bf16 v[136:151], v[88:91], v[60:63], v[136:151]
    v_mfma_f32_32x32x16_bf16 v[120:135], v[92:95], v[56:59], v[120:135]
    v_mfma_f32_32x32x16_bf16 v[152:167], v[92:95], v[60:63], v[152:167]
    s_add_u32 s72, s76, 4096
    s_add_u32 s73, s77, 4096
    buffer_load_dwordx4 v[56:59], v1, s[52:55], s72 offen sc1
    buffer_load_dwordx4 v[60:63], v1, s[52:55], s73 offen sc1
    s_waitcnt vmcnt(16)
    ds_read_b64_tr_b16 v[88:89], v3 offset:16384
    ds_read_b64_tr_b16 v[90:91], v3 offset:17408
    ds_read_b64_tr_b16 v[92:93], v4 offset:16384
    ds_read_b64_tr_b16 v[94:95], v4 offset:17408
    s_waitcnt lgkmcnt(4)
    v_mfma_f32_32x32x16_bf16 v[104:119], v[80:83], v[64:67], v[104:119]
    v_mfma_f32_32x32x16_bf16 v[136:151], v[80:83], v[68:71], v[136:151]
    v_mfma_f32_32x32x16_bf16 v[120:135], v[84:87], v[64:67], v[120:135]
    v_mfma_f32_32x32x16_bf16 v[152:167], v[84:87], v[68:71], v[152:167]
    s_add_u32 s72, s76, 5120
    s_add_u32 s73, s77, 5120
    buffer_load_dwordx4 v[64:67], v1, s[52:55], s72 offen sc1
    buffer_load_dwordx4 v[68:71], v1, s[52:55], s73 offen sc1
    s_waitcnt vmcnt(14)
    ds_read_b64_tr_b16 v[80:81], v3 offset:18432
    ds_read_b64_tr_b16 v[82:83], v3 offset:19456
    ds_read_b64_tr_b16 v[84:85], v4 offset:18432
    ds_read_b64_tr_b16 v[86:87], v4 offset:19456
    s_waitcnt lgkmcnt(4)
    v_mfma_f32_32x32x16_bf16 v[104:119], v[88:91], v[72:75], v[104:119]
    v_mfma_f32_32x32x16_bf16 v[136:151], v[88:91], v[76:79], v[136:151]
    v_mfma_f32_32x32x16_bf16 v[120:135], v[92:95], v[72:75], v[120:135]
    v_mfma_f32_32x32x16_bf16 v[152:167], v[92:95], v[76:79], v[152:167]
    s_add_u32 s72, s76, 6144
    s_add_u32 s73, s77, 6144
    buffer_load_dwordx4 v[72:75], v1, s[52:55], s72 offen sc1
    buffer_load_dwordx4 v[76:79], v1, s[52:55], s73 offen sc1
    s_waitcnt vmcnt(14)
    s_waitcnt lgkmcnt(0)
    v_mfma_f32_32x32x16_bf16 v[104:119], v[80:83], v[16:19], v[104:119]
    v_mfma_f32_32x32x16_bf16 v[136:151], v[80:83], v[20:23], v[136:151]
    v_mfma_f32_32x32x16_bf16 v[120:135], v[84:87], v[16:19], v[120:135]
    v_mfma_f32_32x32x16_bf16 v[152:167], v[84:87], v[20:23], v[152:167]
    s_add_u32 s72, s76, 7168
    s_add_u32 s73, s77, 7168
    buffer_load_dwordx4 v[16:19], v1, s[52:55], s72 offen sc1
    buffer_load_dwordx4 v[20:23], v1, s[52:55], s73 offen sc1
    s_waitcnt vmcnt(14)
    v_mfma_f32_32x32x16_bf16 v[104:119], v[176:179], v[24:27], v[104:119]
    v_mfma_f32_32x32x16_bf16 v[136:151], v[176:179], v[28:31], v[136:151]
    v_mfma_f32_32x32x16_bf16 v[120:135], v[180:183], v[24:27], v[120:135]
    v_mfma_f32_32x32x16_bf16 v[152:167], v[180:183], v[28:31], v[152:167]
    s_add_u32 s72, s76, 8192
    s_add_u32 s73, s77, 8192
    buffer_load_dwordx4 v[24:27], v1, s[52:55], s72 offen sc1
    buffer_load_dwordx4 v[28:31], v1, s[52:55], s73 offen sc1
    s_waitcnt vmcnt(14)
    v_mfma_f32_32x32x16_bf16 v[104:119], v[184:187], v[32:35], v[104:119]
    v_mfma_f32_32x32x16_bf16 v[136:151], v[184:187], v[36:39], v[136:151]
    v_mfma_f32_32x32x16_bf16 v[120:135], v[188:191], v[32:35], v[120:135]
    v_mfma_f32_32x32x16_bf16 v[152:167], v[188:191], v[36:39], v[152:167]
    s_add_u32 s72, s76, 9216
    s_add_u32 s73, s77, 9216
    buffer_load_dwordx4 v[32:35], v1, s[52:55], s72 offen sc1
    buffer_load_dwordx4 v[36:39], v1, s[52:55], s73 offen sc1
    s_waitcnt vmcnt(14)
    v_mfma_f32_32x32x16_bf16 v[104:119], v[192:195], v[40:43], v[104:119]
    v_mfma_f32_32x32x16_bf16 v[136:151], v[192:195], v[44:47], v[136:151]
    v_mfma_f32_32x32x16_bf16 v[120:135], v[196:199], v[40:43], v[120:135]
    v_mfma_f32_32x32x16_bf16 v[152:167], v[196:199], v[44:47], v[152:167]
    s_add_u32 s72, s76, 27648
    s_add_u32 s73, s77, 27648
    buffer_load_dwordx4 v[40:43], v1, s[52:55], s72 offen sc1
    buffer_load_dwordx4 v[44:47], v1, s[52:55], s73 offen sc1
    s_waitcnt vmcnt(14)
    v_mfma_f32_32x32x16_bf16 v[104:119], v[200:203], v[48:51], v[104:119]
    v_mfma_f32_32x32x16_bf16 v[136:151], v[200:203], v[52:55], v[136:151]
    v_mfma_f32_32x32x16_bf16 v[120:135], v[204:207], v[48:51], v[120:135]
    v_mfma_f32_32x32x16_bf16 v[152:167], v[204:207], v[52:55], v[152:167]
    s_waitcnt vmcnt(12)
    v_mfma_f32_32x32x16_bf16 v[104:119], v[208:211], v[56:59], v[104:119]
    v_mfma_f32_32x32x16_bf16 v[136:151], v[208:211], v[60:63], v[136:151]
    v_mfma_f32_32x32x16_bf16 v[120:135], v[212:215], v[56:59], v[120:135]
    v_mfma_f32_32x32x16_bf16 v[152:167], v[212:215], v[60:63], v[152:167]
    s_waitcnt vmcnt(10)
    v_mfma_f32_32x32x16_bf16 v[104:119], v[216:219], v[64:67], v[104:119]
    v_mfma_f32_32x32x16_bf16 v[136:151], v[216:219], v[68:71], v[136:151]
    v_mfma_f32_32x32x16_bf16 v[120:135], v[220:223], v[64:67], v[120:135]
    v_mfma_f32_32x32x16_bf16 v[152:167], v[220:223], v[68:71], v[152:167]
    s_waitcnt vmcnt(8)
    v_mfma_f32_32x32x16_bf16 v[104:119], v[224:227], v[72:75], v[104:119]
    v_mfma_f32_32x32x16_bf16 v[136:151], v[224:227], v[76:79], v[136:151]
    v_mfma_f32_32x32x16_bf16 v[120:135], v[228:231], v[72:75], v[120:135]
    v_mfma_f32_32x32x16_bf16 v[152:167], v[228:231], v[76:79], v[152:167]
    s_waitcnt vmcnt(6)
    v_mfma_f32_32x32x16_bf16 v[104:119], v[232:235], v[16:19], v[104:119]
    v_mfma_f32_32x32x16_bf16 v[136:151], v[232:235], v[20:23], v[136:151]
    v_mfma_f32_32x32x16_bf16 v[120:135], v[236:239], v[16:19], v[120:135]
    v_mfma_f32_32x32x16_bf16 v[152:167], v[236:239], v[20:23], v[152:167]
    s_waitcnt vmcnt(4)
    v_mfma_f32_32x32x16_bf16 v[104:119], v[240:243], v[24:27], v[104:119]
    v_mfma_f32_32x32x16_bf16 v[136:151], v[240:243], v[28:31], v[136:151]
    v_mfma_f32_32x32x16_bf16 v[120:135], v[244:247], v[24:27], v[120:135]
    v_mfma_f32_32x32x16_bf16 v[152:167], v[244:247], v[28:31], v[152:167]
    s_waitcnt vmcnt(2)
    ds_read_b64_tr_b16 v[88:89], v3 offset:0
    ds_read_b64_tr_b16 v[90:91], v3 offset:1024
    ds_read_b64_tr_b16 v[92:93], v4 offset:0
    ds_read_b64_tr_b16 v[94:95], v4 offset:1024
    v_mfma_f32_32x32x16_bf16 v[104:119], v[248:251], v[32:35], v[104:119]
    v_mfma_f32_32x32x16_bf16 v[136:151], v[248:251], v[36:39], v[136:151]
    v_mfma_f32_32x32x16_bf16 v[120:135], v[252:255], v[32:35], v[120:135]
    v_mfma_f32_32x32x16_bf16 v[152:167], v[252:255], v[36:39], v[152:167]
    s_waitcnt vmcnt(0)
    s_waitcnt lgkmcnt(0)
    v_mfma_f32_32x32x16_bf16 v[104:119], v[88:91], v[40:43], v[104:119]
    v_mfma_f32_32x32x16_bf16 v[136:151], v[88:91], v[44:47], v[136:151]
    v_mfma_f32_32x32x16_bf16 v[120:135], v[92:95], v[40:43], v[120:135]
    v_mfma_f32_32x32x16_bf16 v[152:167], v[92:95], v[44:47], v[152:167]
    s_setprio 2
    s_waitcnt lgkmcnt(0)
    s_nop 0
    v_add_u32 v14, s79, v1
    s_nop 5
    ds_write_b128 v14, v[104:107] offset:0
    ds_write_b128 v14, v[108:111] offset:1088
    ds_write_b128 v14, v[112:115] offset:2176
    ds_write_b128 v14, v[116:119] offset:3264
    ds_write_b128 v14, v[136:139] offset:8704
    ds_write_b128 v14, v[140:143] offset:9792
    ds_write_b128 v14, v[144:147] offset:10880
    ds_write_b128 v14, v[148:151] offset:11968
    ds_write_b128 v14, v[120:123] offset:4352
    ds_write_b128 v14, v[124:127] offset:5440
    ds_write_b128 v14, v[128:131] offset:6528
    ds_write_b128 v14, v[132:135] offset:7616
    ds_write_b128 v14, v[152:155] offset:13056
    ds_write_b128 v14, v[156:159] offset:14144
    ds_write_b128 v14, v[160:163] offset:15232
    ds_write_b128 v14, v[164:167] offset:16320
    s_mov_b64 exec, 1
    ds_add_u32 v6, v7 offset:32
    s_mov_b64 exec, -1
    v_add_u32 v9, 34816, v11
    v_lshlrev_b32 v192, 16, v96
    v_and_b32 v193, 0xffff0000, v96
    v_lshlrev_b32 v194, 16, v97
    v_and_b32 v195, 0xffff0000, v97
    v_lshlrev_b32 v196, 16, v98
    v_and_b32 v197, 0xffff0000, v98
    v_lshlrev_b32 v198, 16, v99
    v_and_b32 v199, 0xffff0000, v99
    v_lshlrev_b32 v200, 16, v100
    v_and_b32 v201, 0xffff0000, v100
    v_lshlrev_b32 v202, 16, v101
    v_and_b32 v203, 0xffff0000, v101
    v_lshlrev_b32 v204, 16, v102
    v_and_b32 v205, 0xffff0000, v102
    v_lshlrev_b32 v206, 16, v103
    v_and_b32 v207, 0xffff0000, v103
    s_mov_b32 s3, 0x40000
LW_151:
    ds_read_b32 v15, v6 offset:32
    s_waitcnt lgkmcnt(0)
    v_readfirstlane_b32 s71, v15
    s_cmp_ge_u32 s71, 44
    s_cbranch_scc1 LD_152
    s_sub_u32 s3, s3, 1
    s_cmp_lg_u32 s3, 0
    s_cbranch_scc1 LW_151
LD_152:
    ds_read_b128 v[16:19], v12 offset:0
    ds_read_b128 v[20:23], v12 offset:512
    ds_read_b128 v[24:27], v12 offset:128
    ds_read_b128 v[28:31], v12 offset:640
    ds_read_b128 v[32:35], v12 offset:20480
    ds_read_b128 v[36:39], v12 offset:20992
    ds_read_b128 v[40:43], v12 offset:20608
    ds_read_b128 v[44:47], v12 offset:21120
    ds_read_b128 v[48:51], v13 offset:0
    ds_read_b128 v[52:55], v13 offset:512
    ds_read_b128 v[56:59], v13 offset:128
    ds_read_b128 v[60:63], v13 offset:640
    s_waitcnt lgkmcnt(4)
    v_add_f32 v16, v16, v32
    v_add_f32 v17, v17, v33
    v_add_f32 v18, v18, v34
    v_add_f32 v19, v19, v35
    v_add_f32 v20, v20, v36
    v_add_f32 v21, v21, v37
    v_add_f32 v22, v22, v38
    v_add_f32 v23, v23, v39
    v_add_f32 v24, v24, v40
    v_add_f32 v25, v25, v41
    v_add_f32 v26, v26, v42
    v_add_f32 v27, v27, v43
    v_add_f32 v28, v28, v44
    v_add_f32 v29, v29, v45
    v_add_f32 v30, v30, v46
    v_add_f32 v31, v31, v47
    ds_read_b128 v[64:67], v13 offset:20480
    ds_read_b128 v[68:71], v13 offset:20992
    ds_read_b128 v[72:75], v13 offset:20608
    ds_read_b128 v[76:79], v13 offset:21120
    s_waitcnt lgkmcnt(4)
    v_add_f32 v16, v16, v48
    v_add_f32 v17, v17, v49
    v_add_f32 v18, v18, v50
    v_add_f32 v19, v19, v51
    v_add_f32 v20, v20, v52
    v_add_f32 v21, v21, v53
    v_add_f32 v22, v22, v54
    v_add_f32 v23, v23, v55
    v_add_f32 v24, v24, v56
    v_add_f32 v25, v25, v57
    v_add_f32 v26, v26, v58
    v_add_f32 v27, v27, v59
    v_add_f32 v28, v28, v60
    v_add_f32 v29, v29, v61
    v_add_f32 v30, v30, v62
    v_add_f32 v31, v31, v63
    s_waitcnt lgkmcnt(0)
    v_add_f32 v16, v16, v64
    v_add_f32 v17, v17, v65
    v_add_f32 v18, v18, v66
    v_add_f32 v19, v19, v67
    v_add_f32 v20, v20, v68
    v_add_f32 v21, v21, v69
    v_add_f32 v22, v22, v70
    v_add_f32 v23, v23, v71
    v_add_f32 v24, v24, v72
    v_add_f32 v25, v25, v73
    v_add_f32 v26, v26, v74
    v_add_f32 v27, v27, v75
    v_add_f32 v28, v28, v76
    v_add_f32 v29, v29, v77
    v_add_f32 v30, v30, v78
    v_add_f32 v31, v31, v79
    s_mov_b32 s72, 0xbfb8aa3b
    v_mul_f32 v176, s72, v16
    v_mul_f32 v177, s72, v17
    v_mul_f32 v178, s72, v18
    v_mul_f32 v179, s72, v19
    v_mul_f32 v180, s72, v20
    v_mul_f32 v181, s72, v21
    v_mul_f32 v182, s72, v22
    v_mul_f32 v183, s72, v23
    v_mul_f32 v184, s72, v24
    v_mul_f32 v185, s72, v25
    v_mul_f32 v186, s72, v26
    v_mul_f32 v187, s72, v27
    v_mul_f32 v188, s72, v28
    v_mul_f32 v189, s72, v29
    v_mul_f32 v190, s72, v30
    v_mul_f32 v191, s72, v31
    v_exp_f32 v176, v176
    v_exp_f32 v177, v177
    v_exp_f32 v178, v178
    v_exp_f32 v179, v179
    v_exp_f32 v180, v180
    v_exp_f32 v181, v181
    v_exp_f32 v182, v182
    v_exp_f32 v183, v183
    v_exp_f32 v184, v184
    v_exp_f32 v185, v185
    v_exp_f32 v186, v186
    v_exp_f32 v187, v187
    v_exp_f32 v188, v188
    v_exp_f32 v189, v189
    v_exp_f32 v190, v190
    v_exp_f32 v191, v191
    v_add_f32 v176, 1.0, v176
    v_add_f32 v177, 1.0, v177
    v_add_f32 v178, 1.0, v178
    v_add_f32 v179, 1.0, v179
    v_add_f32 v180, 1.0, v180
    v_add_f32 v181, 1.0, v181
    v_add_f32 v182, 1.0, v182
    v_add_f32 v183, 1.0, v183
    v_add_f32 v184, 1.0, v184
    v_add_f32 v185, 1.0, v185
    v_add_f32 v186, 1.0, v186
    v_add_f32 v187, 1.0, v187
    v_add_f32 v188, 1.0, v188
    v_add_f32 v189, 1.0, v189
    v_add_f32 v190, 1.0, v190
    v_add_f32 v191, 1.0, v191
    v_rcp_f32 v176, v176
    v_rcp_f32 v177, v177
    v_rcp_f32 v178, v178
    v_rcp_f32 v179, v179
    v_rcp_f32 v180, v180
    v_rcp_f32 v181, v181
    v_rcp_f32 v182, v182
    v_rcp_f32 v183, v183
    v_rcp_f32 v184, v184
    v_rcp_f32 v185, v185
    v_rcp_f32 v186, v186
    v_rcp_f32 v187, v187
    v_rcp_f32 v188, v188
    v_rcp_f32 v189, v189
    v_rcp_f32 v190, v190
    v_rcp_f32 v191, v191
    s_nop 0
    v_mul_f32 v176, v176, v16
    v_mul_f32 v177, v177, v17
    v_mul_f32 v178, v178, v18
    v_mul_f32 v179, v179, v19
    v_mul_f32 v180, v180, v20
    v_mul_f32 v181, v181, v21
    v_mul_f32 v182, v182, v22
    v_mul_f32 v183, v183, v23
    v_mul_f32 v184, v184, v24
    v_mul_f32 v185, v185, v25
    v_mul_f32 v186, v186, v26
    v_mul_f32 v187, v187, v27
    v_mul_f32 v188, v188, v28
    v_mul_f32 v189, v189, v29
    v_mul_f32 v190, v190, v30
    v_mul_f32 v191, v191, v31
    s_mov_b32 s3, 0x40000
LW_153:
    ds_read_b32 v15, v6 offset:60
    s_waitcnt lgkmcnt(0)
    v_readfirstlane_b32 s71, v15
    s_cmp_ge_u32 s71, 4
    s_cbranch_scc1 LD_154
    s_sub_u32 s3, s3, 1
    s_cmp_lg_u32 s3, 0
    s_cbranch_scc1 LW_153
LD_154:
    ds_read_b128 v[16:19], v11 offset:0
    ds_read_b128 v[20:23], v11 offset:512
    ds_read_b128 v[24:27], v11 offset:128
    ds_read_b128 v[28:31], v11 offset:640
    ds_read_b128 v[32:35], v11 offset:17408
    ds_read_b128 v[36:39], v11 offset:17920
    ds_read_b128 v[40:43], v11 offset:17536
    ds_read_b128 v[44:47], v11 offset:18048
    ds_read_b128 v[48:51], v9 offset:0
    ds_read_b128 v[52:55], v9 offset:512
    ds_read_b128 v[56:59], v9 offset:128
    ds_read_b128 v[60:63], v9 offset:640
    s_waitcnt lgkmcnt(4)
    v_pk_add_f32 v[16:17], v[16:17], v[32:33]
    v_pk_add_f32 v[18:19], v[18:19], v[34:35]
    v_pk_add_f32 v[20:21], v[20:21], v[36:37]
    v_pk_add_f32 v[22:23], v[22:23], v[38:39]
    v_pk_add_f32 v[24:25], v[24:25], v[40:41]
    v_pk_add_f32 v[26:27], v[26:27], v[42:43]
    v_pk_add_f32 v[28:29], v[28:29], v[44:45]
    v_pk_add_f32 v[30:31], v[30:31], v[46:47]
    ds_read_b128 v[64:67], v9 offset:17408
    ds_read_b128 v[68:71], v9 offset:17920
    ds_read_b128 v[72:75], v9 offset:17536
    ds_read_b128 v[76:79], v9 offset:18048
    s_waitcnt lgkmcnt(4)
    v_pk_add_f32 v[16:17], v[16:17], v[48:49]
    v_pk_add_f32 v[18:19], v[18:19], v[50:51]
    v_pk_add_f32 v[20:21], v[20:21], v[52:53]
    v_pk_add_f32 v[22:23], v[22:23], v[54:55]
    v_pk_add_f32 v[24:25], v[24:25], v[56:57]
    v_pk_add_f32 v[26:27], v[26:27], v[58:59]
    v_pk_add_f32 v[28:29], v[28:29], v[60:61]
    v_pk_add_f32 v[30:31], v[30:31], v[62:63]
    s_waitcnt lgkmcnt(0)
    v_pk_add_f32 v[16:17], v[16:17], v[64:65]
    v_pk_add_f32 v[18:19], v[18:19], v[66:67]
    v_pk_add_f32 v[20:21], v[20:21], v[68:69]
    v_pk_add_f32 v[22:23], v[22:23], v[70:71]
    v_pk_add_f32 v[24:25], v[24:25], v[72:73]
    v_pk_add_f32 v[26:27], v[26:27], v[74:75]
    v_pk_add_f32 v[28:29], v[28:29], v[76:77]
    v_pk_add_f32 v[30:31], v[30:31], v[78:79]
    v_pk_fma_f32 v[16:17], v[16:17], v[176:177], v[192:193]
    v_pk_fma_f32 v[18:19], v[18:19], v[178:179], v[194:195]
    v_pk_fma_f32 v[20:21], v[20:21], v[180:181], v[196:197]
    v_pk_fma_f32 v[22:23], v[22:23], v[182:183], v[198:199]
    v_pk_fma_f32 v[24:25], v[24:25], v[184:185], v[200:201]
    v_pk_fma_f32 v[26:27], v[26:27], v[186:187], v[202:203]
    v_pk_fma_f32 v[28:29], v[28:29], v[188:189], v[204:205]
    v_pk_fma_f32 v[30:31], v[30:31], v[190:191], v[206:207]
    v_cvt_pk_bf16_f32 v32, v16, v17
    v_cvt_pk_bf16_f32 v33, v18, v19
    v_cvt_pk_bf16_f32 v34, v20, v21
    v_cvt_pk_bf16_f32 v35, v22, v23
    buffer_store_dwordx4 v[32:35], v5, s[48:51], s82 offen nt
    v_cvt_pk_bf16_f32 v36, v24, v25
    v_cvt_pk_bf16_f32 v37, v26, v27
    v_cvt_pk_bf16_f32 v38, v28, v29
    v_cvt_pk_bf16_f32 v39, v30, v31
    buffer_store_dwordx4 v[36:39], v5, s[48:51], s36 offen nt
L_ffn_end:
L_end:
    s_endpgm
L_code_end:

.section .rodata,"a"
.p2align 6
.amdhsa_kernel recurrent_scan__softmax_full_mha__glu_gated_swiglu__prompt_kernel
  .amdhsa_next_free_vgpr 256
  .amdhsa_next_free_sgpr 102
  .amdhsa_accum_offset 256
  .amdhsa_group_segment_fixed_size 0
  .amdhsa_kernarg_size 80
  .amdhsa_user_sgpr_count 2
  .amdhsa_user_sgpr_kernarg_segment_ptr 1
  .amdhsa_system_sgpr_workgroup_id_x 1
.end_amdhsa_kernel
```
